```python
import torch

def _softmax(x, axis=-1):
    return torch.softmax(x, dim=axis)

def _gelu(x):
    return torch.nn.functional.gelu(x, approximate='tanh')

def _silu(x):
    return torch.nn.functional.silu(x)

def _sigmoid(x):
    return torch.sigmoid(x)

def _layernorm(x, axis=-1, eps=1e-05):
    m = x.mean(dim=axis, keepdim=True)
    v = x.var(dim=axis, keepdim=True, unbiased=False)
    return (x - m) / torch.sqrt(v + eps)

def _scatter_add(tgt, idx, src, axis=0):
    return tgt.clone().index_add_(axis, idx, src)

def _segment_sum(src, seg, n):
    out = torch.zeros((n,) + src.shape[1:], dtype=src.dtype)
    return out.index_add_(0, seg, src)

def _pad(x, pw):
    flat = tuple((v for pair in reversed(pw) for v in pair))
    return torch.nn.functional.pad(x, flat)
kernel_name = 'concat_heads__sliding_block__memory_aug_recurrent_mem_tr__prompt'

def setup_inputs():

    _w = lambda a: (lambda t: t.to(torch.bfloat16) if t.is_floating_point() else t)(torch.as_tensor(a))

    def _A_setup():
        B, S, D = (1, 2048, 512)
        return {'x': _w((lambda *s: torch.randn(*s, dtype=torch.bfloat16) * 0.2)(B, S, D)), 'wqkv': _w((lambda *s: torch.randn(*s, dtype=torch.bfloat16) * 0.2)(D, 3 * D)), 'wo': _w((lambda *s: torch.randn(*s, dtype=torch.bfloat16) * 0.05)(D, D))}
    _A_in = _A_setup()

    def _B_setup():
        B, S, Dm = (1, 2048, 512)
        H, Dh = (32, 128)
        M, seg = (8, 32)
        seg = min(seg, S)
        S = S // seg * seg
        return {'x': _w((lambda *s: torch.randn(*s, dtype=torch.bfloat16) * 0.05)(B, S, Dm)), 'mem0': _w((lambda *s: torch.randn(*s, dtype=torch.bfloat16) * 1.6)(B, M, Dm)), 'Wq': _w((lambda *s: torch.randn(*s, dtype=torch.bfloat16) * 0.8)(Dm, H, Dh) * Dm ** (-0.5)), 'Wk': _w((lambda *s: torch.randn(*s, dtype=torch.bfloat16) * 0.8)(Dm, H, Dh) * Dm ** (-0.5)), 'Wv': _w((lambda *s: torch.randn(*s, dtype=torch.bfloat16) * 1.6)(Dm, H, Dh) * Dm ** (-0.5)), 'Wo': _w((lambda *s: torch.randn(*s, dtype=torch.bfloat16) * 1.6)(H, Dh, Dm) * (H * Dh) ** (-0.5)), 'seg_len': seg}
    _B_in = _B_setup()
    return {'A_x': _A_in['x'], 'A_wqkv': _A_in['wqkv'], 'A_wo': _A_in['wo'], 'B_x': _B_in['x'], 'B_mem0': _B_in['mem0'], 'B_Wq': _B_in['Wq'], 'B_Wk': _B_in['Wk'], 'B_Wv': _B_in['Wv'], 'B_Wo': _B_in['Wo'], 'B_seg_len': _B_in['seg_len']}

def reference(A_x, A_wqkv, A_wo, B_x, B_mem0, B_Wq, B_Wk, B_Wv, B_Wo, B_seg_len):

    def _A_ref(x, wqkv, wo):
        B, S, D = x.shape
        H = 32
        Dh = D // H
        W = 256
        qkv = (lambda x, *d: x.permute(*d))((x @ wqkv).reshape(B, S, 3, H, Dh), 2, 0, 3, 1, 4)
        q, k, v = (qkv[0], qkv[1], qkv[2])
        scores = torch.einsum('bhqd,bhkd->bhqk', q, k) * Dh ** (-0.5)
        idx = torch.arange(S)
        mask = (idx[:, None] - idx[None, :] >= 0) & (idx[:, None] - idx[None, :] < W)
        scores = torch.where(mask[None, None], scores, -1000000000.0)
        p = _softmax(scores, axis=-1)
        o = torch.einsum('bhqk,bhkd->bhqd', p, v)
        return (lambda x, *d: x.permute(*d))(o, 0, 2, 1, 3).reshape(B, S, D) @ wo

    def _B_ref(x, mem0, Wq, Wk, Wv, Wo, seg_len):
        B, S, Dm = x.shape
        H, Dh = (Wq.shape[1], Wq.shape[2])
        M = mem0.shape[1]
        scale = Dh ** (-0.5)
        n_seg = S // seg_len
        L = M + seg_len
        idx = torch.arange(L)
        mask = (idx[:, None] < M) | (idx[:, None] >= idx[None, :])
        mem = mem0
        outs = []
        for s in range(n_seg):
            xs = x[:, s * seg_len:(s + 1) * seg_len, :].clone()
            h = torch.concatenate([mem, xs], axis=1)
            q = torch.einsum('btd,dhe->bhte', h, Wq)
            k = torch.einsum('btd,dhe->bhte', h, Wk)
            v = torch.einsum('btd,dhe->bhte', h, Wv)
            scores = torch.einsum('bhqe,bhke->bhqk', q, k) * scale
            scores = torch.where(mask[None, None], scores, -1000000000.0)
            p = _softmax(scores, axis=-1)
            o = torch.einsum('bhqk,bhke->bhqe', p, v)
            o = torch.einsum('bhte,hed->btd', o, Wo)
            mem = o[:, :M, :].clone()
            outs.append(o[:, M:, :])
        return torch.concatenate(outs, axis=1)
    a = _A_ref(A_x, A_wqkv, A_wo)
    b = _B_ref(B_x, B_mem0, B_Wq, B_Wk, B_Wv, B_Wo, B_seg_len)
    return torch.concatenate([a, b], axis=-1)
```

```asm
; @launch grid=(256,1,1) block=(256,1,1) lds=163840
.amdgcn_target "amdgcn-amd-amdhsa--gfx950"
.text
.globl concat_heads__sliding_block__memory_aug_recurrent_mem_tr__prompt_kernel
.p2align 8
.type concat_heads__sliding_block__memory_aug_recurrent_mem_tr__prompt_kernel,@function
concat_heads__sliding_block__memory_aug_recurrent_mem_tr__prompt_kernel:
    s_cmp_ge_u32 s2, 256
    s_cbranch_scc1 L_exit
    s_mov_b32 s101, 0
    s_load_dwordx16 s[4:19], s[0:1], 0
    s_load_dwordx8 s[20:27], s[0:1], 64
    s_load_dwordx2 s[28:29], s[0:1], 96
    s_getreg_b32 s44, hwreg(HW_REG_XCC_ID)
    s_and_b32 s44, s44, 7
    v_lshrrev_b32 v1, 6, v0
    s_nop 0
    v_readfirstlane_b32 s45, v1
    s_waitcnt lgkmcnt(0)
    s_mov_b32 s32, s28
    s_and_b32 s33, s29, 0xffff
    s_mov_b32 s34, 0x10000000
    s_mov_b32 s35, 0x00020000
    s_cmp_lg_u32 s45, 0
    s_cbranch_scc1 L_elect_done
    s_mov_b64 s[76:77], exec
    s_mov_b64 exec, 1
    s_and_b32 s48, s44, 3
    s_lshl_b32 s48, s48, 6
    s_and_b32 s49, s44, 4
    s_add_u32 s48, s48, s49
    s_add_u32 s48, s48, 48
    v_mov_b32 v2, s48
    v_mov_b32 v3, 1
    global_atomic_add v4, v2, v3, s[26:27] sc0
    s_waitcnt vmcnt(0)
    v_readfirstlane_b32 s46, v4
    s_nop 2
    s_cmp_lg_u32 s46, 31
    s_cbranch_scc1 L_elect_wait
    s_add_u32 s48, s44, 1
    v_mov_b32 v4, s48
    v_mov_b32 v5, 0
    v_mov_b32 v2, 64
    global_atomic_cmpswap v2, v[4:5], s[26:27]
    s_waitcnt vmcnt(0)
L_elect_wait:
    v_mov_b32 v2, 64
L_elect_spin:
    s_add_u32 s101, s101, 1
    s_cmp_gt_u32 s101, 0x200000
    s_cbranch_scc1 L_exit
    global_load_dword v4, v2, s[26:27] sc1
    s_waitcnt vmcnt(0)
    v_readfirstlane_b32 s48, v4
    s_nop 2
    s_cmp_eq_u32 s48, 0
    s_cbranch_scc1 L_elect_spin
    s_sub_u32 s48, s48, 1
    s_mov_b32 s47, 1
    s_cmp_lg_u32 s48, s44
    s_cbranch_scc1 L_elect_worker
    s_cmp_lt_u32 s46, 32
    s_cbranch_scc1 L_elect_pub
L_elect_worker:
    s_mov_b32 s47, 0
    s_cmp_gt_u32 s44, s48
    s_cselect_b32 s49, 1, 0
    s_sub_u32 s46, s44, s49
    s_min_u32 s46, s46, 6
L_elect_pub:
    v_mov_b32 v2, 161792
    v_mov_b32 v4, s47
    v_mov_b32 v5, s46
    ds_write_b64 v2, v[4:5]
    s_waitcnt lgkmcnt(0)
    s_mov_b64 exec, s[76:77]
L_elect_done:
    s_barrier
    v_mov_b32 v2, 161792
    ds_read_b64 v[4:5], v2
    s_waitcnt lgkmcnt(0)
    v_readfirstlane_b32 s47, v4
    v_readfirstlane_b32 s46, v5
    s_nop 2
    s_barrier
    s_cmp_eq_u32 s47, 0
    s_cbranch_scc1 L_worker
    v_mov_b32 v19, v0
    v_and_b32 v20, 63, v19
    v_and_b32 v21, 15, v19
    v_bfe_u32 v22, v19, 4, 2
    v_lshlrev_b32 v0, 4, v20
    s_lshl_b32 s78, s45, 9
    s_lshl_b32 s79, s45, 10
    s_lshl_b32 s48, s45, 14
    s_add_u32 s48, s48, 32768
    v_add_u32 v1, s48, v0
    v_lshlrev_b32 v23, 8, v22
    v_bfe_u32 v24, v21, 1, 1
    v_lshl_add_u32 v23, v24, 7, v23
    v_lshrrev_b32 v24, 2, v21
    v_lshl_add_u32 v23, v24, 5, v23
    v_and_b32 v24, 1, v21
    v_lshl_add_u32 v2, v24, 4, v23
    v_lshrrev_b32 v23, 3, v21
    v_lshlrev_b32 v23, 7, v23
    v_lshl_add_u32 v23, v22, 5, v23
    v_and_b32 v24, 7, v21
    v_lshl_add_u32 v23, v24, 1, v23
    v_add_u32 v3, s78, v23
    v_lshlrev_b32 v23, 7, v22
    v_lshl_add_u32 v4, v24, 4, v23
    v_lshrrev_b32 v24, 2, v21
    v_lshlrev_b32 v24, 1, v24
    v_and_b32 v25, 1, v21
    v_add_u32 v24, v24, v25
    v_lshl_add_u32 v5, v24, 4, v23
    v_lshrrev_b32 v23, 1, v22
    v_lshlrev_b32 v23, 7, v23
    v_lshl_add_u32 v23, v21, 4, v23
    v_and_b32 v24, 1, v22
    v_lshl_add_u32 v23, v24, 3, v23
    s_add_u32 s49, s78, 30720
    v_add_u32 v23, s49, v23
    v_lshlrev_b32 v24, 3, v19
    v_add_u32 v24, 16384, v24
    v_cmp_gt_u32 vcc, 8, v21
    s_nop 1
    v_cndmask_b32 v6, v24, v23, vcc
    v_lshlrev_b32 v23, 4, v21
    v_lshl_add_u32 v23, v22, 2, v23
    v_add_u32 v12, s78, v23
    s_lshl_b32 s49, s45, 3
    v_add_u32 v23, s49, v22
    v_mul_u32_u24 v23, 8320, v23
    v_lshl_add_u32 v23, v21, 3, v23
    s_lshl_b32 s49, s46, 8
    s_add_u32 s49, s49, 0x100000
    v_add_u32 v7, s49, v23
    s_mov_b32 s55, 33280
    s_mul_i32 s54, s46, 8320
    s_lshl_b32 s49, s45, 6
    s_add_u32 s54, s54, s49
    s_add_u32 s54, s54, 0x100000
    s_add_u32 s56, s54, 4096
    v_lshrrev_b32 v23, 2, v20
    v_lshlrev_b32 v23, 8, v23
    v_and_b32 v24, 3, v20
    v_lshl_add_u32 v9, v24, 4, v23
    s_lshr_b32 s50, s46, 2
    s_lshl_b32 s50, s50, 10
    s_and_b32 s51, s45, 1
    s_lshl_b32 s51, s51, 9
    s_add_u32 s50, s50, s51
    s_lshr_b32 s51, s45, 1
    s_lshl_b32 s51, s51, 2
    s_add_u32 s50, s50, s51
    s_and_b32 s51, s46, 3
    s_lshl_b32 s48, s51, 6
    s_add_u32 s50, s50, s48
    s_lshl_b32 s51, s51, 1
    v_bfe_u32 v25, v20, 2, 2
    v_add_u32 v27, s51, v25
    v_lshrrev_b32 v23, 1, v24
    v_lshlrev_b32 v23, 8, v23
    v_and_b32 v26, 1, v24
    v_lshl_add_u32 v23, v26, 5, v23
    v_lshl_add_u32 v23, v25, 4, v23
    v_lshl_add_u32 v23, v22, 3, v23
    v_add_u32 v23, s50, v23
    v_and_b32 v26, 0x28, v20
    v_cmp_eq_u32 vcc, 0, v26
    v_mov_b32 v26, 0x7fffff00
    s_nop 0
    v_cndmask_b32 v8, v26, v23, vcc
    s_mov_b32 s84, 0x00f000f0
    s_mov_b32 s85, 0x00f000f0
    v_and_b32 v23, 31, v20
    v_lshlrev_b32 v23, 6, v23
    v_lshrrev_b32 v24, 5, v20
    v_lshl_add_u32 v10, v24, 24, v23
    v_and_b32 v23, 1, v20
    v_lshlrev_b32 v23, 4, v23
    v_mov_b32 v24, 0x3f80
    v_lshlrev_b32 v15, v23, v24
    s_mov_b32 s86, 0x30003
    s_mov_b32 s87, 0x30003
    s_mov_b32 s88, 0xc000c
    s_mov_b32 s89, 0xc000c
    s_mov_b32 s90, 0x300030
    s_mov_b32 s91, 0x300030
    s_mov_b32 s92, 0xc000c0
    s_mov_b32 s93, 0xc000c0
    v_bfe_u32 v23, v20, 1, 1
    v_mov_b32 v24, 0x4444
    v_mov_b32 v25, 0xeeee
    v_cmp_eq_u32 vcc, 1, v23
    s_nop 1
    v_cndmask_b32 v11, v24, v25, vcc
    s_mov_b32 s64, 0x3db504f3
    s_mov_b32 s65, 0x3db504f3
    s_mov_b32 s66, 0x3e0293ee
    s_mov_b32 s67, 0x3e0293ee
    s_lshl_b32 s50, s45, 11
    s_add_u32 s68, s50, 0
    s_add_u32 s69, s50, 8192
    s_lshl_b32 s51, s46, 13
    s_add_u32 s61, s51, s50
    s_add_u32 s61, s61, 0x1000000
    s_lshl_b32 s51, s46, 12
    s_add_u32 s62, s51, s79
    s_add_u32 s62, s62, 0x4000000
    s_lshl_b32 s50, s46, 7
    s_add_u32 s70, s50, 0x0
    s_lshl_b32 s51, s45, 2
    s_add_u32 s71, s50, s51
    s_add_u32 s71, s71, 0x1000
    v_mov_b32 v41, v27
    s_lshr_b32 s48, s45, 1
    s_lshl_b32 s48, s48, 6
    s_and_b32 s49, s45, 1
    s_lshl_b32 s49, s49, 3
    s_add_u32 s48, s48, s49
    v_lshlrev_b32 v24, 4, v22
    v_add_u32 v24, s48, v24
    v_lshlrev_b32 v24, 13, v24
    v_bfe_u32 v23, v20, 4, 1
    v_lshlrev_b32 v25, 1, v23
    v_xor_b32 v25, v25, v21
    v_lshl_add_u32 v30, v25, 4, v24
    v_bfe_u32 v25, v20, 2, 2
    v_lshl_add_u32 v30, v25, 20, v30
    v_xor_b32 v31, 0x100040, v30
    v_xor_b32 v32, 0x200080, v30
    v_xor_b32 v33, 0x3000c0, v30
    s_and_b32 s48, s45, 1
    s_lshl_b32 s48, s48, 7
    v_xor_b32 v34, s48, v0
    s_lshl_b32 s48, s45, 13
    v_add_u32 v34, s48, v34
    v_lshrrev_b32 v23, 2, v21
    v_and_b32 v24, 3, v21
    v_lshrrev_b32 v25, 1, v22
    v_lshlrev_b32 v25, 4, v25
    v_lshrrev_b32 v26, 1, v23
    v_lshl_add_u32 v25, v26, 3, v25
    v_and_b32 v27, 1, v22
    v_lshl_add_u32 v25, v27, 2, v25
    v_and_b32 v28, 1, v23
    v_add_u32 v25, v25, v28
    v_lshl_add_u32 v28, v27, 1, v28
    v_lshl_add_u32 v28, v26, 2, v28
    v_lshlrev_b32 v28, 1, v28
    v_lshrrev_b32 v26, 1, v24
    v_and_b32 v27, 1, v24
    s_lshl_b32 s48, s45, 2
    v_add_u32 v29, s48, v26
    v_xor_b32 v29, v29, v28
    v_lshlrev_b32 v29, 4, v29
    v_lshl_add_u32 v29, v27, 3, v29
    v_lshl_add_u32 v35, v25, 8, v29
    v_xor_b32 v36, 32, v35
    v_xor_b32 v29, v26, v28
    s_lshl_b32 s48, s45, 4
    v_add_u32 v29, s48, v29
    v_lshlrev_b32 v29, 4, v29
    v_lshl_add_u32 v29, v27, 3, v29
    v_lshl_add_u32 v37, v25, 10, v29
    s_mov_b32 s4, s12
    s_and_b32 s5, s13, 0xffff
    s_mov_b32 s6, 0x2000
    s_mov_b32 s7, 0x00020000
    s_lshr_b32 s50, s46, 2
    s_lshl_b32 s50, s50, 7
    s_lshr_b32 s51, s45, 1
    s_lshl_b32 s51, s51, 6
    s_add_u32 s50, s50, s51
    s_and_b32 s51, s45, 1
    s_lshl_b32 s51, s51, 4
    s_add_u32 s50, s50, s51
    v_and_b32 v40, 3, v20
    v_lshlrev_b32 v40, 2, v40
    v_and_b32 v42, 1, v22
    v_lshl_add_u32 v40, v42, 1, v40
    v_and_b32 v42, 7, v41
    v_lshl_add_u32 v40, v42, 10, v40
    buffer_load_ushort v42, v40, s[4:7], s50 offen
    buffer_load_ushort v43, v40, s[4:7], s50 offen offset:32
    s_mov_b32 s36, s18
    s_and_b32 s37, s19, 0xffff
    s_mov_b32 s38, 0x400000
    s_mov_b32 s39, 0x00020000
    s_lshl_b32 s48, s45, 13
    s_add_u32 m0, s48, 0
    s_lshl_b32 s49, s46, 8
    s_add_u32 s49, s49, 0
    v_xor_b32 v38, 0x0, v30
    buffer_load_dwordx4 v38, s[36:39], s49 offen lds
    s_lshl_b32 s48, s45, 13
    s_add_u32 m0, s48, 1024
    s_lshl_b32 s49, s46, 8
    s_add_u32 s49, s49, 8192
    v_xor_b32 v38, 0x0, v31
    buffer_load_dwordx4 v38, s[36:39], s49 offen lds
    s_lshl_b32 s48, s45, 13
    s_add_u32 m0, s48, 2048
    s_lshl_b32 s49, s46, 8
    s_add_u32 s49, s49, 16384
    v_xor_b32 v38, 0x0, v32
    buffer_load_dwordx4 v38, s[36:39], s49 offen lds
    s_lshl_b32 s48, s45, 13
    s_add_u32 m0, s48, 3072
    s_lshl_b32 s49, s46, 8
    s_add_u32 s49, s49, 24576
    v_xor_b32 v38, 0x0, v33
    buffer_load_dwordx4 v38, s[36:39], s49 offen lds
    s_lshl_b32 s48, s45, 13
    s_add_u32 m0, s48, 4096
    s_lshl_b32 s49, s46, 8
    s_add_u32 s49, s49, 32768
    v_xor_b32 v38, 0x0, v30
    buffer_load_dwordx4 v38, s[36:39], s49 offen lds
    s_lshl_b32 s48, s45, 13
    s_add_u32 m0, s48, 5120
    s_lshl_b32 s49, s46, 8
    s_add_u32 s49, s49, 40960
    v_xor_b32 v38, 0x0, v31
    buffer_load_dwordx4 v38, s[36:39], s49 offen lds
    s_lshl_b32 s48, s45, 13
    s_add_u32 m0, s48, 6144
    s_lshl_b32 s49, s46, 8
    s_add_u32 s49, s49, 49152
    v_xor_b32 v38, 0x0, v32
    buffer_load_dwordx4 v38, s[36:39], s49 offen lds
    s_lshl_b32 s48, s45, 13
    s_add_u32 m0, s48, 7168
    s_lshl_b32 s49, s46, 8
    s_add_u32 s49, s49, 57344
    v_xor_b32 v38, 0x0, v33
    buffer_load_dwordx4 v38, s[36:39], s49 offen lds
    s_lshl_b32 s48, s45, 13
    s_add_u32 m0, s48, 32768
    s_lshl_b32 s49, s46, 8
    s_add_u32 s49, s49, 0
    v_xor_b32 v38, 0x100000, v30
    buffer_load_dwordx4 v38, s[36:39], s49 offen lds
    s_lshl_b32 s48, s45, 13
    s_add_u32 m0, s48, 33792
    s_lshl_b32 s49, s46, 8
    s_add_u32 s49, s49, 8192
    v_xor_b32 v38, 0x100000, v31
    buffer_load_dwordx4 v38, s[36:39], s49 offen lds
    s_lshl_b32 s48, s45, 13
    s_add_u32 m0, s48, 34816
    s_lshl_b32 s49, s46, 8
    s_add_u32 s49, s49, 16384
    v_xor_b32 v38, 0x100000, v32
    buffer_load_dwordx4 v38, s[36:39], s49 offen lds
    s_lshl_b32 s48, s45, 13
    s_add_u32 m0, s48, 35840
    s_lshl_b32 s49, s46, 8
    s_add_u32 s49, s49, 24576
    v_xor_b32 v38, 0x100000, v33
    buffer_load_dwordx4 v38, s[36:39], s49 offen lds
    s_lshl_b32 s48, s45, 13
    s_add_u32 m0, s48, 36864
    s_lshl_b32 s49, s46, 8
    s_add_u32 s49, s49, 32768
    v_xor_b32 v38, 0x100000, v30
    buffer_load_dwordx4 v38, s[36:39], s49 offen lds
    s_lshl_b32 s48, s45, 13
    s_add_u32 m0, s48, 37888
    s_lshl_b32 s49, s46, 8
    s_add_u32 s49, s49, 40960
    v_xor_b32 v38, 0x100000, v31
    buffer_load_dwordx4 v38, s[36:39], s49 offen lds
    s_lshl_b32 s48, s45, 13
    s_add_u32 m0, s48, 38912
    s_lshl_b32 s49, s46, 8
    s_add_u32 s49, s49, 49152
    v_xor_b32 v38, 0x100000, v32
    buffer_load_dwordx4 v38, s[36:39], s49 offen lds
    s_lshl_b32 s48, s45, 13
    s_add_u32 m0, s48, 39936
    s_lshl_b32 s49, s46, 8
    s_add_u32 s49, s49, 57344
    v_xor_b32 v38, 0x100000, v33
    buffer_load_dwordx4 v38, s[36:39], s49 offen lds
    s_lshl_b32 s48, s45, 13
    s_add_u32 m0, s48, 65536
    s_lshl_b32 s49, s46, 8
    s_add_u32 s49, s49, 0
    v_xor_b32 v38, 0x200000, v30
    buffer_load_dwordx4 v38, s[36:39], s49 offen lds
    s_lshl_b32 s48, s45, 13
    s_add_u32 m0, s48, 66560
    s_lshl_b32 s49, s46, 8
    s_add_u32 s49, s49, 8192
    v_xor_b32 v38, 0x200000, v31
    buffer_load_dwordx4 v38, s[36:39], s49 offen lds
    s_lshl_b32 s48, s45, 13
    s_add_u32 m0, s48, 67584
    s_lshl_b32 s49, s46, 8
    s_add_u32 s49, s49, 16384
    v_xor_b32 v38, 0x200000, v32
    buffer_load_dwordx4 v38, s[36:39], s49 offen lds
    s_lshl_b32 s48, s45, 13
    s_add_u32 m0, s48, 68608
    s_lshl_b32 s49, s46, 8
    s_add_u32 s49, s49, 24576
    v_xor_b32 v38, 0x200000, v33
    buffer_load_dwordx4 v38, s[36:39], s49 offen lds
    s_lshl_b32 s48, s45, 13
    s_add_u32 m0, s48, 69632
    s_lshl_b32 s49, s46, 8
    s_add_u32 s49, s49, 32768
    v_xor_b32 v38, 0x200000, v30
    buffer_load_dwordx4 v38, s[36:39], s49 offen lds
    s_lshl_b32 s48, s45, 13
    s_add_u32 m0, s48, 70656
    s_lshl_b32 s49, s46, 8
    s_add_u32 s49, s49, 40960
    v_xor_b32 v38, 0x200000, v31
    buffer_load_dwordx4 v38, s[36:39], s49 offen lds
    s_lshl_b32 s48, s45, 13
    s_add_u32 m0, s48, 71680
    s_lshl_b32 s49, s46, 8
    s_add_u32 s49, s49, 49152
    v_xor_b32 v38, 0x200000, v32
    buffer_load_dwordx4 v38, s[36:39], s49 offen lds
    s_lshl_b32 s48, s45, 13
    s_add_u32 m0, s48, 72704
    s_lshl_b32 s49, s46, 8
    s_add_u32 s49, s49, 57344
    v_xor_b32 v38, 0x200000, v33
    buffer_load_dwordx4 v38, s[36:39], s49 offen lds
    s_lshl_b32 s48, s45, 13
    s_add_u32 m0, s48, 98304
    s_lshl_b32 s49, s46, 8
    s_add_u32 s49, s49, 0
    v_xor_b32 v38, 0x300000, v30
    buffer_load_dwordx4 v38, s[36:39], s49 offen lds
    s_lshl_b32 s48, s45, 13
    s_add_u32 m0, s48, 99328
    s_lshl_b32 s49, s46, 8
    s_add_u32 s49, s49, 8192
    v_xor_b32 v38, 0x300000, v31
    buffer_load_dwordx4 v38, s[36:39], s49 offen lds
    s_lshl_b32 s48, s45, 13
    s_add_u32 m0, s48, 100352
    s_lshl_b32 s49, s46, 8
    s_add_u32 s49, s49, 16384
    v_xor_b32 v38, 0x300000, v32
    buffer_load_dwordx4 v38, s[36:39], s49 offen lds
    s_lshl_b32 s48, s45, 13
    s_add_u32 m0, s48, 101376
    s_lshl_b32 s49, s46, 8
    s_add_u32 s49, s49, 24576
    v_xor_b32 v38, 0x300000, v33
    buffer_load_dwordx4 v38, s[36:39], s49 offen lds
    s_lshl_b32 s48, s45, 13
    s_add_u32 m0, s48, 102400
    s_lshl_b32 s49, s46, 8
    s_add_u32 s49, s49, 32768
    v_xor_b32 v38, 0x300000, v30
    buffer_load_dwordx4 v38, s[36:39], s49 offen lds
    s_lshl_b32 s48, s45, 13
    s_add_u32 m0, s48, 103424
    s_lshl_b32 s49, s46, 8
    s_add_u32 s49, s49, 40960
    v_xor_b32 v38, 0x300000, v31
    buffer_load_dwordx4 v38, s[36:39], s49 offen lds
    s_lshl_b32 s48, s45, 13
    s_add_u32 m0, s48, 104448
    s_lshl_b32 s49, s46, 8
    s_add_u32 s49, s49, 49152
    v_xor_b32 v38, 0x300000, v32
    buffer_load_dwordx4 v38, s[36:39], s49 offen lds
    s_lshl_b32 s48, s45, 13
    s_add_u32 m0, s48, 105472
    s_lshl_b32 s49, s46, 8
    s_add_u32 s49, s49, 57344
    v_xor_b32 v38, 0x300000, v33
    buffer_load_dwordx4 v38, s[36:39], s49 offen lds
    s_mov_b32 s40, s16
    s_and_b32 s41, s17, 0xffff
    s_mov_b32 s42, 0x400000
    s_mov_b32 s43, 0x00020000
    s_lshl_b32 s48, s45, 13
    s_add_u32 m0, s48, 131072
    s_lshl_b32 s49, s46, 8
    s_add_u32 s49, s49, 0
    v_xor_b32 v38, 0x0, v30
    buffer_load_dwordx4 v38, s[40:43], s49 offen lds
    s_lshl_b32 s48, s45, 13
    s_add_u32 m0, s48, 132096
    s_lshl_b32 s49, s46, 8
    s_add_u32 s49, s49, 8192
    v_xor_b32 v38, 0x0, v31
    buffer_load_dwordx4 v38, s[40:43], s49 offen lds
    s_lshl_b32 s48, s45, 13
    s_add_u32 m0, s48, 133120
    s_lshl_b32 s49, s46, 8
    s_add_u32 s49, s49, 16384
    v_xor_b32 v38, 0x0, v32
    buffer_load_dwordx4 v38, s[40:43], s49 offen lds
    s_lshl_b32 s48, s45, 13
    s_add_u32 m0, s48, 134144
    s_lshl_b32 s49, s46, 8
    s_add_u32 s49, s49, 24576
    v_xor_b32 v38, 0x0, v33
    buffer_load_dwordx4 v38, s[40:43], s49 offen lds
    s_lshl_b32 s48, s45, 13
    s_add_u32 m0, s48, 135168
    s_lshl_b32 s49, s46, 8
    s_add_u32 s49, s49, 32768
    v_xor_b32 v38, 0x0, v30
    buffer_load_dwordx4 v38, s[40:43], s49 offen lds
    s_lshl_b32 s48, s45, 13
    s_add_u32 m0, s48, 136192
    s_lshl_b32 s49, s46, 8
    s_add_u32 s49, s49, 40960
    v_xor_b32 v38, 0x0, v31
    buffer_load_dwordx4 v38, s[40:43], s49 offen lds
    s_lshl_b32 s48, s45, 13
    s_add_u32 m0, s48, 137216
    s_lshl_b32 s49, s46, 8
    s_add_u32 s49, s49, 49152
    v_xor_b32 v38, 0x0, v32
    buffer_load_dwordx4 v38, s[40:43], s49 offen lds
    s_lshl_b32 s48, s45, 13
    s_add_u32 m0, s48, 138240
    s_lshl_b32 s49, s46, 8
    s_add_u32 s49, s49, 57344
    v_xor_b32 v38, 0x0, v33
    buffer_load_dwordx4 v38, s[40:43], s49 offen lds
    s_waitcnt vmcnt(32)
    s_barrier
    v_add_u32 v38, 0, v35
    v_add_u32 v39, 0, v36
    ds_read_b64_tr_b16 a[192:193], v38 offset:0
    ds_read_b64_tr_b16 a[194:195], v38 offset:512
    ds_read_b64_tr_b16 a[196:197], v38 offset:8192
    ds_read_b64_tr_b16 a[198:199], v38 offset:8704
    ds_read_b64_tr_b16 v[128:129], v39 offset:0
    ds_read_b64_tr_b16 v[130:131], v39 offset:512
    ds_read_b64_tr_b16 v[132:133], v39 offset:8192
    ds_read_b64_tr_b16 v[134:135], v39 offset:8704
    ds_read_b64_tr_b16 a[200:201], v38 offset:16384
    ds_read_b64_tr_b16 a[202:203], v38 offset:16896
    ds_read_b64_tr_b16 a[204:205], v38 offset:24576
    ds_read_b64_tr_b16 a[206:207], v38 offset:25088
    ds_read_b64_tr_b16 v[136:137], v39 offset:16384
    ds_read_b64_tr_b16 v[138:139], v39 offset:16896
    ds_read_b64_tr_b16 v[140:141], v39 offset:24576
    ds_read_b64_tr_b16 v[142:143], v39 offset:25088
    s_waitcnt lgkmcnt(0)
    s_barrier
    v_mov_b32 v44, 0
    v_mov_b32 v45, 0
    v_mov_b32 v46, 0
    v_mov_b32 v47, 0
    buffer_store_dwordx4 v[44:47], v9, s[32:35], s54 offen
    buffer_store_dwordx4 v[44:47], v9, s[32:35], s56 offen
    v_mov_b32 v40, -1
    s_mov_b32 s48, 0x22000
    buffer_store_dword v40, v8, s[32:35], s48 offen
    s_mov_b32 s48, 0x24000
    buffer_store_dword v40, v8, s[32:35], s48 offen
    v_lshl_or_b32 v42, v43, 16, v42
    v_min_u32 v42, -2, v42
    s_mov_b32 s48, 0x20000
    buffer_store_dword v42, v8, s[32:35], s48 offen
    s_cmp_lg_u32 s45, 0
    s_cbranch_scc1 L_if_1
    v_and_b32 v41, 31, v20
    v_lshlrev_b32 v41, 2, v41
    v_lshrrev_b32 v43, 5, v20
    v_lshl_add_u32 v41, v43, 12, v41
    buffer_store_dword v44, v41, s[32:35], s70 offen sc1
    v_lshlrev_b32 v43, 11, v20
    s_and_b32 s48, s46, 15
    s_lshl_b32 s48, s48, 7
    s_add_u32 s48, s48, 0x2000
    s_mov_b64 exec, 15
    buffer_store_dword v44, v43, s[32:35], s48 offen sc1
    s_mov_b64 exec, -1
L_if_1:
    s_lshl_b32 s48, s45, 13
    s_add_u32 m0, s48, 0
    s_lshl_b32 s49, s46, 8
    s_add_u32 s49, s49, 0
    v_xor_b32 v38, 0x100000, v30
    buffer_load_dwordx4 v38, s[40:43], s49 offen lds
    s_lshl_b32 s48, s45, 13
    s_add_u32 m0, s48, 1024
    s_lshl_b32 s49, s46, 8
    s_add_u32 s49, s49, 8192
    v_xor_b32 v38, 0x100000, v31
    buffer_load_dwordx4 v38, s[40:43], s49 offen lds
    s_lshl_b32 s48, s45, 13
    s_add_u32 m0, s48, 2048
    s_lshl_b32 s49, s46, 8
    s_add_u32 s49, s49, 16384
    v_xor_b32 v38, 0x100000, v32
    buffer_load_dwordx4 v38, s[40:43], s49 offen lds
    s_lshl_b32 s48, s45, 13
    s_add_u32 m0, s48, 3072
    s_lshl_b32 s49, s46, 8
    s_add_u32 s49, s49, 24576
    v_xor_b32 v38, 0x100000, v33
    buffer_load_dwordx4 v38, s[40:43], s49 offen lds
    s_lshl_b32 s48, s45, 13
    s_add_u32 m0, s48, 4096
    s_lshl_b32 s49, s46, 8
    s_add_u32 s49, s49, 32768
    v_xor_b32 v38, 0x100000, v30
    buffer_load_dwordx4 v38, s[40:43], s49 offen lds
    s_lshl_b32 s48, s45, 13
    s_add_u32 m0, s48, 5120
    s_lshl_b32 s49, s46, 8
    s_add_u32 s49, s49, 40960
    v_xor_b32 v38, 0x100000, v31
    buffer_load_dwordx4 v38, s[40:43], s49 offen lds
    s_lshl_b32 s48, s45, 13
    s_add_u32 m0, s48, 6144
    s_lshl_b32 s49, s46, 8
    s_add_u32 s49, s49, 49152
    v_xor_b32 v38, 0x100000, v32
    buffer_load_dwordx4 v38, s[40:43], s49 offen lds
    s_lshl_b32 s48, s45, 13
    s_add_u32 m0, s48, 7168
    s_lshl_b32 s49, s46, 8
    s_add_u32 s49, s49, 57344
    v_xor_b32 v38, 0x100000, v33
    buffer_load_dwordx4 v38, s[40:43], s49 offen lds
    s_waitcnt vmcnt(32)
    s_barrier
    v_add_u32 v38, 32768, v35
    v_add_u32 v39, 32768, v36
    ds_read_b64_tr_b16 a[208:209], v38 offset:0
    ds_read_b64_tr_b16 a[210:211], v38 offset:512
    ds_read_b64_tr_b16 a[212:213], v38 offset:8192
    ds_read_b64_tr_b16 a[214:215], v38 offset:8704
    ds_read_b64_tr_b16 v[144:145], v39 offset:0
    ds_read_b64_tr_b16 v[146:147], v39 offset:512
    ds_read_b64_tr_b16 v[148:149], v39 offset:8192
    ds_read_b64_tr_b16 v[150:151], v39 offset:8704
    ds_read_b64_tr_b16 a[216:217], v38 offset:16384
    ds_read_b64_tr_b16 a[218:219], v38 offset:16896
    ds_read_b64_tr_b16 a[220:221], v38 offset:24576
    ds_read_b64_tr_b16 a[222:223], v38 offset:25088
    ds_read_b64_tr_b16 v[152:153], v39 offset:16384
    ds_read_b64_tr_b16 v[154:155], v39 offset:16896
    ds_read_b64_tr_b16 v[156:157], v39 offset:24576
    ds_read_b64_tr_b16 v[158:159], v39 offset:25088
    s_waitcnt lgkmcnt(0)
    s_barrier
    s_lshl_b32 s48, s45, 13
    s_add_u32 m0, s48, 32768
    s_lshl_b32 s49, s46, 8
    s_add_u32 s49, s49, 0
    v_xor_b32 v38, 0x200000, v30
    buffer_load_dwordx4 v38, s[40:43], s49 offen lds
    s_lshl_b32 s48, s45, 13
    s_add_u32 m0, s48, 33792
    s_lshl_b32 s49, s46, 8
    s_add_u32 s49, s49, 8192
    v_xor_b32 v38, 0x200000, v31
    buffer_load_dwordx4 v38, s[40:43], s49 offen lds
    s_lshl_b32 s48, s45, 13
    s_add_u32 m0, s48, 34816
    s_lshl_b32 s49, s46, 8
    s_add_u32 s49, s49, 16384
    v_xor_b32 v38, 0x200000, v32
    buffer_load_dwordx4 v38, s[40:43], s49 offen lds
    s_lshl_b32 s48, s45, 13
    s_add_u32 m0, s48, 35840
    s_lshl_b32 s49, s46, 8
    s_add_u32 s49, s49, 24576
    v_xor_b32 v38, 0x200000, v33
    buffer_load_dwordx4 v38, s[40:43], s49 offen lds
    s_lshl_b32 s48, s45, 13
    s_add_u32 m0, s48, 36864
    s_lshl_b32 s49, s46, 8
    s_add_u32 s49, s49, 32768
    v_xor_b32 v38, 0x200000, v30
    buffer_load_dwordx4 v38, s[40:43], s49 offen lds
    s_lshl_b32 s48, s45, 13
    s_add_u32 m0, s48, 37888
    s_lshl_b32 s49, s46, 8
    s_add_u32 s49, s49, 40960
    v_xor_b32 v38, 0x200000, v31
    buffer_load_dwordx4 v38, s[40:43], s49 offen lds
    s_lshl_b32 s48, s45, 13
    s_add_u32 m0, s48, 38912
    s_lshl_b32 s49, s46, 8
    s_add_u32 s49, s49, 49152
    v_xor_b32 v38, 0x200000, v32
    buffer_load_dwordx4 v38, s[40:43], s49 offen lds
    s_lshl_b32 s48, s45, 13
    s_add_u32 m0, s48, 39936
    s_lshl_b32 s49, s46, 8
    s_add_u32 s49, s49, 57344
    v_xor_b32 v38, 0x200000, v33
    buffer_load_dwordx4 v38, s[40:43], s49 offen lds
    s_waitcnt vmcnt(32)
    s_barrier
    v_add_u32 v38, 65536, v35
    v_add_u32 v39, 65536, v36
    ds_read_b64_tr_b16 a[224:225], v38 offset:0
    ds_read_b64_tr_b16 a[226:227], v38 offset:512
    ds_read_b64_tr_b16 a[228:229], v38 offset:8192
    ds_read_b64_tr_b16 a[230:231], v38 offset:8704
    ds_read_b64_tr_b16 v[160:161], v39 offset:0
    ds_read_b64_tr_b16 v[162:163], v39 offset:512
    ds_read_b64_tr_b16 v[164:165], v39 offset:8192
    ds_read_b64_tr_b16 v[166:167], v39 offset:8704
    ds_read_b64_tr_b16 a[232:233], v38 offset:16384
    ds_read_b64_tr_b16 a[234:235], v38 offset:16896
    ds_read_b64_tr_b16 a[236:237], v38 offset:24576
    ds_read_b64_tr_b16 a[238:239], v38 offset:25088
    ds_read_b64_tr_b16 v[168:169], v39 offset:16384
    ds_read_b64_tr_b16 v[170:171], v39 offset:16896
    ds_read_b64_tr_b16 v[172:173], v39 offset:24576
    ds_read_b64_tr_b16 v[174:175], v39 offset:25088
    s_waitcnt lgkmcnt(0)
    s_barrier
    s_lshl_b32 s48, s45, 13
    s_add_u32 m0, s48, 65536
    s_lshl_b32 s49, s46, 8
    s_add_u32 s49, s49, 0
    v_xor_b32 v38, 0x300000, v30
    buffer_load_dwordx4 v38, s[40:43], s49 offen lds
    s_lshl_b32 s48, s45, 13
    s_add_u32 m0, s48, 66560
    s_lshl_b32 s49, s46, 8
    s_add_u32 s49, s49, 8192
    v_xor_b32 v38, 0x300000, v31
    buffer_load_dwordx4 v38, s[40:43], s49 offen lds
    s_lshl_b32 s48, s45, 13
    s_add_u32 m0, s48, 67584
    s_lshl_b32 s49, s46, 8
    s_add_u32 s49, s49, 16384
    v_xor_b32 v38, 0x300000, v32
    buffer_load_dwordx4 v38, s[40:43], s49 offen lds
    s_lshl_b32 s48, s45, 13
    s_add_u32 m0, s48, 68608
    s_lshl_b32 s49, s46, 8
    s_add_u32 s49, s49, 24576
    v_xor_b32 v38, 0x300000, v33
    buffer_load_dwordx4 v38, s[40:43], s49 offen lds
    s_lshl_b32 s48, s45, 13
    s_add_u32 m0, s48, 69632
    s_lshl_b32 s49, s46, 8
    s_add_u32 s49, s49, 32768
    v_xor_b32 v38, 0x300000, v30
    buffer_load_dwordx4 v38, s[40:43], s49 offen lds
    s_lshl_b32 s48, s45, 13
    s_add_u32 m0, s48, 70656
    s_lshl_b32 s49, s46, 8
    s_add_u32 s49, s49, 40960
    v_xor_b32 v38, 0x300000, v31
    buffer_load_dwordx4 v38, s[40:43], s49 offen lds
    s_lshl_b32 s48, s45, 13
    s_add_u32 m0, s48, 71680
    s_lshl_b32 s49, s46, 8
    s_add_u32 s49, s49, 49152
    v_xor_b32 v38, 0x300000, v32
    buffer_load_dwordx4 v38, s[40:43], s49 offen lds
    s_lshl_b32 s48, s45, 13
    s_add_u32 m0, s48, 72704
    s_lshl_b32 s49, s46, 8
    s_add_u32 s49, s49, 57344
    v_xor_b32 v38, 0x300000, v33
    buffer_load_dwordx4 v38, s[40:43], s49 offen lds
    s_waitcnt vmcnt(32)
    s_barrier
    v_add_u32 v38, 98304, v35
    v_add_u32 v39, 98304, v36
    ds_read_b64_tr_b16 a[240:241], v38 offset:0
    ds_read_b64_tr_b16 a[242:243], v38 offset:512
    ds_read_b64_tr_b16 a[244:245], v38 offset:8192
    ds_read_b64_tr_b16 a[246:247], v38 offset:8704
    ds_read_b64_tr_b16 v[176:177], v39 offset:0
    ds_read_b64_tr_b16 v[178:179], v39 offset:512
    ds_read_b64_tr_b16 v[180:181], v39 offset:8192
    ds_read_b64_tr_b16 v[182:183], v39 offset:8704
    ds_read_b64_tr_b16 a[248:249], v38 offset:16384
    ds_read_b64_tr_b16 a[250:251], v38 offset:16896
    ds_read_b64_tr_b16 a[252:253], v38 offset:24576
    ds_read_b64_tr_b16 a[254:255], v38 offset:25088
    ds_read_b64_tr_b16 v[184:185], v39 offset:16384
    ds_read_b64_tr_b16 v[186:187], v39 offset:16896
    ds_read_b64_tr_b16 v[188:189], v39 offset:24576
    ds_read_b64_tr_b16 v[190:191], v39 offset:25088
    s_waitcnt lgkmcnt(0)
    s_barrier
    s_mov_b32 s36, s20
    s_and_b32 s37, s21, 0xffff
    s_mov_b32 s38, 0x400000
    s_mov_b32 s39, 0x00020000
    s_lshl_b32 s48, s45, 13
    s_add_u32 m0, s48, 98304
    v_xor_b32 v38, 0, v34
    s_lshl_b32 s49, s46, 17
    s_add_u32 s49, s49, 0
    buffer_load_dwordx4 v38, s[36:39], s49 offen lds
    s_lshl_b32 s48, s45, 13
    s_add_u32 m0, s48, 99328
    v_xor_b32 v38, 32, v34
    s_lshl_b32 s49, s46, 17
    s_add_u32 s49, s49, 1024
    buffer_load_dwordx4 v38, s[36:39], s49 offen lds
    s_lshl_b32 s48, s45, 13
    s_add_u32 m0, s48, 100352
    v_xor_b32 v38, 0, v34
    s_lshl_b32 s49, s46, 17
    s_add_u32 s49, s49, 2048
    buffer_load_dwordx4 v38, s[36:39], s49 offen lds
    s_lshl_b32 s48, s45, 13
    s_add_u32 m0, s48, 101376
    v_xor_b32 v38, 32, v34
    s_lshl_b32 s49, s46, 17
    s_add_u32 s49, s49, 3072
    buffer_load_dwordx4 v38, s[36:39], s49 offen lds
    s_lshl_b32 s48, s45, 13
    s_add_u32 m0, s48, 102400
    v_xor_b32 v38, 64, v34
    s_lshl_b32 s49, s46, 17
    s_add_u32 s49, s49, 4096
    buffer_load_dwordx4 v38, s[36:39], s49 offen lds
    s_lshl_b32 s48, s45, 13
    s_add_u32 m0, s48, 103424
    v_xor_b32 v38, 96, v34
    s_lshl_b32 s49, s46, 17
    s_add_u32 s49, s49, 5120
    buffer_load_dwordx4 v38, s[36:39], s49 offen lds
    s_lshl_b32 s48, s45, 13
    s_add_u32 m0, s48, 104448
    v_xor_b32 v38, 64, v34
    s_lshl_b32 s49, s46, 17
    s_add_u32 s49, s49, 6144
    buffer_load_dwordx4 v38, s[36:39], s49 offen lds
    s_lshl_b32 s48, s45, 13
    s_add_u32 m0, s48, 105472
    v_xor_b32 v38, 96, v34
    s_lshl_b32 s49, s46, 17
    s_add_u32 s49, s49, 7168
    buffer_load_dwordx4 v38, s[36:39], s49 offen lds
    s_waitcnt vmcnt(32)
    s_barrier
    v_add_u32 v38, 131072, v35
    v_add_u32 v39, 131072, v36
    ds_read_b64_tr_b16 a[64:65], v38 offset:0
    ds_read_b64_tr_b16 a[66:67], v38 offset:512
    ds_read_b64_tr_b16 a[68:69], v38 offset:8192
    ds_read_b64_tr_b16 a[70:71], v38 offset:8704
    ds_read_b64_tr_b16 a[128:129], v39 offset:0
    ds_read_b64_tr_b16 a[130:131], v39 offset:512
    ds_read_b64_tr_b16 a[132:133], v39 offset:8192
    ds_read_b64_tr_b16 a[134:135], v39 offset:8704
    ds_read_b64_tr_b16 a[72:73], v38 offset:16384
    ds_read_b64_tr_b16 a[74:75], v38 offset:16896
    ds_read_b64_tr_b16 a[76:77], v38 offset:24576
    ds_read_b64_tr_b16 a[78:79], v38 offset:25088
    ds_read_b64_tr_b16 a[136:137], v39 offset:16384
    ds_read_b64_tr_b16 a[138:139], v39 offset:16896
    ds_read_b64_tr_b16 a[140:141], v39 offset:24576
    ds_read_b64_tr_b16 a[142:143], v39 offset:25088
    s_waitcnt lgkmcnt(0)
    s_barrier
    s_lshl_b32 s48, s45, 13
    s_add_u32 m0, s48, 131072
    v_xor_b32 v38, 0, v34
    s_lshl_b32 s49, s46, 17
    s_add_u32 s49, s49, 32768
    buffer_load_dwordx4 v38, s[36:39], s49 offen lds
    s_lshl_b32 s48, s45, 13
    s_add_u32 m0, s48, 132096
    v_xor_b32 v38, 32, v34
    s_lshl_b32 s49, s46, 17
    s_add_u32 s49, s49, 33792
    buffer_load_dwordx4 v38, s[36:39], s49 offen lds
    s_lshl_b32 s48, s45, 13
    s_add_u32 m0, s48, 133120
    v_xor_b32 v38, 0, v34
    s_lshl_b32 s49, s46, 17
    s_add_u32 s49, s49, 34816
    buffer_load_dwordx4 v38, s[36:39], s49 offen lds
    s_lshl_b32 s48, s45, 13
    s_add_u32 m0, s48, 134144
    v_xor_b32 v38, 32, v34
    s_lshl_b32 s49, s46, 17
    s_add_u32 s49, s49, 35840
    buffer_load_dwordx4 v38, s[36:39], s49 offen lds
    s_lshl_b32 s48, s45, 13
    s_add_u32 m0, s48, 135168
    v_xor_b32 v38, 64, v34
    s_lshl_b32 s49, s46, 17
    s_add_u32 s49, s49, 36864
    buffer_load_dwordx4 v38, s[36:39], s49 offen lds
    s_lshl_b32 s48, s45, 13
    s_add_u32 m0, s48, 136192
    v_xor_b32 v38, 96, v34
    s_lshl_b32 s49, s46, 17
    s_add_u32 s49, s49, 37888
    buffer_load_dwordx4 v38, s[36:39], s49 offen lds
    s_lshl_b32 s48, s45, 13
    s_add_u32 m0, s48, 137216
    v_xor_b32 v38, 64, v34
    s_lshl_b32 s49, s46, 17
    s_add_u32 s49, s49, 38912
    buffer_load_dwordx4 v38, s[36:39], s49 offen lds
    s_lshl_b32 s48, s45, 13
    s_add_u32 m0, s48, 138240
    v_xor_b32 v38, 96, v34
    s_lshl_b32 s49, s46, 17
    s_add_u32 s49, s49, 39936
    buffer_load_dwordx4 v38, s[36:39], s49 offen lds
    s_waitcnt vmcnt(32)
    s_barrier
    s_cmp_lg_u32 s45, 0
    s_cbranch_scc1 L_if_2
    s_mov_b64 exec, 1
    v_mov_b32 v40, 128
    v_mov_b32 v41, 1
    global_atomic_add v40, v41, s[26:27]
    s_mov_b64 exec, -1
L_if_2:
    v_add_u32 v38, 0, v35
    v_add_u32 v39, 0, v36
    ds_read_b64_tr_b16 a[80:81], v38 offset:0
    ds_read_b64_tr_b16 a[82:83], v38 offset:512
    ds_read_b64_tr_b16 a[84:85], v38 offset:8192
    ds_read_b64_tr_b16 a[86:87], v38 offset:8704
    ds_read_b64_tr_b16 a[144:145], v39 offset:0
    ds_read_b64_tr_b16 a[146:147], v39 offset:512
    ds_read_b64_tr_b16 a[148:149], v39 offset:8192
    ds_read_b64_tr_b16 a[150:151], v39 offset:8704
    ds_read_b64_tr_b16 a[88:89], v38 offset:16384
    ds_read_b64_tr_b16 a[90:91], v38 offset:16896
    ds_read_b64_tr_b16 a[92:93], v38 offset:24576
    ds_read_b64_tr_b16 a[94:95], v38 offset:25088
    ds_read_b64_tr_b16 a[152:153], v39 offset:16384
    ds_read_b64_tr_b16 a[154:155], v39 offset:16896
    ds_read_b64_tr_b16 a[156:157], v39 offset:24576
    ds_read_b64_tr_b16 a[158:159], v39 offset:25088
    s_waitcnt lgkmcnt(0)
    s_barrier
    s_lshl_b32 s48, s45, 13
    s_add_u32 m0, s48, 0
    v_xor_b32 v38, 0, v34
    s_lshl_b32 s49, s46, 17
    s_add_u32 s49, s49, 65536
    buffer_load_dwordx4 v38, s[36:39], s49 offen lds
    s_lshl_b32 s48, s45, 13
    s_add_u32 m0, s48, 1024
    v_xor_b32 v38, 32, v34
    s_lshl_b32 s49, s46, 17
    s_add_u32 s49, s49, 66560
    buffer_load_dwordx4 v38, s[36:39], s49 offen lds
    s_lshl_b32 s48, s45, 13
    s_add_u32 m0, s48, 2048
    v_xor_b32 v38, 0, v34
    s_lshl_b32 s49, s46, 17
    s_add_u32 s49, s49, 67584
    buffer_load_dwordx4 v38, s[36:39], s49 offen lds
    s_lshl_b32 s48, s45, 13
    s_add_u32 m0, s48, 3072
    v_xor_b32 v38, 32, v34
    s_lshl_b32 s49, s46, 17
    s_add_u32 s49, s49, 68608
    buffer_load_dwordx4 v38, s[36:39], s49 offen lds
    s_lshl_b32 s48, s45, 13
    s_add_u32 m0, s48, 4096
    v_xor_b32 v38, 64, v34
    s_lshl_b32 s49, s46, 17
    s_add_u32 s49, s49, 69632
    buffer_load_dwordx4 v38, s[36:39], s49 offen lds
    s_lshl_b32 s48, s45, 13
    s_add_u32 m0, s48, 5120
    v_xor_b32 v38, 96, v34
    s_lshl_b32 s49, s46, 17
    s_add_u32 s49, s49, 70656
    buffer_load_dwordx4 v38, s[36:39], s49 offen lds
    s_lshl_b32 s48, s45, 13
    s_add_u32 m0, s48, 6144
    v_xor_b32 v38, 64, v34
    s_lshl_b32 s49, s46, 17
    s_add_u32 s49, s49, 71680
    buffer_load_dwordx4 v38, s[36:39], s49 offen lds
    s_lshl_b32 s48, s45, 13
    s_add_u32 m0, s48, 7168
    v_xor_b32 v38, 96, v34
    s_lshl_b32 s49, s46, 17
    s_add_u32 s49, s49, 72704
    buffer_load_dwordx4 v38, s[36:39], s49 offen lds
    s_waitcnt vmcnt(32)
    s_barrier
    v_add_u32 v38, 32768, v35
    v_add_u32 v39, 32768, v36
    ds_read_b64_tr_b16 a[96:97], v38 offset:0
    ds_read_b64_tr_b16 a[98:99], v38 offset:512
    ds_read_b64_tr_b16 a[100:101], v38 offset:8192
    ds_read_b64_tr_b16 a[102:103], v38 offset:8704
    ds_read_b64_tr_b16 a[160:161], v39 offset:0
    ds_read_b64_tr_b16 a[162:163], v39 offset:512
    ds_read_b64_tr_b16 a[164:165], v39 offset:8192
    ds_read_b64_tr_b16 a[166:167], v39 offset:8704
    ds_read_b64_tr_b16 a[104:105], v38 offset:16384
    ds_read_b64_tr_b16 a[106:107], v38 offset:16896
    ds_read_b64_tr_b16 a[108:109], v38 offset:24576
    ds_read_b64_tr_b16 a[110:111], v38 offset:25088
    ds_read_b64_tr_b16 a[168:169], v39 offset:16384
    ds_read_b64_tr_b16 a[170:171], v39 offset:16896
    ds_read_b64_tr_b16 a[172:173], v39 offset:24576
    ds_read_b64_tr_b16 a[174:175], v39 offset:25088
    s_waitcnt lgkmcnt(0)
    s_barrier
    s_lshl_b32 s48, s45, 13
    s_add_u32 m0, s48, 32768
    v_xor_b32 v38, 0, v34
    s_lshl_b32 s49, s46, 17
    s_add_u32 s49, s49, 98304
    buffer_load_dwordx4 v38, s[36:39], s49 offen lds
    s_lshl_b32 s48, s45, 13
    s_add_u32 m0, s48, 33792
    v_xor_b32 v38, 32, v34
    s_lshl_b32 s49, s46, 17
    s_add_u32 s49, s49, 99328
    buffer_load_dwordx4 v38, s[36:39], s49 offen lds
    s_lshl_b32 s48, s45, 13
    s_add_u32 m0, s48, 34816
    v_xor_b32 v38, 0, v34
    s_lshl_b32 s49, s46, 17
    s_add_u32 s49, s49, 100352
    buffer_load_dwordx4 v38, s[36:39], s49 offen lds
    s_lshl_b32 s48, s45, 13
    s_add_u32 m0, s48, 35840
    v_xor_b32 v38, 32, v34
    s_lshl_b32 s49, s46, 17
    s_add_u32 s49, s49, 101376
    buffer_load_dwordx4 v38, s[36:39], s49 offen lds
    s_lshl_b32 s48, s45, 13
    s_add_u32 m0, s48, 36864
    v_xor_b32 v38, 64, v34
    s_lshl_b32 s49, s46, 17
    s_add_u32 s49, s49, 102400
    buffer_load_dwordx4 v38, s[36:39], s49 offen lds
    s_lshl_b32 s48, s45, 13
    s_add_u32 m0, s48, 37888
    v_xor_b32 v38, 96, v34
    s_lshl_b32 s49, s46, 17
    s_add_u32 s49, s49, 103424
    buffer_load_dwordx4 v38, s[36:39], s49 offen lds
    s_lshl_b32 s48, s45, 13
    s_add_u32 m0, s48, 38912
    v_xor_b32 v38, 64, v34
    s_lshl_b32 s49, s46, 17
    s_add_u32 s49, s49, 104448
    buffer_load_dwordx4 v38, s[36:39], s49 offen lds
    s_lshl_b32 s48, s45, 13
    s_add_u32 m0, s48, 39936
    v_xor_b32 v38, 96, v34
    s_lshl_b32 s49, s46, 17
    s_add_u32 s49, s49, 105472
    buffer_load_dwordx4 v38, s[36:39], s49 offen lds
    s_waitcnt vmcnt(32)
    s_barrier
    v_add_u32 v38, 65536, v35
    v_add_u32 v39, 65536, v36
    ds_read_b64_tr_b16 a[112:113], v38 offset:0
    ds_read_b64_tr_b16 a[114:115], v38 offset:512
    ds_read_b64_tr_b16 a[116:117], v38 offset:8192
    ds_read_b64_tr_b16 a[118:119], v38 offset:8704
    ds_read_b64_tr_b16 a[176:177], v39 offset:0
    ds_read_b64_tr_b16 a[178:179], v39 offset:512
    ds_read_b64_tr_b16 a[180:181], v39 offset:8192
    ds_read_b64_tr_b16 a[182:183], v39 offset:8704
    ds_read_b64_tr_b16 a[120:121], v38 offset:16384
    ds_read_b64_tr_b16 a[122:123], v38 offset:16896
    ds_read_b64_tr_b16 a[124:125], v38 offset:24576
    ds_read_b64_tr_b16 a[126:127], v38 offset:25088
    ds_read_b64_tr_b16 a[184:185], v39 offset:16384
    ds_read_b64_tr_b16 a[186:187], v39 offset:16896
    ds_read_b64_tr_b16 a[188:189], v39 offset:24576
    ds_read_b64_tr_b16 a[190:191], v39 offset:25088
    s_waitcnt lgkmcnt(0)
    s_barrier
    s_waitcnt vmcnt(24)
    s_barrier
    v_xor_b32 v38, 0, v37
    v_add_u32 v38, 98304, v38
    ds_read_b64_tr_b16 v[192:193], v38 offset:0
    ds_read_b64_tr_b16 v[194:195], v38 offset:2048
    v_xor_b32 v38, 32, v37
    v_add_u32 v38, 98304, v38
    ds_read_b64_tr_b16 v[208:209], v38 offset:0
    ds_read_b64_tr_b16 v[210:211], v38 offset:2048
    v_xor_b32 v38, 64, v37
    v_add_u32 v38, 98304, v38
    ds_read_b64_tr_b16 v[224:225], v38 offset:0
    ds_read_b64_tr_b16 v[226:227], v38 offset:2048
    v_xor_b32 v38, 96, v37
    v_add_u32 v38, 98304, v38
    ds_read_b64_tr_b16 v[240:241], v38 offset:0
    ds_read_b64_tr_b16 v[242:243], v38 offset:2048
    v_xor_b32 v38, 128, v37
    v_add_u32 v38, 98304, v38
    ds_read_b64_tr_b16 v[64:65], v38 offset:0
    ds_read_b64_tr_b16 v[66:67], v38 offset:2048
    v_xor_b32 v38, 160, v37
    v_add_u32 v38, 98304, v38
    ds_read_b64_tr_b16 v[80:81], v38 offset:0
    ds_read_b64_tr_b16 v[82:83], v38 offset:2048
    v_xor_b32 v38, 192, v37
    v_add_u32 v38, 98304, v38
    ds_read_b64_tr_b16 v[96:97], v38 offset:0
    ds_read_b64_tr_b16 v[98:99], v38 offset:2048
    v_xor_b32 v38, 224, v37
    v_add_u32 v38, 98304, v38
    ds_read_b64_tr_b16 v[112:113], v38 offset:0
    ds_read_b64_tr_b16 v[114:115], v38 offset:2048
    s_waitcnt lgkmcnt(0)
    s_barrier
    buffer_load_dwordx4 v[44:47], v9, s[32:35], s54 offen sc1
    buffer_load_dwordx4 v[44:47], v9, s[32:35], s56 offen sc1
    s_add_u32 s48, s68, 0x20000
    buffer_load_dwordx4 v[44:47], v0, s[32:35], s48 offen sc1
    buffer_load_dwordx4 v[44:47], v0, s[32:35], s48 offen offset:1024 sc1
    s_add_u32 s48, s68, 0x22000
    buffer_load_dwordx4 v[44:47], v0, s[32:35], s48 offen sc1
    buffer_load_dwordx4 v[44:47], v0, s[32:35], s48 offen offset:1024 sc1
    s_add_u32 s48, s68, 0x24000
    buffer_load_dwordx4 v[44:47], v0, s[32:35], s48 offen sc1
    buffer_load_dwordx4 v[44:47], v0, s[32:35], s48 offen offset:1024 sc1
    s_mov_b32 s40, s14
    s_and_b32 s41, s15, 0xffff
    s_mov_b32 s42, 0x400000
    s_mov_b32 s43, 0x00020000
    s_lshl_b32 s48, s45, 13
    s_add_u32 m0, s48, 98304
    s_lshl_b32 s49, s46, 8
    s_add_u32 s49, s49, 0
    v_xor_b32 v38, 0x0, v30
    buffer_load_dwordx4 v38, s[40:43], s49 offen lds
    s_lshl_b32 s48, s45, 13
    s_add_u32 m0, s48, 99328
    s_lshl_b32 s49, s46, 8
    s_add_u32 s49, s49, 8192
    v_xor_b32 v38, 0x0, v31
    buffer_load_dwordx4 v38, s[40:43], s49 offen lds
    s_lshl_b32 s48, s45, 13
    s_add_u32 m0, s48, 100352
    s_lshl_b32 s49, s46, 8
    s_add_u32 s49, s49, 16384
    v_xor_b32 v38, 0x0, v32
    buffer_load_dwordx4 v38, s[40:43], s49 offen lds
    s_lshl_b32 s48, s45, 13
    s_add_u32 m0, s48, 101376
    s_lshl_b32 s49, s46, 8
    s_add_u32 s49, s49, 24576
    v_xor_b32 v38, 0x0, v33
    buffer_load_dwordx4 v38, s[40:43], s49 offen lds
    s_lshl_b32 s48, s45, 13
    s_add_u32 m0, s48, 102400
    s_lshl_b32 s49, s46, 8
    s_add_u32 s49, s49, 32768
    v_xor_b32 v38, 0x0, v30
    buffer_load_dwordx4 v38, s[40:43], s49 offen lds
    s_lshl_b32 s48, s45, 13
    s_add_u32 m0, s48, 103424
    s_lshl_b32 s49, s46, 8
    s_add_u32 s49, s49, 40960
    v_xor_b32 v38, 0x0, v31
    buffer_load_dwordx4 v38, s[40:43], s49 offen lds
    s_lshl_b32 s48, s45, 13
    s_add_u32 m0, s48, 104448
    s_lshl_b32 s49, s46, 8
    s_add_u32 s49, s49, 49152
    v_xor_b32 v38, 0x0, v32
    buffer_load_dwordx4 v38, s[40:43], s49 offen lds
    s_lshl_b32 s48, s45, 13
    s_add_u32 m0, s48, 105472
    s_lshl_b32 s49, s46, 8
    s_add_u32 s49, s49, 57344
    v_xor_b32 v38, 0x0, v33
    buffer_load_dwordx4 v38, s[40:43], s49 offen lds
    s_waitcnt vmcnt(24)
    s_barrier
    v_xor_b32 v38, 0, v37
    v_add_u32 v38, 131072, v38
    ds_read_b64_tr_b16 v[196:197], v38 offset:0
    ds_read_b64_tr_b16 v[198:199], v38 offset:2048
    v_xor_b32 v38, 32, v37
    v_add_u32 v38, 131072, v38
    ds_read_b64_tr_b16 v[212:213], v38 offset:0
    ds_read_b64_tr_b16 v[214:215], v38 offset:2048
    v_xor_b32 v38, 64, v37
    v_add_u32 v38, 131072, v38
    ds_read_b64_tr_b16 v[228:229], v38 offset:0
    ds_read_b64_tr_b16 v[230:231], v38 offset:2048
    v_xor_b32 v38, 96, v37
    v_add_u32 v38, 131072, v38
    ds_read_b64_tr_b16 v[244:245], v38 offset:0
    ds_read_b64_tr_b16 v[246:247], v38 offset:2048
    v_xor_b32 v38, 128, v37
    v_add_u32 v38, 131072, v38
    ds_read_b64_tr_b16 v[68:69], v38 offset:0
    ds_read_b64_tr_b16 v[70:71], v38 offset:2048
    v_xor_b32 v38, 160, v37
    v_add_u32 v38, 131072, v38
    ds_read_b64_tr_b16 v[84:85], v38 offset:0
    ds_read_b64_tr_b16 v[86:87], v38 offset:2048
    v_xor_b32 v38, 192, v37
    v_add_u32 v38, 131072, v38
    ds_read_b64_tr_b16 v[100:101], v38 offset:0
    ds_read_b64_tr_b16 v[102:103], v38 offset:2048
    v_xor_b32 v38, 224, v37
    v_add_u32 v38, 131072, v38
    ds_read_b64_tr_b16 v[116:117], v38 offset:0
    ds_read_b64_tr_b16 v[118:119], v38 offset:2048
    s_waitcnt lgkmcnt(0)
    s_barrier
    s_lshl_b32 s48, s45, 13
    s_add_u32 m0, s48, 131072
    s_lshl_b32 s49, s46, 8
    s_add_u32 s49, s49, 0
    v_xor_b32 v38, 0x100000, v30
    buffer_load_dwordx4 v38, s[40:43], s49 offen lds
    s_lshl_b32 s48, s45, 13
    s_add_u32 m0, s48, 132096
    s_lshl_b32 s49, s46, 8
    s_add_u32 s49, s49, 8192
    v_xor_b32 v38, 0x100000, v31
    buffer_load_dwordx4 v38, s[40:43], s49 offen lds
    s_lshl_b32 s48, s45, 13
    s_add_u32 m0, s48, 133120
    s_lshl_b32 s49, s46, 8
    s_add_u32 s49, s49, 16384
    v_xor_b32 v38, 0x100000, v32
    buffer_load_dwordx4 v38, s[40:43], s49 offen lds
    s_lshl_b32 s48, s45, 13
    s_add_u32 m0, s48, 134144
    s_lshl_b32 s49, s46, 8
    s_add_u32 s49, s49, 24576
    v_xor_b32 v38, 0x100000, v33
    buffer_load_dwordx4 v38, s[40:43], s49 offen lds
    s_lshl_b32 s48, s45, 13
    s_add_u32 m0, s48, 135168
    s_lshl_b32 s49, s46, 8
    s_add_u32 s49, s49, 32768
    v_xor_b32 v38, 0x100000, v30
    buffer_load_dwordx4 v38, s[40:43], s49 offen lds
    s_lshl_b32 s48, s45, 13
    s_add_u32 m0, s48, 136192
    s_lshl_b32 s49, s46, 8
    s_add_u32 s49, s49, 40960
    v_xor_b32 v38, 0x100000, v31
    buffer_load_dwordx4 v38, s[40:43], s49 offen lds
    s_lshl_b32 s48, s45, 13
    s_add_u32 m0, s48, 137216
    s_lshl_b32 s49, s46, 8
    s_add_u32 s49, s49, 49152
    v_xor_b32 v38, 0x100000, v32
    buffer_load_dwordx4 v38, s[40:43], s49 offen lds
    s_lshl_b32 s48, s45, 13
    s_add_u32 m0, s48, 138240
    s_lshl_b32 s49, s46, 8
    s_add_u32 s49, s49, 57344
    v_xor_b32 v38, 0x100000, v33
    buffer_load_dwordx4 v38, s[40:43], s49 offen lds
    s_waitcnt vmcnt(24)
    s_barrier
    v_xor_b32 v38, 0, v37
    v_add_u32 v38, 0, v38
    ds_read_b64_tr_b16 v[200:201], v38 offset:0
    ds_read_b64_tr_b16 v[202:203], v38 offset:2048
    v_xor_b32 v38, 32, v37
    v_add_u32 v38, 0, v38
    ds_read_b64_tr_b16 v[216:217], v38 offset:0
    ds_read_b64_tr_b16 v[218:219], v38 offset:2048
    v_xor_b32 v38, 64, v37
    v_add_u32 v38, 0, v38
    ds_read_b64_tr_b16 v[232:233], v38 offset:0
    ds_read_b64_tr_b16 v[234:235], v38 offset:2048
    v_xor_b32 v38, 96, v37
    v_add_u32 v38, 0, v38
    ds_read_b64_tr_b16 v[248:249], v38 offset:0
    ds_read_b64_tr_b16 v[250:251], v38 offset:2048
    v_xor_b32 v38, 128, v37
    v_add_u32 v38, 0, v38
    ds_read_b64_tr_b16 v[72:73], v38 offset:0
    ds_read_b64_tr_b16 v[74:75], v38 offset:2048
    v_xor_b32 v38, 160, v37
    v_add_u32 v38, 0, v38
    ds_read_b64_tr_b16 v[88:89], v38 offset:0
    ds_read_b64_tr_b16 v[90:91], v38 offset:2048
    v_xor_b32 v38, 192, v37
    v_add_u32 v38, 0, v38
    ds_read_b64_tr_b16 v[104:105], v38 offset:0
    ds_read_b64_tr_b16 v[106:107], v38 offset:2048
    v_xor_b32 v38, 224, v37
    v_add_u32 v38, 0, v38
    ds_read_b64_tr_b16 v[120:121], v38 offset:0
    ds_read_b64_tr_b16 v[122:123], v38 offset:2048
    s_waitcnt lgkmcnt(0)
    s_barrier
    s_lshl_b32 s48, s45, 13
    s_add_u32 m0, s48, 0
    s_lshl_b32 s49, s46, 8
    s_add_u32 s49, s49, 0
    v_xor_b32 v38, 0x200000, v30
    buffer_load_dwordx4 v38, s[40:43], s49 offen lds
    s_lshl_b32 s48, s45, 13
    s_add_u32 m0, s48, 1024
    s_lshl_b32 s49, s46, 8
    s_add_u32 s49, s49, 8192
    v_xor_b32 v38, 0x200000, v31
    buffer_load_dwordx4 v38, s[40:43], s49 offen lds
    s_lshl_b32 s48, s45, 13
    s_add_u32 m0, s48, 2048
    s_lshl_b32 s49, s46, 8
    s_add_u32 s49, s49, 16384
    v_xor_b32 v38, 0x200000, v32
    buffer_load_dwordx4 v38, s[40:43], s49 offen lds
    s_lshl_b32 s48, s45, 13
    s_add_u32 m0, s48, 3072
    s_lshl_b32 s49, s46, 8
    s_add_u32 s49, s49, 24576
    v_xor_b32 v38, 0x200000, v33
    buffer_load_dwordx4 v38, s[40:43], s49 offen lds
    s_lshl_b32 s48, s45, 13
    s_add_u32 m0, s48, 4096
    s_lshl_b32 s49, s46, 8
    s_add_u32 s49, s49, 32768
    v_xor_b32 v38, 0x200000, v30
    buffer_load_dwordx4 v38, s[40:43], s49 offen lds
    s_lshl_b32 s48, s45, 13
    s_add_u32 m0, s48, 5120
    s_lshl_b32 s49, s46, 8
    s_add_u32 s49, s49, 40960
    v_xor_b32 v38, 0x200000, v31
    buffer_load_dwordx4 v38, s[40:43], s49 offen lds
    s_lshl_b32 s48, s45, 13
    s_add_u32 m0, s48, 6144
    s_lshl_b32 s49, s46, 8
    s_add_u32 s49, s49, 49152
    v_xor_b32 v38, 0x200000, v32
    buffer_load_dwordx4 v38, s[40:43], s49 offen lds
    s_lshl_b32 s48, s45, 13
    s_add_u32 m0, s48, 7168
    s_lshl_b32 s49, s46, 8
    s_add_u32 s49, s49, 57344
    v_xor_b32 v38, 0x200000, v33
    buffer_load_dwordx4 v38, s[40:43], s49 offen lds
    s_waitcnt vmcnt(24)
    s_barrier
    v_xor_b32 v38, 0, v37
    v_add_u32 v38, 32768, v38
    ds_read_b64_tr_b16 v[204:205], v38 offset:0
    ds_read_b64_tr_b16 v[206:207], v38 offset:2048
    v_xor_b32 v38, 32, v37
    v_add_u32 v38, 32768, v38
    ds_read_b64_tr_b16 v[220:221], v38 offset:0
    ds_read_b64_tr_b16 v[222:223], v38 offset:2048
    v_xor_b32 v38, 64, v37
    v_add_u32 v38, 32768, v38
    ds_read_b64_tr_b16 v[236:237], v38 offset:0
    ds_read_b64_tr_b16 v[238:239], v38 offset:2048
    v_xor_b32 v38, 96, v37
    v_add_u32 v38, 32768, v38
    ds_read_b64_tr_b16 v[252:253], v38 offset:0
    ds_read_b64_tr_b16 v[254:255], v38 offset:2048
    v_xor_b32 v38, 128, v37
    v_add_u32 v38, 32768, v38
    ds_read_b64_tr_b16 v[76:77], v38 offset:0
    ds_read_b64_tr_b16 v[78:79], v38 offset:2048
    v_xor_b32 v38, 160, v37
    v_add_u32 v38, 32768, v38
    ds_read_b64_tr_b16 v[92:93], v38 offset:0
    ds_read_b64_tr_b16 v[94:95], v38 offset:2048
    v_xor_b32 v38, 192, v37
    v_add_u32 v38, 32768, v38
    ds_read_b64_tr_b16 v[108:109], v38 offset:0
    ds_read_b64_tr_b16 v[110:111], v38 offset:2048
    v_xor_b32 v38, 224, v37
    v_add_u32 v38, 32768, v38
    ds_read_b64_tr_b16 v[124:125], v38 offset:0
    ds_read_b64_tr_b16 v[126:127], v38 offset:2048
    s_waitcnt lgkmcnt(0)
    s_barrier
    s_waitcnt vmcnt(16)
    s_barrier
    v_add_u32 v38, 98304, v35
    v_add_u32 v39, 98304, v36
    ds_read_b64_tr_b16 a[0:1], v38 offset:0
    ds_read_b64_tr_b16 a[2:3], v38 offset:512
    ds_read_b64_tr_b16 a[4:5], v38 offset:8192
    ds_read_b64_tr_b16 a[6:7], v38 offset:8704
    ds_read_b64_tr_b16 v[48:49], v39 offset:0
    ds_read_b64_tr_b16 v[50:51], v39 offset:512
    ds_read_b64_tr_b16 v[52:53], v39 offset:8192
    ds_read_b64_tr_b16 v[54:55], v39 offset:8704
    ds_read_b64_tr_b16 a[8:9], v38 offset:16384
    ds_read_b64_tr_b16 a[10:11], v38 offset:16896
    ds_read_b64_tr_b16 a[12:13], v38 offset:24576
    ds_read_b64_tr_b16 a[14:15], v38 offset:25088
    ds_read_b64_tr_b16 v[56:57], v39 offset:16384
    ds_read_b64_tr_b16 v[58:59], v39 offset:16896
    ds_read_b64_tr_b16 v[60:61], v39 offset:24576
    ds_read_b64_tr_b16 v[62:63], v39 offset:25088
    s_waitcnt lgkmcnt(0)
    ds_write_b128 v1, v[48:51] offset:0
    ds_write_b128 v1, v[52:55] offset:1024
    ds_write_b128 v1, v[56:59] offset:2048
    ds_write_b128 v1, v[60:63] offset:3072
    s_waitcnt lgkmcnt(0)
    s_barrier
    s_lshl_b32 s48, s45, 13
    s_add_u32 m0, s48, 98304
    s_lshl_b32 s49, s46, 8
    s_add_u32 s49, s49, 0
    v_xor_b32 v38, 0x300000, v30
    buffer_load_dwordx4 v38, s[40:43], s49 offen lds
    s_lshl_b32 s48, s45, 13
    s_add_u32 m0, s48, 99328
    s_lshl_b32 s49, s46, 8
    s_add_u32 s49, s49, 8192
    v_xor_b32 v38, 0x300000, v31
    buffer_load_dwordx4 v38, s[40:43], s49 offen lds
    s_lshl_b32 s48, s45, 13
    s_add_u32 m0, s48, 100352
    s_lshl_b32 s49, s46, 8
    s_add_u32 s49, s49, 16384
    v_xor_b32 v38, 0x300000, v32
    buffer_load_dwordx4 v38, s[40:43], s49 offen lds
    s_lshl_b32 s48, s45, 13
    s_add_u32 m0, s48, 101376
    s_lshl_b32 s49, s46, 8
    s_add_u32 s49, s49, 24576
    v_xor_b32 v38, 0x300000, v33
    buffer_load_dwordx4 v38, s[40:43], s49 offen lds
    s_lshl_b32 s48, s45, 13
    s_add_u32 m0, s48, 102400
    s_lshl_b32 s49, s46, 8
    s_add_u32 s49, s49, 32768
    v_xor_b32 v38, 0x300000, v30
    buffer_load_dwordx4 v38, s[40:43], s49 offen lds
    s_lshl_b32 s48, s45, 13
    s_add_u32 m0, s48, 103424
    s_lshl_b32 s49, s46, 8
    s_add_u32 s49, s49, 40960
    v_xor_b32 v38, 0x300000, v31
    buffer_load_dwordx4 v38, s[40:43], s49 offen lds
    s_lshl_b32 s48, s45, 13
    s_add_u32 m0, s48, 104448
    s_lshl_b32 s49, s46, 8
    s_add_u32 s49, s49, 49152
    v_xor_b32 v38, 0x300000, v32
    buffer_load_dwordx4 v38, s[40:43], s49 offen lds
    s_lshl_b32 s48, s45, 13
    s_add_u32 m0, s48, 105472
    s_lshl_b32 s49, s46, 8
    s_add_u32 s49, s49, 57344
    v_xor_b32 v38, 0x300000, v33
    buffer_load_dwordx4 v38, s[40:43], s49 offen lds
    s_waitcnt vmcnt(16)
    s_barrier
    v_add_u32 v38, 131072, v35
    v_add_u32 v39, 131072, v36
    ds_read_b64_tr_b16 a[16:17], v38 offset:0
    ds_read_b64_tr_b16 a[18:19], v38 offset:512
    ds_read_b64_tr_b16 a[20:21], v38 offset:8192
    ds_read_b64_tr_b16 a[22:23], v38 offset:8704
    ds_read_b64_tr_b16 v[48:49], v39 offset:0
    ds_read_b64_tr_b16 v[50:51], v39 offset:512
    ds_read_b64_tr_b16 v[52:53], v39 offset:8192
    ds_read_b64_tr_b16 v[54:55], v39 offset:8704
    ds_read_b64_tr_b16 a[24:25], v38 offset:16384
    ds_read_b64_tr_b16 a[26:27], v38 offset:16896
    ds_read_b64_tr_b16 a[28:29], v38 offset:24576
    ds_read_b64_tr_b16 a[30:31], v38 offset:25088
    ds_read_b64_tr_b16 v[56:57], v39 offset:16384
    ds_read_b64_tr_b16 v[58:59], v39 offset:16896
    ds_read_b64_tr_b16 v[60:61], v39 offset:24576
    ds_read_b64_tr_b16 v[62:63], v39 offset:25088
    s_waitcnt lgkmcnt(0)
    ds_write_b128 v1, v[48:51] offset:4096
    ds_write_b128 v1, v[52:55] offset:5120
    ds_write_b128 v1, v[56:59] offset:6144
    ds_write_b128 v1, v[60:63] offset:7168
    s_waitcnt lgkmcnt(0)
    s_barrier
    s_waitcnt vmcnt(8)
    s_barrier
    v_add_u32 v38, 0, v35
    v_add_u32 v39, 0, v36
    ds_read_b64_tr_b16 a[32:33], v38 offset:0
    ds_read_b64_tr_b16 a[34:35], v38 offset:512
    ds_read_b64_tr_b16 a[36:37], v38 offset:8192
    ds_read_b64_tr_b16 a[38:39], v38 offset:8704
    ds_read_b64_tr_b16 v[48:49], v39 offset:0
    ds_read_b64_tr_b16 v[50:51], v39 offset:512
    ds_read_b64_tr_b16 v[52:53], v39 offset:8192
    ds_read_b64_tr_b16 v[54:55], v39 offset:8704
    ds_read_b64_tr_b16 a[40:41], v38 offset:16384
    ds_read_b64_tr_b16 a[42:43], v38 offset:16896
    ds_read_b64_tr_b16 a[44:45], v38 offset:24576
    ds_read_b64_tr_b16 a[46:47], v38 offset:25088
    ds_read_b64_tr_b16 v[56:57], v39 offset:16384
    ds_read_b64_tr_b16 v[58:59], v39 offset:16896
    ds_read_b64_tr_b16 v[60:61], v39 offset:24576
    ds_read_b64_tr_b16 v[62:63], v39 offset:25088
    s_waitcnt lgkmcnt(0)
    ds_write_b128 v1, v[48:51] offset:8192
    ds_write_b128 v1, v[52:55] offset:9216
    ds_write_b128 v1, v[56:59] offset:10240
    ds_write_b128 v1, v[60:63] offset:11264
    s_waitcnt lgkmcnt(0)
    s_barrier
    s_waitcnt vmcnt(0)
    s_barrier
    v_add_u32 v38, 98304, v35
    v_add_u32 v39, 98304, v36
    ds_read_b64_tr_b16 a[48:49], v38 offset:0
    ds_read_b64_tr_b16 a[50:51], v38 offset:512
    ds_read_b64_tr_b16 a[52:53], v38 offset:8192
    ds_read_b64_tr_b16 a[54:55], v38 offset:8704
    ds_read_b64_tr_b16 v[48:49], v39 offset:0
    ds_read_b64_tr_b16 v[50:51], v39 offset:512
    ds_read_b64_tr_b16 v[52:53], v39 offset:8192
    ds_read_b64_tr_b16 v[54:55], v39 offset:8704
    ds_read_b64_tr_b16 a[56:57], v38 offset:16384
    ds_read_b64_tr_b16 a[58:59], v38 offset:16896
    ds_read_b64_tr_b16 a[60:61], v38 offset:24576
    ds_read_b64_tr_b16 a[62:63], v38 offset:25088
    ds_read_b64_tr_b16 v[56:57], v39 offset:16384
    ds_read_b64_tr_b16 v[58:59], v39 offset:16896
    ds_read_b64_tr_b16 v[60:61], v39 offset:24576
    ds_read_b64_tr_b16 v[62:63], v39 offset:25088
    s_waitcnt lgkmcnt(0)
    ds_write_b128 v1, v[48:51] offset:12288
    ds_write_b128 v1, v[52:55] offset:13312
    ds_write_b128 v1, v[56:59] offset:14336
    ds_write_b128 v1, v[60:63] offset:15360
    s_waitcnt lgkmcnt(0)
    s_barrier
    v_add_u32 v38, 65536, v1
    ds_write_b128 v38, v[64:67] offset:0
    ds_write_b128 v38, v[68:71] offset:1024
    ds_write_b128 v38, v[72:75] offset:2048
    ds_write_b128 v38, v[76:79] offset:3072
    ds_write_b128 v38, v[80:83] offset:4096
    ds_write_b128 v38, v[84:87] offset:5120
    ds_write_b128 v38, v[88:91] offset:6144
    ds_write_b128 v38, v[92:95] offset:7168
    ds_write_b128 v38, v[96:99] offset:8192
    ds_write_b128 v38, v[100:103] offset:9216
    ds_write_b128 v38, v[104:107] offset:10240
    ds_write_b128 v38, v[108:111] offset:11264
    ds_write_b128 v38, v[112:115] offset:12288
    ds_write_b128 v38, v[116:119] offset:13312
    ds_write_b128 v38, v[120:123] offset:14336
    ds_write_b128 v38, v[124:127] offset:15360
    s_waitcnt lgkmcnt(0)
    v_add_u32 v14, 65536, v1
    s_mov_b32 s52, 0
    s_mov_b32 s53, 1
    s_mov_b32 s58, 0x20000
    s_mov_b32 s59, 0x22000
    s_mov_b32 s60, 0x24000
    v_mov_b32 v120, 128
L_spin_3:
    s_add_u32 s101, s101, 1
    s_cmp_gt_u32 s101, 0x200000
    s_cbranch_scc1 L_exit
    global_load_dword v121, v120, s[26:27] sc1
    s_waitcnt vmcnt(0)
    v_readfirstlane_b32 s48, v121
    s_nop 2
    s_cmp_lt_u32 s48, 32
    s_cbranch_scc1 L_spin_3
    v_mov_b32 v40, 0
L_f1_4:
    s_add_u32 s101, s101, 1
    s_cmp_gt_u32 s101, 0x200000
    s_cbranch_scc1 L_exit
    buffer_load_dword v13, v40, s[32:35], s70 offen sc1
    s_waitcnt vmcnt(0)
    v_readfirstlane_b32 s49, v13
    s_nop 2
    s_cmp_lt_u32 s49, 3
    s_cbranch_scc1 L_f1_4
    s_barrier
    s_mov_b32 m0, s68
    s_add_u32 s48, s61, 0x1000000
    buffer_load_dwordx4 v0, s[32:35], s61 offen sc1 lds
    buffer_load_dwordx4 v0, s[32:35], s61 offen offset:1024 sc1 lds
    s_mov_b32 m0, s69
    s_add_u32 s61, s61, 0x40000
    buffer_load_dwordx4 v0, s[32:35], s48 offen sc1 lds
    buffer_load_dwordx4 v0, s[32:35], s48 offen offset:1024 sc1 lds
    v_mov_b32 v13, 3
    ds_read_b128 v[72:75], v1 offset:0
    ds_read_b128 v[76:79], v1 offset:1024
    ds_read_b128 v[80:83], v1 offset:2048
    ds_read_b128 v[84:87], v1 offset:3072
    ds_read_b128 v[88:91], v1 offset:4096
    ds_read_b128 v[92:95], v1 offset:5120
    ds_read_b128 v[96:99], v1 offset:6144
    ds_read_b128 v[100:103], v1 offset:7168
    ds_read_b128 v[104:107], v1 offset:8192
    ds_read_b128 v[108:111], v1 offset:9216
    ds_read_b128 v[112:115], v1 offset:10240
    ds_read_b128 v[116:119], v1 offset:11264
    s_branch L_hop2
L_step:
    ds_write_b128 v20, v[120:123] offset:16384
    ds_write_b128 v20, v[124:127] offset:17408
    v_smfmac_f32_16x16x64_bf16 v[48:51], v[120:123], a[0:7], v11
    v_smfmac_f32_16x16x64_bf16 v[52:55], v[120:123], v[72:79], v11
    v_smfmac_f32_16x16x64_bf16 v[48:51], v[124:127], a[8:15], v11
    v_smfmac_f32_16x16x64_bf16 v[52:55], v[124:127], v[80:87], v11
    v_smfmac_f32_16x16x64_bf16 v[56:59], v[120:123], a[64:71], v11
    ds_read_b128 v[72:75], v1 offset:12288
    v_smfmac_f32_16x16x64_bf16 v[60:63], v[120:123], a[128:135], v11
    s_waitcnt lgkmcnt(1)
    s_barrier
    v_smfmac_f32_16x16x64_bf16 v[64:67], v[120:123], a[192:199], v11
    ds_read_b128 v[24:27], v21 offset:16384
    v_smfmac_f32_16x16x64_bf16 v[68:71], v[120:123], v[128:135], v11
    ds_read_b128 v[28:31], v21 offset:17408
    v_smfmac_f32_16x16x64_bf16 v[56:59], v[124:127], a[72:79], v11
    ds_read_b128 v[32:35], v22 offset:16384
    v_smfmac_f32_16x16x64_bf16 v[60:63], v[124:127], a[136:143], v11
    ds_read_b128 v[36:39], v22 offset:17408
    v_smfmac_f32_16x16x64_bf16 v[64:67], v[124:127], a[200:207], v11
    ds_read_b128 v[40:43], v23 offset:16384
    v_smfmac_f32_16x16x64_bf16 v[68:71], v[124:127], v[136:143], v11
    ds_read_b128 v[44:47], v23 offset:17408
    ds_read_b128 v[76:79], v1 offset:13312
    ds_read_b128 v[80:83], v1 offset:14336
    s_waitcnt lgkmcnt(7)
    v_smfmac_f32_16x16x64_bf16 v[48:51], v[24:27], a[16:23], v11
    ds_read_b128 v[84:87], v1 offset:15360
    v_smfmac_f32_16x16x64_bf16 v[52:55], v[24:27], v[88:95], v11
    ds_read_b128 v[88:91], v0 offset:0
    s_waitcnt lgkmcnt(8)
    v_smfmac_f32_16x16x64_bf16 v[48:51], v[28:31], a[24:31], v11
    s_waitcnt vmcnt(0)
    ds_read_b128 v[120:123], v16 offset:26624
    v_smfmac_f32_16x16x64_bf16 v[52:55], v[28:31], v[96:103], v11
    ds_read_b128 v[96:99], v0 offset:2048
    s_waitcnt lgkmcnt(9)
    v_smfmac_f32_16x16x64_bf16 v[48:51], v[32:35], a[32:39], v11
    buffer_store_dword v17, v8, s[32:35], s60 offen
    v_smfmac_f32_16x16x64_bf16 v[52:55], v[32:35], v[104:111], v11
    ds_read_b128 v[104:107], v0 offset:4096
    s_waitcnt lgkmcnt(9)
    v_smfmac_f32_16x16x64_bf16 v[48:51], v[36:39], a[40:47], v11
    buffer_load_dword v13, v10, s[32:35], s94 offen sc1
    v_smfmac_f32_16x16x64_bf16 v[52:55], v[36:39], v[112:119], v11
    ds_read_b128 v[112:115], v0 offset:6144
    s_waitcnt lgkmcnt(9)
    v_smfmac_f32_16x16x64_bf16 v[48:51], v[40:43], a[48:55], v11
    buffer_load_dword v13, v18, s[32:35], s95 offen sc1
    s_waitcnt lgkmcnt(7)
    v_smfmac_f32_16x16x64_bf16 v[52:55], v[40:43], v[72:79], v11
    s_waitcnt lgkmcnt(3)
    buffer_store_dwordx4 v[120:123], v0, s[32:35], s96 offen sc1
    v_smfmac_f32_16x16x64_bf16 v[48:51], v[44:47], a[56:63], v11
    buffer_store_dword v19, v18, s[32:35], s71 offen sc1
    v_smfmac_f32_16x16x64_bf16 v[52:55], v[44:47], v[80:87], v11
    v_smfmac_f32_16x16x64_bf16 v[56:59], v[24:27], a[80:87], v11
    ds_read_b128 v[92:95], v0 offset:1024
    s_nop 0
    v_smfmac_f32_16x16x64_bf16 v[60:63], v[24:27], a[144:151], v11
    ds_read_b128 v[100:103], v0 offset:3072
    s_nop 1
    v_smfmac_f32_16x16x64_bf16 v[56:59], v[28:31], a[88:95], v11
    v_add_f32 v48, v48, v50
    v_add_f32 v49, v49, v51
    v_cvt_pk_bf16_f32 v48, v48, v49
    v_smfmac_f32_16x16x64_bf16 v[60:63], v[28:31], a[152:159], v11
    ds_write_b16 v3, v48 offset:24576
    ds_write_b16_d16_hi v3, v48 offset:24592
    v_smfmac_f32_16x16x64_bf16 v[56:59], v[32:35], a[96:103], v11
    v_add_f32 v52, v52, v54
    v_add_f32 v53, v53, v55
    v_cvt_pk_bf16_f32 v52, v52, v53
    v_smfmac_f32_16x16x64_bf16 v[60:63], v[32:35], a[160:167], v11
    ds_write_b16 v3, v52 offset:24832
    ds_write_b16_d16_hi v3, v52 offset:24848
    v_smfmac_f32_16x16x64_bf16 v[56:59], v[36:39], a[104:111], v11
    ds_read_b128 v[108:111], v0 offset:5120
    v_smfmac_f32_16x16x64_bf16 v[60:63], v[36:39], a[168:175], v11
    ds_read_b128 v[116:119], v0 offset:7168
    s_waitcnt lgkmcnt(2)
    s_barrier
    v_smfmac_f32_16x16x64_bf16 v[56:59], v[40:43], a[112:119], v11
    ds_read_b128 v[48:51], v4 offset:24576
    ds_read_b128 v[52:55], v4 offset:25088
    v_smfmac_f32_16x16x64_bf16 v[60:63], v[40:43], a[176:183], v11
    ds_read_b128 v[120:123], v4 offset:25600
    ds_read_b128 v[124:127], v4 offset:26112
    v_smfmac_f32_16x16x64_bf16 v[56:59], v[44:47], a[120:127], v11
    v_smfmac_f32_16x16x64_bf16 v[60:63], v[44:47], a[184:191], v11
    s_waitcnt lgkmcnt(3)
    v_mfma_f32_16x16x32_bf16 v[72:75], v[88:91], v[48:51], 0
    s_waitcnt lgkmcnt(2)
    v_mfma_f32_16x16x32_bf16 v[72:75], v[92:95], v[52:55], v[72:75]
    s_nop 3
    s_waitcnt lgkmcnt(1)
    v_mfma_f32_16x16x32_bf16 v[72:75], v[96:99], v[120:123], v[72:75]
    v_add_f32 v56, v56, v58
    v_add_f32 v57, v57, v59
    v_cvt_pk_bf16_f32 v56, v56, v57
    s_waitcnt lgkmcnt(0)
    v_mfma_f32_16x16x32_bf16 v[72:75], v[100:103], v[124:127], v[72:75]
    ds_write_b16 v3, v56 offset:26624
    ds_write_b16_d16_hi v3, v56 offset:26640
    v_mfma_f32_16x16x32_bf16 v[76:79], v[104:107], v[48:51], 0
    v_add_f32 v60, v60, v62
    v_add_f32 v61, v61, v63
    v_cvt_pk_bf16_f32 v60, v60, v61
    v_mfma_f32_16x16x32_bf16 v[76:79], v[108:111], v[52:55], v[76:79]
    ds_write_b16 v3, v60 offset:26880
    ds_write_b16_d16_hi v3, v60 offset:26896
    v_mfma_f32_16x16x32_bf16 v[76:79], v[112:115], v[120:123], v[76:79]
    v_mfma_f32_16x16x32_bf16 v[76:79], v[116:119], v[124:127], v[76:79]
    v_smfmac_f32_16x16x64_bf16 v[64:67], v[24:27], a[208:215], v11
    v_smfmac_f32_16x16x64_bf16 v[68:71], v[24:27], v[144:151], v11
    s_waitcnt lgkmcnt(0)
    s_barrier
    ds_read_b128 v[88:91], v5 offset:26624
    ds_read_b128 v[92:95], v5 offset:27136
    ds_read_b128 v[96:99], v5 offset:27648
    ds_read_b128 v[100:103], v5 offset:28160
    v_smfmac_f32_16x16x64_bf16 v[64:67], v[28:31], a[216:223], v11
    v_add_u32 v56, s69, v0
    ds_read_b128 v[104:107], v56
    ds_read_b128 v[108:111], v56 offset:1024
    v_smfmac_f32_16x16x64_bf16 v[68:71], v[28:31], v[152:159], v11
    s_mov_b32 m0, s68
    v_max3_f32 v84, v72, v73, v74
    buffer_load_dwordx4 v0, s[32:35], s94 offen sc1 lds
    v_max3_f32 v85, v75, v76, v77
    v_smfmac_f32_16x16x64_bf16 v[64:67], v[32:35], a[224:231], v11
    buffer_load_dwordx4 v0, s[32:35], s94 offen offset:1024 sc1 lds
    v_max3_f32 v84, v84, v78, v79
    v_max_f32 v84, v84, v85
    v_smfmac_f32_16x16x64_bf16 v[68:71], v[32:35], v[160:167], v11
    ds_read_b128 v[112:115], v14 offset:0
    ds_read_b128 v[116:119], v14 offset:1024
    v_mov_b32 v56, 0x3f803f80
    v_mov_b32 v57, 0x3f803f80
    v_mov_b64 v[58:59], v[56:57]
    s_waitcnt lgkmcnt(7)
    v_mfma_f32_16x16x32_bf16 v[80:83], v[88:91], v[48:51], 0
    s_waitcnt lgkmcnt(6)
    v_mfma_f32_16x16x32_bf16 v[80:83], v[92:95], v[52:55], v[80:83]
    s_waitcnt lgkmcnt(5)
    v_mfma_f32_16x16x32_bf16 v[80:83], v[96:99], v[120:123], v[80:83]
    s_waitcnt lgkmcnt(4)
    v_mfma_f32_16x16x32_bf16 v[80:83], v[100:103], v[124:127], v[80:83]
    v_smfmac_f32_16x16x64_bf16 v[64:67], v[36:39], a[232:239], v11
    ds_read_b128 v[88:91], v14 offset:2048
    ds_read_b128 v[92:95], v14 offset:3072
    v_smfmac_f32_16x16x64_bf16 v[68:71], v[36:39], v[168:175], v11
    ds_read_b128 v[96:99], v14 offset:4096
    ds_read_b128 v[100:103], v14 offset:5120
    v_smfmac_f32_16x16x64_bf16 v[64:67], v[40:43], a[240:247], v11
    s_nop 0
    s_waitcnt lgkmcnt(6)
    s_mov_b32 m0, s69
    s_add_u32 s48, s94, 0x1000000
    v_max3_f32 v84, v84, v80, v81
    v_mov_b32 v85, v84
    v_smfmac_f32_16x16x64_bf16 v[68:71], v[40:43], v[176:183], v11
    buffer_load_dwordx4 v0, s[32:35], s48 offen offset:0 sc1 lds
    v_permlane16_swap_b32 v85, v84
    s_nop 0
    v_max_f32 v84, v84, v85
    v_mov_b32 v85, v84
    v_smfmac_f32_16x16x64_bf16 v[64:67], v[44:47], a[248:255], v11
    buffer_load_dwordx4 v0, s[32:35], s48 offen offset:1024 sc1 lds
    v_permlane32_swap_b32 v85, v84
    s_nop 0
    v_max_f32 v84, v84, v85
    v_mul_f32 v84, s66, v84
    v_mov_b32 v85, v84
    v_pk_fma_f32 v[72:73], v[72:73], s[66:67], v[84:85] neg_lo:[0,0,1] neg_hi:[0,0,1]
    v_pk_fma_f32 v[74:75], v[74:75], s[66:67], v[84:85] neg_lo:[0,0,1] neg_hi:[0,0,1]
    v_smfmac_f32_16x16x64_bf16 v[68:71], v[44:47], v[184:191], v11
    v_pk_fma_f32 v[76:77], v[76:77], s[66:67], v[84:85] neg_lo:[0,0,1] neg_hi:[0,0,1]
    v_pk_fma_f32 v[78:79], v[78:79], s[66:67], v[84:85] neg_lo:[0,0,1] neg_hi:[0,0,1]
    v_pk_fma_f32 v[80:81], v[80:81], s[66:67], v[84:85] neg_lo:[0,0,1] neg_hi:[0,0,1]
    v_exp_f32 v72, v72
    v_exp_f32 v73, v73
    v_exp_f32 v74, v74
    v_exp_f32 v75, v75
    v_exp_f32 v76, v76
    v_exp_f32 v77, v77
    v_exp_f32 v78, v78
    v_exp_f32 v79, v79
    v_exp_f32 v80, v80
    v_exp_f32 v81, v81
    v_cvt_pk_bf16_f32 v20, v72, v73
    v_cvt_pk_bf16_f32 v21, v74, v75
    v_cvt_pk_bf16_f32 v22, v76, v77
    v_cvt_pk_bf16_f32 v23, v78, v79
    v_cvt_pk_bf16_f32 v24, v80, v81
    v_mov_b32 v25, 0
    v_mfma_f32_16x16x32_bf16 v[60:63], v[56:59], v[20:23], 0
    v_pk_add_f32 v[64:65], v[64:65], v[66:67]
    v_mfma_f32_16x16x16_bf16 v[60:63], v[56:57], v[24:25], v[60:63]
    v_pk_add_f32 v[68:69], v[68:69], v[70:71]
    v_mfma_f32_16x16x32_bf16 v[28:31], v[104:107], v[20:23], 0
    v_cvt_pk_bf16_f32 v16, v64, v65
    v_cvt_pk_bf16_f32 v18, v68, v69
    v_mfma_f32_16x16x32_bf16 v[32:35], v[108:111], v[20:23], 0
    v_mov_b32 v17, 0
    v_mov_b32 v19, 0
    ds_write_b32 v12, v16 offset:28672
    v_rcp_f32 v26, v60
    v_mfma_f32_16x16x16_bf16 v[28:31], v[16:17], v[24:25], v[28:31]
    v_mfma_f32_16x16x16_bf16 v[32:35], v[18:19], v[24:25], v[32:35]
    ds_write_b32 v12, v18 offset:28928
    s_cmp_eq_u32 s52, 63
    s_cbranch_scc1 L_chain_done
    v_mov_b32 v27, v26
    v_mov_b64 v[48:49], 0
    v_mov_b64 v[50:51], 0
    v_mov_b64 v[52:53], 0
    v_mov_b64 v[54:55], 0
    v_pk_mul_f32 v[28:29], v[28:29], v[26:27]
    v_pk_mul_f32 v[30:31], v[30:31], v[26:27]
    v_pk_mul_f32 v[32:33], v[32:33], v[26:27]
    v_pk_mul_f32 v[34:35], v[34:35], v[26:27]
    v_cvt_pk_bf16_f32 v20, v28, v29
    v_cvt_pk_bf16_f32 v21, v30, v31
    v_cvt_pk_bf16_f32 v22, v32, v33
    v_cvt_pk_bf16_f32 v23, v34, v35
    ds_write_b64 v6, v[20:21]
    ds_write_b64 v6, v[22:23] offset:256
    ds_read_b128 v[120:123], v14 offset:6144
    ds_read_b128 v[124:127], v14 offset:7168
    ds_read_b128 v[72:75], v14 offset:8192
    ds_read_b128 v[76:79], v14 offset:9216
    v_mov_b64 v[56:57], 0
    v_mov_b64 v[58:59], 0
    v_mov_b64 v[60:61], 0
    v_mov_b64 v[62:63], 0
    v_mov_b64 v[64:65], 0
    v_mov_b64 v[66:67], 0
    s_waitcnt lgkmcnt(4)
    s_barrier
    ds_read_b128 v[24:27], v2 offset:30720
    ds_read_b128 v[28:31], v2 offset:31744
    v_mov_b64 v[68:69], 0
    v_mov_b64 v[70:71], 0
    v_mov_b64 v[40:41], 0
    v_mov_b64 v[42:43], 0
    v_mov_b64 v[44:45], 0
    v_mov_b64 v[46:47], 0
    s_waitcnt lgkmcnt(1)
    v_smfmac_f32_16x16x64_bf16 v[48:51], v[24:27], v[192:199], v11
    ds_read_b128 v[80:83], v14 offset:10240
    v_smfmac_f32_16x16x64_bf16 v[52:55], v[24:27], v[208:215], v11
    ds_read_b128 v[84:87], v14 offset:11264
    s_waitcnt lgkmcnt(2)
    v_smfmac_f32_16x16x64_bf16 v[48:51], v[28:31], v[200:207], v11
    ds_read_b128 v[104:107], v14 offset:12288
    v_smfmac_f32_16x16x64_bf16 v[52:55], v[28:31], v[216:223], v11
    ds_read_b128 v[108:111], v14 offset:13312
    v_smfmac_f32_16x16x64_bf16 v[56:59], v[24:27], v[224:231], v11
    ds_read_b128 v[32:35], v14 offset:14336
    v_smfmac_f32_16x16x64_bf16 v[60:63], v[24:27], v[240:247], v11
    ds_read_b128 v[36:39], v14 offset:15360
    v_smfmac_f32_16x16x64_bf16 v[56:59], v[28:31], v[232:239], v11
    v_smfmac_f32_16x16x64_bf16 v[60:63], v[28:31], v[248:255], v11
    v_smfmac_f32_16x16x64_bf16 v[64:67], v[24:27], v[112:119], v11
    v_add_f32 v48, v48, v50
    v_add_f32 v49, v49, v51
    v_cvt_pk_bf16_f32 v16, v48, v49
    v_smfmac_f32_16x16x64_bf16 v[68:71], v[24:27], v[96:103], v11
    v_bfi_b32 v16, 1, s53, v16
    v_add_f32 v52, v52, v54
    v_add_f32 v53, v53, v55
    v_smfmac_f32_16x16x64_bf16 v[64:67], v[28:31], v[88:95], v11
    v_cvt_pk_bf16_f32 v17, v52, v53
    buffer_store_dwordx2 v[16:17], v7, s[32:35], 0 offen offset:0
    v_add_f32 v56, v56, v58
    v_smfmac_f32_16x16x64_bf16 v[68:71], v[28:31], v[120:127], v11
    v_add_f32 v57, v57, v59
    v_cvt_pk_bf16_f32 v18, v56, v57
    v_bfi_b32 v18, 1, s53, v18
    v_smfmac_f32_16x16x64_bf16 v[40:43], v[24:27], v[72:79], v11
    v_add_f32 v60, v60, v62
    v_add_f32 v61, v61, v63
    v_cvt_pk_bf16_f32 v19, v60, v61
    s_waitcnt lgkmcnt(2)
    v_smfmac_f32_16x16x64_bf16 v[44:47], v[24:27], v[104:111], v11
    buffer_store_dwordx2 v[18:19], v7, s[32:35], 0 offen offset:128
    v_add_f32 v64, v64, v66
    v_add_f32 v65, v65, v67
    v_smfmac_f32_16x16x64_bf16 v[40:43], v[28:31], v[80:87], v11
    v_cvt_pk_bf16_f32 v20, v64, v65
    v_bfi_b32 v20, 1, s53, v20
    v_add_f32 v68, v68, v70
    s_waitcnt lgkmcnt(0)
    v_smfmac_f32_16x16x64_bf16 v[44:47], v[28:31], v[32:39], v11
    v_add_f32 v69, v69, v71
    v_cvt_pk_bf16_f32 v21, v68, v69
    buffer_store_dwordx2 v[20:21], v7, s[32:35], s55 offen offset:0
    s_nop 4
    v_add_f32 v40, v40, v42
    v_add_f32 v41, v41, v43
    v_cvt_pk_bf16_f32 v22, v40, v41
    v_bfi_b32 v22, 1, s53, v22
    v_add_f32 v44, v44, v46
    v_add_f32 v45, v45, v47
    v_cvt_pk_bf16_f32 v23, v44, v45
    buffer_store_dwordx2 v[22:23], v7, s[32:35], s55 offen offset:128
    s_add_u32 s61, s61, 0x40000
    v_mov_b32 v32, s53
    v_cndmask_b32 v24, 0, v15, s[86:87]
    v_cndmask_b32 v25, 0, v15, s[88:89]
    v_cndmask_b32 v26, 0, v15, s[90:91]
    v_cndmask_b32 v27, 0, v15, s[92:93]
    ds_read_b128 v[72:75], v1 offset:0
    ds_read_b128 v[76:79], v1 offset:1024
    ds_read_b128 v[80:83], v1 offset:2048
    ds_read_b128 v[84:87], v1 offset:3072
    ds_read_b128 v[88:91], v1 offset:4096
    ds_read_b128 v[92:95], v1 offset:5120
    s_waitcnt vmcnt(0)
    buffer_load_dwordx4 v[120:123], v9, s[32:35], s54 offen sc1
    buffer_load_dwordx4 v[124:127], v9, s[32:35], s56 offen sc1
    s_waitcnt vmcnt(0)
    v_bitop3_b32 v33, v120, v124, v32 bitop3:0x7e
    v_bitop3_b32 v34, v122, v126, v32 bitop3:0x7e
    v_bitop3_b32 v33, v33, v34, 1 bitop3:0xa8
    v_cmp_ne_u32 vcc, 0, v33
    s_cbranch_vccz L_p1d_6
    s_mov_b64 exec, vcc
L_p1_5:
    buffer_load_dwordx4 v[120:123], v9, s[32:35], s54 offen sc1
    buffer_load_dwordx4 v[124:127], v9, s[32:35], s56 offen sc1
    s_mov_b64 exec, -1
    s_add_u32 s101, s101, 1
    s_cmp_gt_u32 s101, 0x200000
    s_cbranch_scc1 L_exit
    s_waitcnt vmcnt(0)
    v_bitop3_b32 v33, v120, v124, v32 bitop3:0x7e
    v_bitop3_b32 v34, v122, v126, v32 bitop3:0x7e
    v_bitop3_b32 v33, v33, v34, 1 bitop3:0xa8
    v_cmp_ne_u32 vcc, 0, v33
    s_cbranch_vccz L_p1d_6
    s_mov_b64 exec, vcc
    s_branch L_p1_5
L_p1d_6:
    v_mfma_f32_16x16x32_bf16 v[28:31], v[24:27], v[120:123], 0
    v_mfma_f32_16x16x32_bf16 v[28:31], v[24:27], v[124:127], v[28:31]
    s_add_u32 s52, s52, 1
    s_mov_b32 s48, s58
    s_mov_b32 s58, s59
    s_mov_b32 s59, s60
    s_mov_b32 s60, s48
    s_xor_b32 s53, s53, 1
    s_nop 1
    v_add_f32_dpp v28, v28, v28 row_ror:4 row_mask:0xf bank_mask:0xf
    v_add_f32_dpp v29, v29, v29 row_ror:4 row_mask:0xf bank_mask:0xf
    v_add_f32_dpp v30, v30, v30 row_ror:4 row_mask:0xf bank_mask:0xf
    v_add_f32_dpp v31, v31, v31 row_ror:4 row_mask:0xf bank_mask:0xf
    v_add_f32_dpp v28, v28, v28 row_ror:8 row_mask:0xf bank_mask:0xf
    v_add_f32_dpp v29, v29, v29 row_ror:8 row_mask:0xf bank_mask:0xf
    v_add_f32_dpp v30, v30, v30 row_ror:8 row_mask:0xf bank_mask:0xf
    v_add_f32_dpp v31, v31, v31 row_ror:8 row_mask:0xf bank_mask:0xf
    v_cvt_pk_bf16_f32 v28, v28, v30
    v_cvt_pk_bf16_f32 v29, v29, v31
    v_cndmask_b32 v28, v28, v29, s[84:85]
    v_min_u32 v28, -2, v28
    buffer_store_dword v28, v8, s[32:35], s58 offen
L_hop2:
    s_lshl_b32 s51, s45, 11
    s_add_u32 s51, s51, s58
    ds_read_b128 v[96:99], v1 offset:6144
    ds_read_b128 v[100:103], v1 offset:7168
    ds_read_b128 v[104:107], v1 offset:8192
    ds_read_b128 v[108:111], v1 offset:9216
    ds_read_b128 v[112:115], v1 offset:10240
    ds_read_b128 v[116:119], v1 offset:11264
    v_mov_b64 v[48:49], 0
    v_mov_b64 v[50:51], 0
    v_mov_b64 v[52:53], 0
    v_mov_b64 v[54:55], 0
    v_mov_b64 v[56:57], 0
    v_mov_b64 v[58:59], 0
    v_mov_b64 v[60:61], 0
    v_mov_b64 v[62:63], 0
    v_mov_b64 v[64:65], 0
    v_mov_b64 v[66:67], 0
    v_mov_b64 v[68:69], 0
    v_mov_b64 v[70:71], 0
    v_add_u32 v20, s68, v0
    v_xor_b32 v21, 2048, v20
    v_xor_b32 v22, 4096, v20
    v_xor_b32 v23, 6144, v20
    v_add_u32 v16, s79, v0
    v_mov_b32 v17, -1
    v_mov_b32 v18, 0
    s_sub_u32 s48, s52, 1
    s_max_i32 s48, s48, 0
    v_mov_b32 v19, s48
    s_cmp_ge_u32 s52, 63
    s_cselect_b32 s94, 0x7ff00000, s61
    s_add_u32 s48, s52, 2
    s_min_u32 s48, s48, 63
    s_and_b32 s48, s48, 0xfffffffc
    s_add_u32 s95, s48, s70
    s_cmp_eq_u32 s52, 0
    s_cselect_b32 s96, 0x7ff00000, s62
    s_cselect_b32 s48, 0, 0x20000
    s_add_u32 s62, s62, s48
    v_readfirstlane_b32 s49, v13
    s_nop 2
    s_cmp_ge_u32 s49, 3
    s_cbranch_scc1 L_flok_7
    s_add_u32 s48, s52, 1
    s_min_u32 s48, s48, 63
    s_and_b32 s48, s48, 0xfffffffc
    s_add_u32 s50, s48, s70
    v_mov_b32 v40, 0
L_f1_8:
    s_add_u32 s101, s101, 1
    s_cmp_gt_u32 s101, 0x200000
    s_cbranch_scc1 L_exit
    buffer_load_dword v13, v40, s[32:35], s50 offen sc1
    s_waitcnt vmcnt(0)
    v_readfirstlane_b32 s49, v13
    s_nop 2
    s_cmp_lt_u32 s49, 3
    s_cbranch_scc1 L_f1_8
L_flok_7:
    s_waitcnt vmcnt(0)
    buffer_load_dwordx4 v[120:123], v0, s[32:35], s51 offen sc1
    buffer_load_dwordx4 v[124:127], v0, s[32:35], s51 offen offset:1024 sc1
    s_waitcnt lgkmcnt(0)
    s_waitcnt vmcnt(0)
    v_max3_u32 v33, v120, v121, v122
    v_max3_u32 v34, v123, v124, v125
    v_max3_u32 v33, v33, v126, v127
    v_max_u32 v33, v33, v34
    v_cmp_eq_u32 vcc, -1, v33
    s_cbranch_vccz L_p2d_10
    s_mov_b64 exec, vcc
L_p2_9:
    buffer_load_dwordx4 v[120:123], v0, s[32:35], s51 offen sc1
    buffer_load_dwordx4 v[124:127], v0, s[32:35], s51 offen offset:1024 sc1
    s_mov_b64 exec, -1
    s_add_u32 s101, s101, 1
    s_cmp_gt_u32 s101, 0x200000
    s_cbranch_scc1 L_exit
    s_waitcnt vmcnt(0)
    v_max3_u32 v33, v120, v121, v122
    v_max3_u32 v34, v123, v124, v125
    v_max3_u32 v33, v33, v126, v127
    v_max_u32 v33, v33, v34
    v_cmp_eq_u32 vcc, -1, v33
    s_cbranch_vccz L_p2d_10
    s_mov_b64 exec, vcc
    s_branch L_p2_9
L_p2d_10:
    s_branch L_step
L_chain_done:
    s_waitcnt lgkmcnt(0)
    s_barrier
    v_add_u32 v124, s79, v0
    ds_read_b128 v[120:123], v124 offset:26624
    s_waitcnt lgkmcnt(0)
    buffer_store_dwordx4 v[120:123], v0, s[32:35], s62 offen sc1
    s_waitcnt vmcnt(0)
    v_mov_b32 v120, 64
    v_mov_b32 v121, 0
    s_mov_b64 exec, 1
    buffer_store_dword v120, v121, s[32:35], s71 offen sc1
    s_mov_b64 exec, -1
    s_branch L_exit
L_worker:
    v_and_b32 v1, 63, v0
    s_mov_b32 s98, 0
    s_mov_b32 s75, 0
    s_mov_b32 s74, 0
L_next_regs:
    v_and_b32 v16, 31, v1
    v_bfe_u32 v17, v1, 1, 3
    v_lshrrev_b32 v18, 5, v1
    v_xor_b32 v17, v17, v18
    v_lshlrev_b32 v16, 7, v16
    v_lshl_add_u32 v16, v17, 4, v16
    s_lshl_b32 s60, s45, 12
    v_add_u32 v16, s60, v16
    v_xor_b32 v8, 0, v16
    v_xor_b32 v9, 32, v16
    v_xor_b32 v10, 64, v16
    v_xor_b32 v11, 96, v16
    v_bfe_u32 v16, v1, 2, 2
    v_lshl_add_u32 v17, v18, 3, v16
    v_lshlrev_b32 v17, 8, v17
    v_bfe_u32 v19, v1, 4, 1
    v_bfe_u32 v20, v1, 1, 1
    v_lshl_add_u32 v19, v19, 1, v20
    v_lshlrev_b32 v20, 2, v16
    v_xor_b32 v19, v19, v20
    v_lshl_add_u32 v17, v19, 4, v17
    v_and_b32 v19, 1, v1
    v_lshl_add_u32 v17, v19, 3, v17
    v_add_u32 v17, 16384, v17
    v_xor_b32 v12, 0, v17
    v_xor_b32 v13, 64, v17
    v_xor_b32 v14, 128, v17
    v_xor_b32 v15, 192, v17
L_next:
    s_barrier
    s_cmp_lg_u32 s45, 0
    s_cbranch_scc1 L_w0_11
    s_mov_b64 exec, 1
    v_mov_b32 v17, 1
L_q_12:
    s_cmp_ge_u32 s74, 7
    s_cbranch_scc1 L_gq_13
    s_lshl_b32 s60, s46, 2
    s_add_u32 s60, s60, 192
    v_mov_b32 v16, s60
    global_atomic_add v18, v16, v17, s[26:27] sc0
    s_waitcnt vmcnt(0)
    v_readfirstlane_b32 s60, v18
    s_nop 2
    s_cmp_lt_u32 s60, 100
    s_cbranch_scc1 L_qok_15
    s_add_u32 s74, s74, 1
    s_add_u32 s46, s46, 1
    s_cmp_ge_u32 s46, 7
    s_cselect_b32 s46, 0, s46
    s_branch L_q_12
L_qok_15:
    s_mul_i32 s61, s60, 171
    s_lshr_b32 s61, s61, 9
    s_mul_i32 s62, s61, 3
    s_sub_u32 s59, s60, s62
    s_lshl_b32 s59, s59, 9
    s_or_b32 s59, s59, 0x10000
    s_sub_u32 s62, s60, 20
    s_cmp_lt_u32 s60, 30
    s_cselect_b32 s60, s61, s62
    s_cselect_b32 s59, s59, 0
    s_mul_i32 s61, s60, 205
    s_lshr_b32 s61, s61, 10
    s_mul_i32 s62, s61, 5
    s_sub_u32 s62, s60, s62
    s_mul_i32 s62, s62, 7
    s_add_u32 s62, s62, s46
    s_lshl_b32 s60, s61, 5
    s_add_u32 s60, s60, s62
    s_lshl_b32 s63, s61, 2
    s_add_u32 s63, s63, s62
    s_add_u32 s63, s63, 480
    s_or_b32 s60, s60, s59
    s_cmp_lt_u32 s62, 32
    s_cbranch_scc1 L_isb_16
    s_mov_b32 s60, s63
    s_cmp_gt_u32 s59, 0x10000
    s_cbranch_scc1 L_q_12
L_isb_16:
    v_mov_b32 v18, s60
    s_branch L_got_14
L_gq_13:
    v_mov_b32 v16, 224
    global_atomic_add v18, v16, v17, s[26:27] sc0
    s_waitcnt vmcnt(0)
    v_readfirstlane_b32 s60, v18
    s_nop 2
    s_lshl_b32 s61, s60, 2
    s_add_u32 s61, s61, 515
    s_add_u32 s62, s60, 560
    s_cmp_lt_u32 s60, 16
    s_cselect_b32 s60, s61, s62
    v_mov_b32 v18, s60
L_got_14:
    s_mov_b32 s75, 1
    s_waitcnt vmcnt(0)
    v_mov_b32 v16, 161792
    ds_write_b32 v16, v18
    s_waitcnt lgkmcnt(0)
    s_mov_b64 exec, -1
L_w0_11:
    s_barrier
    v_mov_b32 v16, 161792
    ds_read_b32 v17, v16
    s_waitcnt lgkmcnt(0)
    v_readfirstlane_b32 s52, v17
    s_nop 2
    s_cmp_ge_u32 s52, 0x10000
    s_cbranch_scc1 L_t_bsplit
    s_cmp_lt_u32 s52, 512
    s_cbranch_scc1 L_t_bproj
    s_cmp_lt_u32 s52, 576
    s_cbranch_scc1 L_t_aproj
    s_cmp_lt_u32 s52, 704
    s_cbranch_scc1 L_t_aattn
    s_cmp_ge_u32 s52, 1456
    s_cbranch_scc1 L_exit
    s_cmp_ge_u32 s52, 1200
    s_cbranch_scc1 L_t_bx
    s_cmp_ge_u32 s52, 1200
    s_cbranch_scc1 L_t_bf
    s_cmp_ge_u32 s52, 768
    s_cbranch_scc1 L_t_bt
    s_sub_u32 s60, s52, 704
    s_lshr_b32 s53, s60, 2
    s_and_b32 s54, s60, 3
    s_branch L_t_aout
L_t_bt:
    s_sub_u32 s60, s52, 768
    s_mul_i32 s53, s60, 1821
    s_lshr_b32 s53, s53, 16
    s_mul_i32 s61, s53, 36
    s_sub_u32 s60, s60, s61
    s_cmp_ge_u32 s60, 32
    s_cbranch_scc1 L_bo_17
    s_lshr_b32 s61, s60, 3
    s_lshl_b32 s55, s53, 2
    s_add_u32 s55, s55, s61
    s_and_b32 s54, s60, 7
    s_branch L_t_battn
L_bo_17:
    s_sub_u32 s54, s60, 32
    s_branch L_t_bout
L_t_bf:
    s_sub_u32 s60, s52, 1200
    s_mul_i32 s61, s60, 2731
    s_lshr_b32 s61, s61, 16
    s_add_u32 s55, s61, 48
    s_lshr_b32 s53, s55, 2
    s_mul_i32 s61, s61, 24
    s_sub_u32 s54, s60, s61
    s_cmp_lt_u32 s54, 8
    s_cbranch_scc1 L_t_battn
    s_sub_u32 s54, s54, 8
    s_branch L_exit
L_t_bx:
    s_sub_u32 s60, s52, 1200
    s_lshr_b32 s61, s60, 5
    s_add_u32 s55, s61, 48
    s_and_b32 s54, s60, 31
    s_cmp_lt_u32 s60, 128
    s_cbranch_scc1 L_t_boutx
    s_sub_u32 s60, s60, 128
    s_lshr_b32 s61, s60, 3
    s_add_u32 s55, s61, 48
    s_lshr_b32 s53, s55, 2
    s_and_b32 s54, s60, 7
    s_branch L_t_battn
L_t_boutx:
    s_mov_b32 s80, s20
    s_and_b32 s81, s21, 0xffff
    s_mov_b32 s82, 0x400000
    s_mov_b32 s83, 0x00020000
    s_mov_b32 s92, s24
    s_and_b32 s93, s25, 0xffff
    s_mov_b32 s94, 0x400000
    s_mov_b32 s95, 0x00020000
    v_lshrrev_b32 v16, 2, v1
    v_lshlrev_b32 v16, 10, v16
    v_and_b32 v19, 3, v1
    v_lshl_add_u32 v16, v19, 4, v16
    s_and_b32 s56, s54, 15
    s_lshr_b32 s57, s54, 4
    s_lshl_b32 s61, s45, 20
    s_lshl_b32 s60, s56, 6
    s_add_u32 s61, s61, s60
    s_lshl_b32 s58, s45, 15
    v_lshrrev_b32 v18, 4, v1
    v_bfe_u32 v17, v1, 2, 2
    v_lshl_add_u32 v17, v18, 3, v17
    v_lshlrev_b32 v17, 6, v17
    v_lshl_add_u32 v17, v19, 3, v17
    v_add_u32 v17, s58, v17
    v_and_b32 v19, 15, v1
    v_lshlrev_b32 v20, 13, v19
    v_lshl_add_u32 v20, v18, 4, v20
    v_lshlrev_b32 v21, 11, v19
    v_lshl_add_u32 v21, v18, 3, v21
    s_add_u32 m0, s58, 0
    s_add_u32 s60, s61, 0
    buffer_load_dwordx4 v16, s[80:83], s60 offen lds
    s_add_u32 m0, s58, 1024
    s_add_u32 s60, s61, 16384
    buffer_load_dwordx4 v16, s[80:83], s60 offen lds
    s_add_u32 m0, s58, 2048
    s_add_u32 s60, s61, 32768
    buffer_load_dwordx4 v16, s[80:83], s60 offen lds
    s_add_u32 m0, s58, 3072
    s_add_u32 s60, s61, 49152
    buffer_load_dwordx4 v16, s[80:83], s60 offen lds
    s_add_u32 m0, s58, 4096
    s_add_u32 s60, s61, 65536
    buffer_load_dwordx4 v16, s[80:83], s60 offen lds
    s_add_u32 m0, s58, 5120
    s_add_u32 s60, s61, 81920
    buffer_load_dwordx4 v16, s[80:83], s60 offen lds
    s_add_u32 m0, s58, 6144
    s_add_u32 s60, s61, 98304
    buffer_load_dwordx4 v16, s[80:83], s60 offen lds
    s_add_u32 m0, s58, 7168
    s_add_u32 s60, s61, 114688
    buffer_load_dwordx4 v16, s[80:83], s60 offen lds
    s_add_u32 m0, s58, 8192
    s_add_u32 s60, s61, 131072
    buffer_load_dwordx4 v16, s[80:83], s60 offen lds
    s_add_u32 m0, s58, 9216
    s_add_u32 s60, s61, 147456
    buffer_load_dwordx4 v16, s[80:83], s60 offen lds
    s_add_u32 m0, s58, 10240
    s_add_u32 s60, s61, 163840
    buffer_load_dwordx4 v16, s[80:83], s60 offen lds
    s_add_u32 m0, s58, 11264
    s_add_u32 s60, s61, 180224
    buffer_load_dwordx4 v16, s[80:83], s60 offen lds
    s_add_u32 m0, s58, 12288
    s_add_u32 s60, s61, 196608
    buffer_load_dwordx4 v16, s[80:83], s60 offen lds
    s_add_u32 m0, s58, 13312
    s_add_u32 s60, s61, 212992
    buffer_load_dwordx4 v16, s[80:83], s60 offen lds
    s_add_u32 m0, s58, 14336
    s_add_u32 s60, s61, 229376
    buffer_load_dwordx4 v16, s[80:83], s60 offen lds
    s_add_u32 m0, s58, 15360
    s_add_u32 s60, s61, 245760
    buffer_load_dwordx4 v16, s[80:83], s60 offen lds
    s_add_u32 m0, s58, 16384
    s_add_u32 s60, s61, 262144
    buffer_load_dwordx4 v16, s[80:83], s60 offen lds
    s_add_u32 m0, s58, 17408
    s_add_u32 s60, s61, 278528
    buffer_load_dwordx4 v16, s[80:83], s60 offen lds
    s_add_u32 m0, s58, 18432
    s_add_u32 s60, s61, 294912
    buffer_load_dwordx4 v16, s[80:83], s60 offen lds
    s_add_u32 m0, s58, 19456
    s_add_u32 s60, s61, 311296
    buffer_load_dwordx4 v16, s[80:83], s60 offen lds
    s_add_u32 m0, s58, 20480
    s_add_u32 s60, s61, 327680
    buffer_load_dwordx4 v16, s[80:83], s60 offen lds
    s_add_u32 m0, s58, 21504
    s_add_u32 s60, s61, 344064
    buffer_load_dwordx4 v16, s[80:83], s60 offen lds
    s_add_u32 m0, s58, 22528
    s_add_u32 s60, s61, 360448
    buffer_load_dwordx4 v16, s[80:83], s60 offen lds
    s_add_u32 m0, s58, 23552
    s_add_u32 s60, s61, 376832
    buffer_load_dwordx4 v16, s[80:83], s60 offen lds
    s_add_u32 m0, s58, 24576
    s_add_u32 s60, s61, 393216
    buffer_load_dwordx4 v16, s[80:83], s60 offen lds
    s_add_u32 m0, s58, 25600
    s_add_u32 s60, s61, 409600
    buffer_load_dwordx4 v16, s[80:83], s60 offen lds
    s_add_u32 m0, s58, 26624
    s_add_u32 s60, s61, 425984
    buffer_load_dwordx4 v16, s[80:83], s60 offen lds
    s_add_u32 m0, s58, 27648
    s_add_u32 s60, s61, 442368
    buffer_load_dwordx4 v16, s[80:83], s60 offen lds
    s_add_u32 m0, s58, 28672
    s_add_u32 s60, s61, 458752
    buffer_load_dwordx4 v16, s[80:83], s60 offen lds
    s_add_u32 m0, s58, 29696
    s_add_u32 s60, s61, 475136
    buffer_load_dwordx4 v16, s[80:83], s60 offen lds
    s_add_u32 m0, s58, 30720
    s_add_u32 s60, s61, 491520
    buffer_load_dwordx4 v16, s[80:83], s60 offen lds
    s_add_u32 m0, s58, 31744
    s_add_u32 s60, s61, 507904
    buffer_load_dwordx4 v16, s[80:83], s60 offen lds
    s_waitcnt vmcnt(0)
    ds_read_b64_tr_b16 a[0:1], v17 offset:0
    ds_read_b64_tr_b16 a[2:3], v17 offset:256
    ds_read_b64_tr_b16 a[128:129], v17 offset:32
    ds_read_b64_tr_b16 a[130:131], v17 offset:288
    ds_read_b64_tr_b16 a[4:5], v17 offset:2048
    ds_read_b64_tr_b16 a[6:7], v17 offset:2304
    ds_read_b64_tr_b16 a[132:133], v17 offset:2080
    ds_read_b64_tr_b16 a[134:135], v17 offset:2336
    ds_read_b64_tr_b16 a[8:9], v17 offset:4096
    ds_read_b64_tr_b16 a[10:11], v17 offset:4352
    ds_read_b64_tr_b16 a[136:137], v17 offset:4128
    ds_read_b64_tr_b16 a[138:139], v17 offset:4384
    ds_read_b64_tr_b16 a[12:13], v17 offset:6144
    ds_read_b64_tr_b16 a[14:15], v17 offset:6400
    ds_read_b64_tr_b16 a[140:141], v17 offset:6176
    ds_read_b64_tr_b16 a[142:143], v17 offset:6432
    ds_read_b64_tr_b16 a[16:17], v17 offset:8192
    ds_read_b64_tr_b16 a[18:19], v17 offset:8448
    ds_read_b64_tr_b16 a[144:145], v17 offset:8224
    ds_read_b64_tr_b16 a[146:147], v17 offset:8480
    ds_read_b64_tr_b16 a[20:21], v17 offset:10240
    ds_read_b64_tr_b16 a[22:23], v17 offset:10496
    ds_read_b64_tr_b16 a[148:149], v17 offset:10272
    ds_read_b64_tr_b16 a[150:151], v17 offset:10528
    ds_read_b64_tr_b16 a[24:25], v17 offset:12288
    ds_read_b64_tr_b16 a[26:27], v17 offset:12544
    ds_read_b64_tr_b16 a[152:153], v17 offset:12320
    ds_read_b64_tr_b16 a[154:155], v17 offset:12576
    ds_read_b64_tr_b16 a[28:29], v17 offset:14336
    ds_read_b64_tr_b16 a[30:31], v17 offset:14592
    ds_read_b64_tr_b16 a[156:157], v17 offset:14368
    ds_read_b64_tr_b16 a[158:159], v17 offset:14624
    ds_read_b64_tr_b16 a[32:33], v17 offset:16384
    ds_read_b64_tr_b16 a[34:35], v17 offset:16640
    ds_read_b64_tr_b16 a[160:161], v17 offset:16416
    ds_read_b64_tr_b16 a[162:163], v17 offset:16672
    ds_read_b64_tr_b16 a[36:37], v17 offset:18432
    ds_read_b64_tr_b16 a[38:39], v17 offset:18688
    ds_read_b64_tr_b16 a[164:165], v17 offset:18464
    ds_read_b64_tr_b16 a[166:167], v17 offset:18720
    ds_read_b64_tr_b16 a[40:41], v17 offset:20480
    ds_read_b64_tr_b16 a[42:43], v17 offset:20736
    ds_read_b64_tr_b16 a[168:169], v17 offset:20512
    ds_read_b64_tr_b16 a[170:171], v17 offset:20768
    ds_read_b64_tr_b16 a[44:45], v17 offset:22528
    ds_read_b64_tr_b16 a[46:47], v17 offset:22784
    ds_read_b64_tr_b16 a[172:173], v17 offset:22560
    ds_read_b64_tr_b16 a[174:175], v17 offset:22816
    ds_read_b64_tr_b16 a[48:49], v17 offset:24576
    ds_read_b64_tr_b16 a[50:51], v17 offset:24832
    ds_read_b64_tr_b16 a[176:177], v17 offset:24608
    ds_read_b64_tr_b16 a[178:179], v17 offset:24864
    ds_read_b64_tr_b16 a[52:53], v17 offset:26624
    ds_read_b64_tr_b16 a[54:55], v17 offset:26880
    ds_read_b64_tr_b16 a[180:181], v17 offset:26656
    ds_read_b64_tr_b16 a[182:183], v17 offset:26912
    ds_read_b64_tr_b16 a[56:57], v17 offset:28672
    ds_read_b64_tr_b16 a[58:59], v17 offset:28928
    ds_read_b64_tr_b16 a[184:185], v17 offset:28704
    ds_read_b64_tr_b16 a[186:187], v17 offset:28960
    ds_read_b64_tr_b16 a[60:61], v17 offset:30720
    ds_read_b64_tr_b16 a[62:63], v17 offset:30976
    ds_read_b64_tr_b16 a[188:189], v17 offset:30752
    ds_read_b64_tr_b16 a[190:191], v17 offset:31008
    s_waitcnt lgkmcnt(0)
    s_add_u32 m0, s58, 0
    s_add_u32 s60, s61, 524288
    buffer_load_dwordx4 v16, s[80:83], s60 offen lds
    s_add_u32 m0, s58, 1024
    s_add_u32 s60, s61, 540672
    buffer_load_dwordx4 v16, s[80:83], s60 offen lds
    s_add_u32 m0, s58, 2048
    s_add_u32 s60, s61, 557056
    buffer_load_dwordx4 v16, s[80:83], s60 offen lds
    s_add_u32 m0, s58, 3072
    s_add_u32 s60, s61, 573440
    buffer_load_dwordx4 v16, s[80:83], s60 offen lds
    s_add_u32 m0, s58, 4096
    s_add_u32 s60, s61, 589824
    buffer_load_dwordx4 v16, s[80:83], s60 offen lds
    s_add_u32 m0, s58, 5120
    s_add_u32 s60, s61, 606208
    buffer_load_dwordx4 v16, s[80:83], s60 offen lds
    s_add_u32 m0, s58, 6144
    s_add_u32 s60, s61, 622592
    buffer_load_dwordx4 v16, s[80:83], s60 offen lds
    s_add_u32 m0, s58, 7168
    s_add_u32 s60, s61, 638976
    buffer_load_dwordx4 v16, s[80:83], s60 offen lds
    s_add_u32 m0, s58, 8192
    s_add_u32 s60, s61, 655360
    buffer_load_dwordx4 v16, s[80:83], s60 offen lds
    s_add_u32 m0, s58, 9216
    s_add_u32 s60, s61, 671744
    buffer_load_dwordx4 v16, s[80:83], s60 offen lds
    s_add_u32 m0, s58, 10240
    s_add_u32 s60, s61, 688128
    buffer_load_dwordx4 v16, s[80:83], s60 offen lds
    s_add_u32 m0, s58, 11264
    s_add_u32 s60, s61, 704512
    buffer_load_dwordx4 v16, s[80:83], s60 offen lds
    s_add_u32 m0, s58, 12288
    s_add_u32 s60, s61, 720896
    buffer_load_dwordx4 v16, s[80:83], s60 offen lds
    s_add_u32 m0, s58, 13312
    s_add_u32 s60, s61, 737280
    buffer_load_dwordx4 v16, s[80:83], s60 offen lds
    s_add_u32 m0, s58, 14336
    s_add_u32 s60, s61, 753664
    buffer_load_dwordx4 v16, s[80:83], s60 offen lds
    s_add_u32 m0, s58, 15360
    s_add_u32 s60, s61, 770048
    buffer_load_dwordx4 v16, s[80:83], s60 offen lds
    s_add_u32 m0, s58, 16384
    s_add_u32 s60, s61, 786432
    buffer_load_dwordx4 v16, s[80:83], s60 offen lds
    s_add_u32 m0, s58, 17408
    s_add_u32 s60, s61, 802816
    buffer_load_dwordx4 v16, s[80:83], s60 offen lds
    s_add_u32 m0, s58, 18432
    s_add_u32 s60, s61, 819200
    buffer_load_dwordx4 v16, s[80:83], s60 offen lds
    s_add_u32 m0, s58, 19456
    s_add_u32 s60, s61, 835584
    buffer_load_dwordx4 v16, s[80:83], s60 offen lds
    s_add_u32 m0, s58, 20480
    s_add_u32 s60, s61, 851968
    buffer_load_dwordx4 v16, s[80:83], s60 offen lds
    s_add_u32 m0, s58, 21504
    s_add_u32 s60, s61, 868352
    buffer_load_dwordx4 v16, s[80:83], s60 offen lds
    s_add_u32 m0, s58, 22528
    s_add_u32 s60, s61, 884736
    buffer_load_dwordx4 v16, s[80:83], s60 offen lds
    s_add_u32 m0, s58, 23552
    s_add_u32 s60, s61, 901120
    buffer_load_dwordx4 v16, s[80:83], s60 offen lds
    s_add_u32 m0, s58, 24576
    s_add_u32 s60, s61, 917504
    buffer_load_dwordx4 v16, s[80:83], s60 offen lds
    s_add_u32 m0, s58, 25600
    s_add_u32 s60, s61, 933888
    buffer_load_dwordx4 v16, s[80:83], s60 offen lds
    s_add_u32 m0, s58, 26624
    s_add_u32 s60, s61, 950272
    buffer_load_dwordx4 v16, s[80:83], s60 offen lds
    s_add_u32 m0, s58, 27648
    s_add_u32 s60, s61, 966656
    buffer_load_dwordx4 v16, s[80:83], s60 offen lds
    s_add_u32 m0, s58, 28672
    s_add_u32 s60, s61, 983040
    buffer_load_dwordx4 v16, s[80:83], s60 offen lds
    s_add_u32 m0, s58, 29696
    s_add_u32 s60, s61, 999424
    buffer_load_dwordx4 v16, s[80:83], s60 offen lds
    s_add_u32 m0, s58, 30720
    s_add_u32 s60, s61, 1015808
    buffer_load_dwordx4 v16, s[80:83], s60 offen lds
    s_add_u32 m0, s58, 31744
    s_add_u32 s60, s61, 1032192
    buffer_load_dwordx4 v16, s[80:83], s60 offen lds
    s_waitcnt vmcnt(0)
    ds_read_b64_tr_b16 a[64:65], v17 offset:0
    ds_read_b64_tr_b16 a[66:67], v17 offset:256
    ds_read_b64_tr_b16 a[192:193], v17 offset:32
    ds_read_b64_tr_b16 a[194:195], v17 offset:288
    ds_read_b64_tr_b16 a[68:69], v17 offset:2048
    ds_read_b64_tr_b16 a[70:71], v17 offset:2304
    ds_read_b64_tr_b16 a[196:197], v17 offset:2080
    ds_read_b64_tr_b16 a[198:199], v17 offset:2336
    ds_read_b64_tr_b16 a[72:73], v17 offset:4096
    ds_read_b64_tr_b16 a[74:75], v17 offset:4352
    ds_read_b64_tr_b16 a[200:201], v17 offset:4128
    ds_read_b64_tr_b16 a[202:203], v17 offset:4384
    ds_read_b64_tr_b16 a[76:77], v17 offset:6144
    ds_read_b64_tr_b16 a[78:79], v17 offset:6400
    ds_read_b64_tr_b16 a[204:205], v17 offset:6176
    ds_read_b64_tr_b16 a[206:207], v17 offset:6432
    ds_read_b64_tr_b16 a[80:81], v17 offset:8192
    ds_read_b64_tr_b16 a[82:83], v17 offset:8448
    ds_read_b64_tr_b16 a[208:209], v17 offset:8224
    ds_read_b64_tr_b16 a[210:211], v17 offset:8480
    ds_read_b64_tr_b16 a[84:85], v17 offset:10240
    ds_read_b64_tr_b16 a[86:87], v17 offset:10496
    ds_read_b64_tr_b16 a[212:213], v17 offset:10272
    ds_read_b64_tr_b16 a[214:215], v17 offset:10528
    ds_read_b64_tr_b16 a[88:89], v17 offset:12288
    ds_read_b64_tr_b16 a[90:91], v17 offset:12544
    ds_read_b64_tr_b16 a[216:217], v17 offset:12320
    ds_read_b64_tr_b16 a[218:219], v17 offset:12576
    ds_read_b64_tr_b16 a[92:93], v17 offset:14336
    ds_read_b64_tr_b16 a[94:95], v17 offset:14592
    ds_read_b64_tr_b16 a[220:221], v17 offset:14368
    ds_read_b64_tr_b16 a[222:223], v17 offset:14624
    ds_read_b64_tr_b16 a[96:97], v17 offset:16384
    ds_read_b64_tr_b16 a[98:99], v17 offset:16640
    ds_read_b64_tr_b16 a[224:225], v17 offset:16416
    ds_read_b64_tr_b16 a[226:227], v17 offset:16672
    ds_read_b64_tr_b16 a[100:101], v17 offset:18432
    ds_read_b64_tr_b16 a[102:103], v17 offset:18688
    ds_read_b64_tr_b16 a[228:229], v17 offset:18464
    ds_read_b64_tr_b16 a[230:231], v17 offset:18720
    ds_read_b64_tr_b16 a[104:105], v17 offset:20480
    ds_read_b64_tr_b16 a[106:107], v17 offset:20736
    ds_read_b64_tr_b16 a[232:233], v17 offset:20512
    ds_read_b64_tr_b16 a[234:235], v17 offset:20768
    ds_read_b64_tr_b16 a[108:109], v17 offset:22528
    ds_read_b64_tr_b16 a[110:111], v17 offset:22784
    ds_read_b64_tr_b16 a[236:237], v17 offset:22560
    ds_read_b64_tr_b16 a[238:239], v17 offset:22816
    ds_read_b64_tr_b16 a[112:113], v17 offset:24576
    ds_read_b64_tr_b16 a[114:115], v17 offset:24832
    ds_read_b64_tr_b16 a[240:241], v17 offset:24608
    ds_read_b64_tr_b16 a[242:243], v17 offset:24864
    ds_read_b64_tr_b16 a[116:117], v17 offset:26624
    ds_read_b64_tr_b16 a[118:119], v17 offset:26880
    ds_read_b64_tr_b16 a[244:245], v17 offset:26656
    ds_read_b64_tr_b16 a[246:247], v17 offset:26912
    ds_read_b64_tr_b16 a[120:121], v17 offset:28672
    ds_read_b64_tr_b16 a[122:123], v17 offset:28928
    ds_read_b64_tr_b16 a[248:249], v17 offset:28704
    ds_read_b64_tr_b16 a[250:251], v17 offset:28960
    ds_read_b64_tr_b16 a[124:125], v17 offset:30720
    ds_read_b64_tr_b16 a[126:127], v17 offset:30976
    ds_read_b64_tr_b16 a[252:253], v17 offset:30752
    ds_read_b64_tr_b16 a[254:255], v17 offset:31008
    s_waitcnt lgkmcnt(0)
    v_lshlrev_b32 v22, 4, v1
    v_add_u32 v23, s58, v22
    s_lshl_b32 s60, s45, 10
    v_add_u32 v22, s60, v22
    v_add_u32 v24, 65536, v22
L_bx_loop:
    s_lshl_b32 s60, s55, 7
    s_add_u32 s60, s60, 0x2000
    s_cmp_lg_u32 s98, 0
    s_cbranch_scc1 L_id_19
    v_mov_b32 v16, 128
L_iw_18:
    s_add_u32 s101, s101, 1
    s_cmp_gt_u32 s101, 0x200000
    s_cbranch_scc1 L_exit
    global_load_dword v17, v16, s[26:27] sc1
    s_waitcnt vmcnt(0)
    v_readfirstlane_b32 s61, v17
    s_nop 2
    s_cmp_lt_u32 s61, 32
    s_cbranch_scc1 L_iw_18
    s_mov_b32 s98, 1
L_id_19:
    v_mov_b32 v16, 0
L_wait_20:
    s_add_u32 s101, s101, 1
    s_cmp_gt_u32 s101, 0x200000
    s_cbranch_scc1 L_exit
    buffer_load_dword v17, v16, s[32:35], s60 offen sc1
    s_waitcnt vmcnt(0)
    v_readfirstlane_b32 s61, v17
    s_nop 2
    s_cmp_ge_u32 s61, 8
    s_cbranch_scc1 L_waitd_21
    s_sleep 4
    s_branch L_wait_20
L_waitd_21:
    s_lshl_b32 s60, s55, 1
    s_add_u32 s60, s60, s57
    s_lshl_b32 s61, s60, 17
    s_lshl_b32 s62, s45, 11
    s_add_u32 s61, s61, s62
    s_add_u32 s61, s61, 0x5000000
    buffer_load_dwordx4 v[64:67], v20, s[32:35], s61 offen offset:0 sc1
    buffer_load_dwordx4 v[68:71], v20, s[32:35], s61 offen offset:64 sc1
    buffer_load_dwordx4 v[72:75], v20, s[32:35], s61 offen offset:128 sc1
    buffer_load_dwordx4 v[76:79], v20, s[32:35], s61 offen offset:192 sc1
    buffer_load_dwordx4 v[80:83], v20, s[32:35], s61 offen offset:256 sc1
    buffer_load_dwordx4 v[84:87], v20, s[32:35], s61 offen offset:320 sc1
    buffer_load_dwordx4 v[88:91], v20, s[32:35], s61 offen offset:384 sc1
    buffer_load_dwordx4 v[92:95], v20, s[32:35], s61 offen offset:448 sc1
    buffer_load_dwordx4 v[96:99], v20, s[32:35], s61 offen offset:512 sc1
    buffer_load_dwordx4 v[100:103], v20, s[32:35], s61 offen offset:576 sc1
    buffer_load_dwordx4 v[104:107], v20, s[32:35], s61 offen offset:640 sc1
    buffer_load_dwordx4 v[108:111], v20, s[32:35], s61 offen offset:704 sc1
    buffer_load_dwordx4 v[112:115], v20, s[32:35], s61 offen offset:768 sc1
    buffer_load_dwordx4 v[116:119], v20, s[32:35], s61 offen offset:832 sc1
    buffer_load_dwordx4 v[120:123], v20, s[32:35], s61 offen offset:896 sc1
    buffer_load_dwordx4 v[124:127], v20, s[32:35], s61 offen offset:960 sc1
    buffer_load_dwordx4 v[128:131], v20, s[32:35], s61 offen offset:1024 sc1
    buffer_load_dwordx4 v[132:135], v20, s[32:35], s61 offen offset:1088 sc1
    buffer_load_dwordx4 v[136:139], v20, s[32:35], s61 offen offset:1152 sc1
    buffer_load_dwordx4 v[140:143], v20, s[32:35], s61 offen offset:1216 sc1
    buffer_load_dwordx4 v[144:147], v20, s[32:35], s61 offen offset:1280 sc1
    buffer_load_dwordx4 v[148:151], v20, s[32:35], s61 offen offset:1344 sc1
    buffer_load_dwordx4 v[152:155], v20, s[32:35], s61 offen offset:1408 sc1
    buffer_load_dwordx4 v[156:159], v20, s[32:35], s61 offen offset:1472 sc1
    buffer_load_dwordx4 v[160:163], v20, s[32:35], s61 offen offset:1536 sc1
    buffer_load_dwordx4 v[164:167], v20, s[32:35], s61 offen offset:1600 sc1
    buffer_load_dwordx4 v[168:171], v20, s[32:35], s61 offen offset:1664 sc1
    buffer_load_dwordx4 v[172:175], v20, s[32:35], s61 offen offset:1728 sc1
    buffer_load_dwordx4 v[176:179], v20, s[32:35], s61 offen offset:1792 sc1
    buffer_load_dwordx4 v[180:183], v20, s[32:35], s61 offen offset:1856 sc1
    buffer_load_dwordx4 v[184:187], v20, s[32:35], s61 offen offset:1920 sc1
    buffer_load_dwordx4 v[188:191], v20, s[32:35], s61 offen offset:1984 sc1
    s_waitcnt vmcnt(31)
    v_mfma_f32_16x16x32_bf16 v[32:35], a[0:3], v[64:67], 0
    v_mfma_f32_16x16x32_bf16 v[36:39], a[128:131], v[64:67], 0
    s_waitcnt vmcnt(30)
    v_mfma_f32_16x16x32_bf16 v[32:35], a[4:7], v[68:71], v[32:35]
    v_mfma_f32_16x16x32_bf16 v[36:39], a[132:135], v[68:71], v[36:39]
    s_waitcnt vmcnt(29)
    v_mfma_f32_16x16x32_bf16 v[32:35], a[8:11], v[72:75], v[32:35]
    v_mfma_f32_16x16x32_bf16 v[36:39], a[136:139], v[72:75], v[36:39]
    s_waitcnt vmcnt(28)
    v_mfma_f32_16x16x32_bf16 v[32:35], a[12:15], v[76:79], v[32:35]
    v_mfma_f32_16x16x32_bf16 v[36:39], a[140:143], v[76:79], v[36:39]
    s_waitcnt vmcnt(27)
    v_mfma_f32_16x16x32_bf16 v[32:35], a[16:19], v[80:83], v[32:35]
    v_mfma_f32_16x16x32_bf16 v[36:39], a[144:147], v[80:83], v[36:39]
    s_waitcnt vmcnt(26)
    v_mfma_f32_16x16x32_bf16 v[32:35], a[20:23], v[84:87], v[32:35]
    v_mfma_f32_16x16x32_bf16 v[36:39], a[148:151], v[84:87], v[36:39]
    s_waitcnt vmcnt(25)
    v_mfma_f32_16x16x32_bf16 v[32:35], a[24:27], v[88:91], v[32:35]
    v_mfma_f32_16x16x32_bf16 v[36:39], a[152:155], v[88:91], v[36:39]
    s_waitcnt vmcnt(24)
    v_mfma_f32_16x16x32_bf16 v[32:35], a[28:31], v[92:95], v[32:35]
    v_mfma_f32_16x16x32_bf16 v[36:39], a[156:159], v[92:95], v[36:39]
    s_waitcnt vmcnt(23)
    v_mfma_f32_16x16x32_bf16 v[32:35], a[32:35], v[96:99], v[32:35]
    v_mfma_f32_16x16x32_bf16 v[36:39], a[160:163], v[96:99], v[36:39]
    s_waitcnt vmcnt(22)
    v_mfma_f32_16x16x32_bf16 v[32:35], a[36:39], v[100:103], v[32:35]
    v_mfma_f32_16x16x32_bf16 v[36:39], a[164:167], v[100:103], v[36:39]
    s_waitcnt vmcnt(21)
    v_mfma_f32_16x16x32_bf16 v[32:35], a[40:43], v[104:107], v[32:35]
    v_mfma_f32_16x16x32_bf16 v[36:39], a[168:171], v[104:107], v[36:39]
    s_waitcnt vmcnt(20)
    v_mfma_f32_16x16x32_bf16 v[32:35], a[44:47], v[108:111], v[32:35]
    v_mfma_f32_16x16x32_bf16 v[36:39], a[172:175], v[108:111], v[36:39]
    s_waitcnt vmcnt(19)
    v_mfma_f32_16x16x32_bf16 v[32:35], a[48:51], v[112:115], v[32:35]
    v_mfma_f32_16x16x32_bf16 v[36:39], a[176:179], v[112:115], v[36:39]
    s_waitcnt vmcnt(18)
    v_mfma_f32_16x16x32_bf16 v[32:35], a[52:55], v[116:119], v[32:35]
    v_mfma_f32_16x16x32_bf16 v[36:39], a[180:183], v[116:119], v[36:39]
    s_waitcnt vmcnt(17)
    v_mfma_f32_16x16x32_bf16 v[32:35], a[56:59], v[120:123], v[32:35]
    v_mfma_f32_16x16x32_bf16 v[36:39], a[184:187], v[120:123], v[36:39]
    s_waitcnt vmcnt(16)
    v_mfma_f32_16x16x32_bf16 v[32:35], a[60:63], v[124:127], v[32:35]
    v_mfma_f32_16x16x32_bf16 v[36:39], a[188:191], v[124:127], v[36:39]
    s_waitcnt vmcnt(15)
    v_mfma_f32_16x16x32_bf16 v[32:35], a[64:67], v[128:131], v[32:35]
    v_mfma_f32_16x16x32_bf16 v[36:39], a[192:195], v[128:131], v[36:39]
    s_waitcnt vmcnt(14)
    v_mfma_f32_16x16x32_bf16 v[32:35], a[68:71], v[132:135], v[32:35]
    v_mfma_f32_16x16x32_bf16 v[36:39], a[196:199], v[132:135], v[36:39]
    s_waitcnt vmcnt(13)
    v_mfma_f32_16x16x32_bf16 v[32:35], a[72:75], v[136:139], v[32:35]
    v_mfma_f32_16x16x32_bf16 v[36:39], a[200:203], v[136:139], v[36:39]
    s_waitcnt vmcnt(12)
    v_mfma_f32_16x16x32_bf16 v[32:35], a[76:79], v[140:143], v[32:35]
    v_mfma_f32_16x16x32_bf16 v[36:39], a[204:207], v[140:143], v[36:39]
    s_waitcnt vmcnt(11)
    v_mfma_f32_16x16x32_bf16 v[32:35], a[80:83], v[144:147], v[32:35]
    v_mfma_f32_16x16x32_bf16 v[36:39], a[208:211], v[144:147], v[36:39]
    s_waitcnt vmcnt(10)
    v_mfma_f32_16x16x32_bf16 v[32:35], a[84:87], v[148:151], v[32:35]
    v_mfma_f32_16x16x32_bf16 v[36:39], a[212:215], v[148:151], v[36:39]
    s_waitcnt vmcnt(9)
    v_mfma_f32_16x16x32_bf16 v[32:35], a[88:91], v[152:155], v[32:35]
    v_mfma_f32_16x16x32_bf16 v[36:39], a[216:219], v[152:155], v[36:39]
    s_waitcnt vmcnt(8)
    v_mfma_f32_16x16x32_bf16 v[32:35], a[92:95], v[156:159], v[32:35]
    v_mfma_f32_16x16x32_bf16 v[36:39], a[220:223], v[156:159], v[36:39]
    s_waitcnt vmcnt(7)
    v_mfma_f32_16x16x32_bf16 v[32:35], a[96:99], v[160:163], v[32:35]
    v_mfma_f32_16x16x32_bf16 v[36:39], a[224:227], v[160:163], v[36:39]
    s_waitcnt vmcnt(6)
    v_mfma_f32_16x16x32_bf16 v[32:35], a[100:103], v[164:167], v[32:35]
    v_mfma_f32_16x16x32_bf16 v[36:39], a[228:231], v[164:167], v[36:39]
    s_waitcnt vmcnt(5)
    v_mfma_f32_16x16x32_bf16 v[32:35], a[104:107], v[168:171], v[32:35]
    v_mfma_f32_16x16x32_bf16 v[36:39], a[232:235], v[168:171], v[36:39]
    s_waitcnt vmcnt(4)
    v_mfma_f32_16x16x32_bf16 v[32:35], a[108:111], v[172:175], v[32:35]
    v_mfma_f32_16x16x32_bf16 v[36:39], a[236:239], v[172:175], v[36:39]
    s_waitcnt vmcnt(3)
    v_mfma_f32_16x16x32_bf16 v[32:35], a[112:115], v[176:179], v[32:35]
    v_mfma_f32_16x16x32_bf16 v[36:39], a[240:243], v[176:179], v[36:39]
    s_waitcnt vmcnt(2)
    v_mfma_f32_16x16x32_bf16 v[32:35], a[116:119], v[180:183], v[32:35]
    v_mfma_f32_16x16x32_bf16 v[36:39], a[244:247], v[180:183], v[36:39]
    s_waitcnt vmcnt(1)
    v_mfma_f32_16x16x32_bf16 v[32:35], a[120:123], v[184:187], v[32:35]
    v_mfma_f32_16x16x32_bf16 v[36:39], a[248:251], v[184:187], v[36:39]
    s_waitcnt vmcnt(0)
    v_mfma_f32_16x16x32_bf16 v[32:35], a[124:127], v[188:191], v[32:35]
    v_mfma_f32_16x16x32_bf16 v[36:39], a[252:255], v[188:191], v[36:39]
    s_nop 7
    ds_write_b128 v23, v[32:35]
    ds_write_b128 v23, v[36:39] offset:1024
    s_waitcnt lgkmcnt(0)
    s_barrier
    s_cmp_ge_u32 s45, 2
    s_cbranch_scc1 L_bxs_22
    ds_read_b128 v[32:35], v22 offset:0
    ds_read_b128 v[36:39], v22 offset:32768
    ds_read_b128 v[40:43], v24 offset:0
    ds_read_b128 v[44:47], v24 offset:32768
    s_lshl_b32 s60, s60, 15
    s_lshl_b32 s61, s56, 6
    s_add_u32 s60, s60, s61
    s_lshl_b32 s61, s45, 5
    s_add_u32 s60, s60, s61
    s_waitcnt lgkmcnt(0)
    v_pk_add_f32 v[32:33], v[32:33], v[36:37]
    v_pk_add_f32 v[40:41], v[40:41], v[44:45]
    v_pk_add_f32 v[34:35], v[34:35], v[38:39]
    v_pk_add_f32 v[42:43], v[42:43], v[46:47]
    v_pk_add_f32 v[32:33], v[32:33], v[40:41]
    v_pk_add_f32 v[34:35], v[34:35], v[42:43]
    v_cvt_pk_bf16_f32 v32, v32, v33
    v_cvt_pk_bf16_f32 v33, v34, v35
    buffer_store_dwordx2 v[32:33], v21, s[92:95], s60 offen offset:1024
L_bxs_22:
    s_barrier
    s_add_u32 s55, s55, 4
    s_cmp_lt_u32 s55, 64
    s_cbranch_scc1 L_bx_loop
    s_branch L_next
L_t_bsplit:
    s_bfe_u32 s53, s52, 0x40005
    s_and_b32 s54, s52, 31
    s_bfe_u32 s57, s52, 0x20009
    s_mov_b32 s36, s10
    s_and_b32 s37, s11, 0xffff
    s_mov_b32 s38, 0x200000
    s_mov_b32 s39, 0x00020000
    s_mov_b32 s80, s14
    s_and_b32 s81, s15, 0xffff
    s_mov_b32 s82, 0x400000
    s_mov_b32 s83, 0x00020000
    s_mov_b32 s84, s16
    s_and_b32 s85, s17, 0xffff
    s_mov_b32 s86, 0x400000
    s_mov_b32 s87, 0x00020000
    s_mov_b32 s88, s18
    s_and_b32 s89, s19, 0xffff
    s_mov_b32 s90, 0x400000
    s_mov_b32 s91, 0x00020000
    v_lshrrev_b32 v16, 3, v1
    s_mov_b32 s60, 1024
    v_mul_lo_u32 v16, v16, s60
    v_and_b32 v17, 7, v1
    v_lshrrev_b32 v18, 4, v1
    v_xor_b32 v17, v17, v18
    v_lshl_add_u32 v16, v17, 4, v16
    v_xor_b32 v2, 0, v16
    v_xor_b32 v3, 64, v16
    v_add_u32 v3, 8192, v3
    v_xor_b32 v4, 0, v16
    v_add_u32 v4, 16384, v4
    v_xor_b32 v5, 64, v16
    v_add_u32 v5, 24576, v5
    s_mov_b32 s60, 8192
    v_mul_lo_u32 v16, v18, s60
    v_and_b32 v17, 15, v1
    v_lshlrev_b32 v19, 2, v18
    v_xor_b32 v17, v17, v19
    v_lshl_add_u32 v6, v17, 4, v16
    s_lshl_b32 s55, s53, 17
    s_lshl_b32 s60, s45, 15
    s_add_u32 s55, s55, s60
    s_lshl_b32 s56, s54, 8
    s_cmp_eq_u32 s57, 2
    s_cbranch_scc1 L_bs_v
    s_cmp_eq_u32 s57, 0
    s_cbranch_scc1 L_bs_q
L_bs_k:
    v_mov_b64 v[64:65], 0
    v_mov_b64 v[66:67], 0
    v_mov_b64 v[68:69], 0
    v_mov_b64 v[70:71], 0
    v_mov_b64 v[72:73], 0
    v_mov_b64 v[74:75], 0
    v_mov_b64 v[76:77], 0
    v_mov_b64 v[78:79], 0
    v_mov_b64 v[80:81], 0
    v_mov_b64 v[82:83], 0
    v_mov_b64 v[84:85], 0
    v_mov_b64 v[86:87], 0
    v_mov_b64 v[88:89], 0
    v_mov_b64 v[90:91], 0
    v_mov_b64 v[92:93], 0
    v_mov_b64 v[94:95], 0
    v_mov_b64 v[96:97], 0
    v_mov_b64 v[98:99], 0
    v_mov_b64 v[100:101], 0
    v_mov_b64 v[102:103], 0
    v_mov_b64 v[104:105], 0
    v_mov_b64 v[106:107], 0
    v_mov_b64 v[108:109], 0
    v_mov_b64 v[110:111], 0
    v_mov_b64 v[112:113], 0
    v_mov_b64 v[114:115], 0
    v_mov_b64 v[116:117], 0
    v_mov_b64 v[118:119], 0
    v_mov_b64 v[120:121], 0
    v_mov_b64 v[122:123], 0
    v_mov_b64 v[124:125], 0
    v_mov_b64 v[126:127], 0
    s_mov_b32 s59, 0
    s_lshl_b32 s60, s45, 12
    s_lshl_b32 s61, s59, 7
    s_add_u32 s61, s61, s55
    s_add_u32 m0, s60, 0
    s_nop 0
    buffer_load_dwordx4 v2, s[36:39], s61 offen lds
    s_add_u32 m0, s60, 1024
    s_nop 0
    buffer_load_dwordx4 v3, s[36:39], s61 offen lds
    s_add_u32 m0, s60, 2048
    s_nop 0
    buffer_load_dwordx4 v4, s[36:39], s61 offen lds
    s_add_u32 m0, s60, 3072
    s_nop 0
    buffer_load_dwordx4 v5, s[36:39], s61 offen lds
    s_lshl_b32 s61, s59, 6
    s_lshl_b32 s62, s45, 4
    s_add_u32 s61, s61, s62
    s_mul_i32 s61, s61, 8192
    s_add_u32 s62, s61, s56
    s_add_u32 m0, s60, 16384
    s_add_u32 s63, s62, 0
    buffer_load_dwordx4 v6, s[84:87], s63 offen lds
    s_add_u32 m0, s60, 17408
    s_add_u32 s63, s62, 32768
    buffer_load_dwordx4 v6, s[84:87], s63 offen lds
    s_add_u32 m0, s60, 18432
    s_add_u32 s63, s62, 65536
    buffer_load_dwordx4 v6, s[84:87], s63 offen lds
    s_add_u32 m0, s60, 19456
    s_add_u32 s63, s62, 98304
    buffer_load_dwordx4 v6, s[84:87], s63 offen lds
    s_mov_b32 s59, 1
    s_lshl_b32 s60, s45, 12
    s_lshl_b32 s61, s59, 7
    s_add_u32 s61, s61, s55
    s_add_u32 m0, s60, 32768
    s_nop 0
    buffer_load_dwordx4 v2, s[36:39], s61 offen lds
    s_add_u32 m0, s60, 33792
    s_nop 0
    buffer_load_dwordx4 v3, s[36:39], s61 offen lds
    s_add_u32 m0, s60, 34816
    s_nop 0
    buffer_load_dwordx4 v4, s[36:39], s61 offen lds
    s_add_u32 m0, s60, 35840
    s_nop 0
    buffer_load_dwordx4 v5, s[36:39], s61 offen lds
    s_lshl_b32 s61, s59, 6
    s_lshl_b32 s62, s45, 4
    s_add_u32 s61, s61, s62
    s_mul_i32 s61, s61, 8192
    s_add_u32 s62, s61, s56
    s_add_u32 m0, s60, 49152
    s_add_u32 s63, s62, 0
    buffer_load_dwordx4 v6, s[84:87], s63 offen lds
    s_add_u32 m0, s60, 50176
    s_add_u32 s63, s62, 32768
    buffer_load_dwordx4 v6, s[84:87], s63 offen lds
    s_add_u32 m0, s60, 51200
    s_add_u32 s63, s62, 65536
    buffer_load_dwordx4 v6, s[84:87], s63 offen lds
    s_add_u32 m0, s60, 52224
    s_add_u32 s63, s62, 98304
    buffer_load_dwordx4 v6, s[84:87], s63 offen lds
    s_mov_b32 s59, 2
    s_lshl_b32 s60, s45, 12
    s_lshl_b32 s61, s59, 7
    s_add_u32 s61, s61, s55
    s_add_u32 m0, s60, 65536
    s_nop 0
    buffer_load_dwordx4 v2, s[36:39], s61 offen lds
    s_add_u32 m0, s60, 66560
    s_nop 0
    buffer_load_dwordx4 v3, s[36:39], s61 offen lds
    s_add_u32 m0, s60, 67584
    s_nop 0
    buffer_load_dwordx4 v4, s[36:39], s61 offen lds
    s_add_u32 m0, s60, 68608
    s_nop 0
    buffer_load_dwordx4 v5, s[36:39], s61 offen lds
    s_lshl_b32 s61, s59, 6
    s_lshl_b32 s62, s45, 4
    s_add_u32 s61, s61, s62
    s_mul_i32 s61, s61, 8192
    s_add_u32 s62, s61, s56
    s_add_u32 m0, s60, 81920
    s_add_u32 s63, s62, 0
    buffer_load_dwordx4 v6, s[84:87], s63 offen lds
    s_add_u32 m0, s60, 82944
    s_add_u32 s63, s62, 32768
    buffer_load_dwordx4 v6, s[84:87], s63 offen lds
    s_add_u32 m0, s60, 83968
    s_add_u32 s63, s62, 65536
    buffer_load_dwordx4 v6, s[84:87], s63 offen lds
    s_add_u32 m0, s60, 84992
    s_add_u32 s63, s62, 98304
    buffer_load_dwordx4 v6, s[84:87], s63 offen lds
    s_mov_b32 s100, 2
L_gl_bsk:
    s_waitcnt vmcnt(16)
L_gl_bsk_in:
    s_barrier
    ds_read_b128 a[48:51], v8
    ds_read_b64_tr_b16 a[0:1], v12 offset:0
    ds_read_b64_tr_b16 a[2:3], v12 offset:1024
    ds_read_b64_tr_b16 a[4:5], v13 offset:0
    ds_read_b64_tr_b16 a[6:7], v13 offset:1024
    ds_read_b64_tr_b16 a[8:9], v14 offset:0
    ds_read_b64_tr_b16 a[10:11], v14 offset:1024
    ds_read_b64_tr_b16 a[12:13], v15 offset:0
    ds_read_b64_tr_b16 a[14:15], v15 offset:1024
    s_add_u32 s100, s100, 1
    s_min_u32 s59, s100, 7
    s_waitcnt lgkmcnt(6)
    v_mfma_f32_32x32x16_bf16 v[64:79], a[0:3], a[48:51], v[64:79]
    ds_read_b128 a[112:115], v9
    ds_read_b64_tr_b16 a[64:65], v12 offset:4096
    ds_read_b64_tr_b16 a[66:67], v12 offset:5120
    s_lshl_b32 s60, s45, 12
    s_lshl_b32 s61, s59, 7
    s_add_u32 s61, s61, s55
    s_add_u32 m0, s60, 98304
    s_nop 0
    buffer_load_dwordx4 v2, s[36:39], s61 offen lds
    s_waitcnt lgkmcnt(7)
    v_mfma_f32_32x32x16_bf16 v[80:95], a[4:7], a[48:51], v[80:95]
    ds_read_b64_tr_b16 a[68:69], v13 offset:4096
    ds_read_b64_tr_b16 a[70:71], v13 offset:5120
    s_waitcnt lgkmcnt(7)
    v_mfma_f32_32x32x16_bf16 v[96:111], a[8:11], a[48:51], v[96:111]
    ds_read_b64_tr_b16 a[72:73], v14 offset:4096
    ds_read_b64_tr_b16 a[74:75], v14 offset:5120
    s_add_u32 m0, s60, 99328
    s_nop 0
    buffer_load_dwordx4 v3, s[36:39], s61 offen lds
    s_waitcnt lgkmcnt(7)
    v_mfma_f32_32x32x16_bf16 v[112:127], a[12:15], a[48:51], v[112:127]
    ds_read_b64_tr_b16 a[76:77], v15 offset:4096
    ds_read_b64_tr_b16 a[78:79], v15 offset:5120
    s_waitcnt lgkmcnt(6)
    v_mfma_f32_32x32x16_bf16 v[64:79], a[64:67], a[112:115], v[64:79]
    ds_read_b128 a[48:51], v10
    ds_read_b64_tr_b16 a[0:1], v12 offset:8192
    ds_read_b64_tr_b16 a[2:3], v12 offset:9216
    s_add_u32 m0, s60, 100352
    s_nop 0
    buffer_load_dwordx4 v4, s[36:39], s61 offen lds
    s_waitcnt lgkmcnt(7)
    v_mfma_f32_32x32x16_bf16 v[80:95], a[68:71], a[112:115], v[80:95]
    ds_read_b64_tr_b16 a[4:5], v13 offset:8192
    ds_read_b64_tr_b16 a[6:7], v13 offset:9216
    s_waitcnt lgkmcnt(7)
    v_mfma_f32_32x32x16_bf16 v[96:111], a[72:75], a[112:115], v[96:111]
    ds_read_b64_tr_b16 a[8:9], v14 offset:8192
    ds_read_b64_tr_b16 a[10:11], v14 offset:9216
    s_add_u32 m0, s60, 101376
    s_nop 0
    buffer_load_dwordx4 v5, s[36:39], s61 offen lds
    s_waitcnt lgkmcnt(7)
    v_mfma_f32_32x32x16_bf16 v[112:127], a[76:79], a[112:115], v[112:127]
    ds_read_b64_tr_b16 a[12:13], v15 offset:8192
    ds_read_b64_tr_b16 a[14:15], v15 offset:9216
    s_waitcnt lgkmcnt(6)
    v_mfma_f32_32x32x16_bf16 v[64:79], a[0:3], a[48:51], v[64:79]
    ds_read_b128 a[112:115], v11
    ds_read_b64_tr_b16 a[64:65], v12 offset:12288
    ds_read_b64_tr_b16 a[66:67], v12 offset:13312
    s_lshl_b32 s61, s59, 6
    s_lshl_b32 s62, s45, 4
    s_add_u32 s61, s61, s62
    s_mul_i32 s61, s61, 8192
    s_add_u32 s62, s61, s56
    s_add_u32 m0, s60, 114688
    s_add_u32 s63, s62, 0
    buffer_load_dwordx4 v6, s[84:87], s63 offen lds
    s_waitcnt lgkmcnt(7)
    v_mfma_f32_32x32x16_bf16 v[80:95], a[4:7], a[48:51], v[80:95]
    ds_read_b64_tr_b16 a[68:69], v13 offset:12288
    ds_read_b64_tr_b16 a[70:71], v13 offset:13312
    s_waitcnt lgkmcnt(7)
    v_mfma_f32_32x32x16_bf16 v[96:111], a[8:11], a[48:51], v[96:111]
    ds_read_b64_tr_b16 a[72:73], v14 offset:12288
    ds_read_b64_tr_b16 a[74:75], v14 offset:13312
    s_add_u32 m0, s60, 115712
    s_add_u32 s63, s62, 32768
    buffer_load_dwordx4 v6, s[84:87], s63 offen lds
    s_waitcnt lgkmcnt(7)
    v_mfma_f32_32x32x16_bf16 v[112:127], a[12:15], a[48:51], v[112:127]
    ds_read_b64_tr_b16 a[76:77], v15 offset:12288
    ds_read_b64_tr_b16 a[78:79], v15 offset:13312
    s_waitcnt lgkmcnt(6)
    v_mfma_f32_32x32x16_bf16 v[64:79], a[64:67], a[112:115], v[64:79]
    s_add_u32 m0, s60, 116736
    s_add_u32 s63, s62, 65536
    buffer_load_dwordx4 v6, s[84:87], s63 offen lds
    s_waitcnt lgkmcnt(4)
    v_mfma_f32_32x32x16_bf16 v[80:95], a[68:71], a[112:115], v[80:95]
    s_waitcnt lgkmcnt(2)
    v_mfma_f32_32x32x16_bf16 v[96:111], a[72:75], a[112:115], v[96:111]
    s_add_u32 m0, s60, 117760
    s_add_u32 s63, s62, 98304
    buffer_load_dwordx4 v6, s[84:87], s63 offen lds
    s_waitcnt lgkmcnt(0)
    v_mfma_f32_32x32x16_bf16 v[112:127], a[76:79], a[112:115], v[112:127]
    v_add_u32 v8, 0x8000, v8
    v_add_u32 v12, 0x8000, v12
    v_add_u32 v9, 0x8000, v9
    v_add_u32 v13, 0x8000, v13
    v_add_u32 v10, 0x8000, v10
    v_add_u32 v14, 0x8000, v14
    v_add_u32 v11, 0x8000, v11
    v_add_u32 v15, 0x8000, v15
    s_waitcnt vmcnt(16)
    s_barrier
    ds_read_b128 a[48:51], v8
    ds_read_b64_tr_b16 a[0:1], v12 offset:0
    ds_read_b64_tr_b16 a[2:3], v12 offset:1024
    ds_read_b64_tr_b16 a[4:5], v13 offset:0
    ds_read_b64_tr_b16 a[6:7], v13 offset:1024
    ds_read_b64_tr_b16 a[8:9], v14 offset:0
    ds_read_b64_tr_b16 a[10:11], v14 offset:1024
    ds_read_b64_tr_b16 a[12:13], v15 offset:0
    ds_read_b64_tr_b16 a[14:15], v15 offset:1024
    s_add_u32 s100, s100, 1
    s_min_u32 s59, s100, 7
    s_waitcnt lgkmcnt(6)
    v_mfma_f32_32x32x16_bf16 v[64:79], a[0:3], a[48:51], v[64:79]
    ds_read_b128 a[112:115], v9
    ds_read_b64_tr_b16 a[64:65], v12 offset:4096
    ds_read_b64_tr_b16 a[66:67], v12 offset:5120
    s_lshl_b32 s60, s45, 12
    s_lshl_b32 s61, s59, 7
    s_add_u32 s61, s61, s55
    s_add_u32 m0, s60, 0
    s_nop 0
    buffer_load_dwordx4 v2, s[36:39], s61 offen lds
    s_waitcnt lgkmcnt(7)
    v_mfma_f32_32x32x16_bf16 v[80:95], a[4:7], a[48:51], v[80:95]
    ds_read_b64_tr_b16 a[68:69], v13 offset:4096
    ds_read_b64_tr_b16 a[70:71], v13 offset:5120
    s_waitcnt lgkmcnt(7)
    v_mfma_f32_32x32x16_bf16 v[96:111], a[8:11], a[48:51], v[96:111]
    ds_read_b64_tr_b16 a[72:73], v14 offset:4096
    ds_read_b64_tr_b16 a[74:75], v14 offset:5120
    s_add_u32 m0, s60, 1024
    s_nop 0
    buffer_load_dwordx4 v3, s[36:39], s61 offen lds
    s_waitcnt lgkmcnt(7)
    v_mfma_f32_32x32x16_bf16 v[112:127], a[12:15], a[48:51], v[112:127]
    ds_read_b64_tr_b16 a[76:77], v15 offset:4096
    ds_read_b64_tr_b16 a[78:79], v15 offset:5120
    s_waitcnt lgkmcnt(6)
    v_mfma_f32_32x32x16_bf16 v[64:79], a[64:67], a[112:115], v[64:79]
    ds_read_b128 a[48:51], v10
    ds_read_b64_tr_b16 a[0:1], v12 offset:8192
    ds_read_b64_tr_b16 a[2:3], v12 offset:9216
    s_add_u32 m0, s60, 2048
    s_nop 0
    buffer_load_dwordx4 v4, s[36:39], s61 offen lds
    s_waitcnt lgkmcnt(7)
    v_mfma_f32_32x32x16_bf16 v[80:95], a[68:71], a[112:115], v[80:95]
    ds_read_b64_tr_b16 a[4:5], v13 offset:8192
    ds_read_b64_tr_b16 a[6:7], v13 offset:9216
    s_waitcnt lgkmcnt(7)
    v_mfma_f32_32x32x16_bf16 v[96:111], a[72:75], a[112:115], v[96:111]
    ds_read_b64_tr_b16 a[8:9], v14 offset:8192
    ds_read_b64_tr_b16 a[10:11], v14 offset:9216
    s_add_u32 m0, s60, 3072
    s_nop 0
    buffer_load_dwordx4 v5, s[36:39], s61 offen lds
    s_waitcnt lgkmcnt(7)
    v_mfma_f32_32x32x16_bf16 v[112:127], a[76:79], a[112:115], v[112:127]
    ds_read_b64_tr_b16 a[12:13], v15 offset:8192
    ds_read_b64_tr_b16 a[14:15], v15 offset:9216
    s_waitcnt lgkmcnt(6)
    v_mfma_f32_32x32x16_bf16 v[64:79], a[0:3], a[48:51], v[64:79]
    ds_read_b128 a[112:115], v11
    ds_read_b64_tr_b16 a[64:65], v12 offset:12288
    ds_read_b64_tr_b16 a[66:67], v12 offset:13312
    s_lshl_b32 s61, s59, 6
    s_lshl_b32 s62, s45, 4
    s_add_u32 s61, s61, s62
    s_mul_i32 s61, s61, 8192
    s_add_u32 s62, s61, s56
    s_add_u32 m0, s60, 16384
    s_add_u32 s63, s62, 0
    buffer_load_dwordx4 v6, s[84:87], s63 offen lds
    s_waitcnt lgkmcnt(7)
    v_mfma_f32_32x32x16_bf16 v[80:95], a[4:7], a[48:51], v[80:95]
    ds_read_b64_tr_b16 a[68:69], v13 offset:12288
    ds_read_b64_tr_b16 a[70:71], v13 offset:13312
    s_waitcnt lgkmcnt(7)
    v_mfma_f32_32x32x16_bf16 v[96:111], a[8:11], a[48:51], v[96:111]
    ds_read_b64_tr_b16 a[72:73], v14 offset:12288
    ds_read_b64_tr_b16 a[74:75], v14 offset:13312
    s_add_u32 m0, s60, 17408
    s_add_u32 s63, s62, 32768
    buffer_load_dwordx4 v6, s[84:87], s63 offen lds
    s_waitcnt lgkmcnt(7)
    v_mfma_f32_32x32x16_bf16 v[112:127], a[12:15], a[48:51], v[112:127]
    ds_read_b64_tr_b16 a[76:77], v15 offset:12288
    ds_read_b64_tr_b16 a[78:79], v15 offset:13312
    s_waitcnt lgkmcnt(6)
    v_mfma_f32_32x32x16_bf16 v[64:79], a[64:67], a[112:115], v[64:79]
    s_add_u32 m0, s60, 18432
    s_add_u32 s63, s62, 65536
    buffer_load_dwordx4 v6, s[84:87], s63 offen lds
    s_waitcnt lgkmcnt(4)
    v_mfma_f32_32x32x16_bf16 v[80:95], a[68:71], a[112:115], v[80:95]
    s_waitcnt lgkmcnt(2)
    v_mfma_f32_32x32x16_bf16 v[96:111], a[72:75], a[112:115], v[96:111]
    s_add_u32 m0, s60, 19456
    s_add_u32 s63, s62, 98304
    buffer_load_dwordx4 v6, s[84:87], s63 offen lds
    s_waitcnt lgkmcnt(0)
    v_mfma_f32_32x32x16_bf16 v[112:127], a[76:79], a[112:115], v[112:127]
    v_add_u32 v8, 0x8000, v8
    v_add_u32 v12, 0x8000, v12
    v_add_u32 v9, 0x8000, v9
    v_add_u32 v13, 0x8000, v13
    v_add_u32 v10, 0x8000, v10
    v_add_u32 v14, 0x8000, v14
    v_add_u32 v11, 0x8000, v11
    v_add_u32 v15, 0x8000, v15
    s_waitcnt vmcnt(16)
    s_barrier
    ds_read_b128 a[48:51], v8
    ds_read_b64_tr_b16 a[0:1], v12 offset:0
    ds_read_b64_tr_b16 a[2:3], v12 offset:1024
    ds_read_b64_tr_b16 a[4:5], v13 offset:0
    ds_read_b64_tr_b16 a[6:7], v13 offset:1024
    ds_read_b64_tr_b16 a[8:9], v14 offset:0
    ds_read_b64_tr_b16 a[10:11], v14 offset:1024
    ds_read_b64_tr_b16 a[12:13], v15 offset:0
    ds_read_b64_tr_b16 a[14:15], v15 offset:1024
    s_add_u32 s100, s100, 1
    s_min_u32 s59, s100, 7
    s_waitcnt lgkmcnt(6)
    v_mfma_f32_32x32x16_bf16 v[64:79], a[0:3], a[48:51], v[64:79]
    ds_read_b128 a[112:115], v9
    ds_read_b64_tr_b16 a[64:65], v12 offset:4096
    ds_read_b64_tr_b16 a[66:67], v12 offset:5120
    s_lshl_b32 s60, s45, 12
    s_lshl_b32 s61, s59, 7
    s_add_u32 s61, s61, s55
    s_add_u32 m0, s60, 32768
    s_nop 0
    buffer_load_dwordx4 v2, s[36:39], s61 offen lds
    s_waitcnt lgkmcnt(7)
    v_mfma_f32_32x32x16_bf16 v[80:95], a[4:7], a[48:51], v[80:95]
    ds_read_b64_tr_b16 a[68:69], v13 offset:4096
    ds_read_b64_tr_b16 a[70:71], v13 offset:5120
    s_waitcnt lgkmcnt(7)
    v_mfma_f32_32x32x16_bf16 v[96:111], a[8:11], a[48:51], v[96:111]
    ds_read_b64_tr_b16 a[72:73], v14 offset:4096
    ds_read_b64_tr_b16 a[74:75], v14 offset:5120
    s_add_u32 m0, s60, 33792
    s_nop 0
    buffer_load_dwordx4 v3, s[36:39], s61 offen lds
    s_waitcnt lgkmcnt(7)
    v_mfma_f32_32x32x16_bf16 v[112:127], a[12:15], a[48:51], v[112:127]
    ds_read_b64_tr_b16 a[76:77], v15 offset:4096
    ds_read_b64_tr_b16 a[78:79], v15 offset:5120
    s_waitcnt lgkmcnt(6)
    v_mfma_f32_32x32x16_bf16 v[64:79], a[64:67], a[112:115], v[64:79]
    ds_read_b128 a[48:51], v10
    ds_read_b64_tr_b16 a[0:1], v12 offset:8192
    ds_read_b64_tr_b16 a[2:3], v12 offset:9216
    s_add_u32 m0, s60, 34816
    s_nop 0
    buffer_load_dwordx4 v4, s[36:39], s61 offen lds
    s_waitcnt lgkmcnt(7)
    v_mfma_f32_32x32x16_bf16 v[80:95], a[68:71], a[112:115], v[80:95]
    ds_read_b64_tr_b16 a[4:5], v13 offset:8192
    ds_read_b64_tr_b16 a[6:7], v13 offset:9216
    s_waitcnt lgkmcnt(7)
    v_mfma_f32_32x32x16_bf16 v[96:111], a[72:75], a[112:115], v[96:111]
    ds_read_b64_tr_b16 a[8:9], v14 offset:8192
    ds_read_b64_tr_b16 a[10:11], v14 offset:9216
    s_add_u32 m0, s60, 35840
    s_nop 0
    buffer_load_dwordx4 v5, s[36:39], s61 offen lds
    s_waitcnt lgkmcnt(7)
    v_mfma_f32_32x32x16_bf16 v[112:127], a[76:79], a[112:115], v[112:127]
    ds_read_b64_tr_b16 a[12:13], v15 offset:8192
    ds_read_b64_tr_b16 a[14:15], v15 offset:9216
    s_waitcnt lgkmcnt(6)
    v_mfma_f32_32x32x16_bf16 v[64:79], a[0:3], a[48:51], v[64:79]
    ds_read_b128 a[112:115], v11
    ds_read_b64_tr_b16 a[64:65], v12 offset:12288
    ds_read_b64_tr_b16 a[66:67], v12 offset:13312
    s_lshl_b32 s61, s59, 6
    s_lshl_b32 s62, s45, 4
    s_add_u32 s61, s61, s62
    s_mul_i32 s61, s61, 8192
    s_add_u32 s62, s61, s56
    s_add_u32 m0, s60, 49152
    s_add_u32 s63, s62, 0
    buffer_load_dwordx4 v6, s[84:87], s63 offen lds
    s_waitcnt lgkmcnt(7)
    v_mfma_f32_32x32x16_bf16 v[80:95], a[4:7], a[48:51], v[80:95]
    ds_read_b64_tr_b16 a[68:69], v13 offset:12288
    ds_read_b64_tr_b16 a[70:71], v13 offset:13312
    s_waitcnt lgkmcnt(7)
    v_mfma_f32_32x32x16_bf16 v[96:111], a[8:11], a[48:51], v[96:111]
    ds_read_b64_tr_b16 a[72:73], v14 offset:12288
    ds_read_b64_tr_b16 a[74:75], v14 offset:13312
    s_add_u32 m0, s60, 50176
    s_add_u32 s63, s62, 32768
    buffer_load_dwordx4 v6, s[84:87], s63 offen lds
    s_waitcnt lgkmcnt(7)
    v_mfma_f32_32x32x16_bf16 v[112:127], a[12:15], a[48:51], v[112:127]
    ds_read_b64_tr_b16 a[76:77], v15 offset:12288
    ds_read_b64_tr_b16 a[78:79], v15 offset:13312
    s_waitcnt lgkmcnt(6)
    v_mfma_f32_32x32x16_bf16 v[64:79], a[64:67], a[112:115], v[64:79]
    s_add_u32 m0, s60, 51200
    s_add_u32 s63, s62, 65536
    buffer_load_dwordx4 v6, s[84:87], s63 offen lds
    s_waitcnt lgkmcnt(4)
    v_mfma_f32_32x32x16_bf16 v[80:95], a[68:71], a[112:115], v[80:95]
    s_waitcnt lgkmcnt(2)
    v_mfma_f32_32x32x16_bf16 v[96:111], a[72:75], a[112:115], v[96:111]
    s_add_u32 m0, s60, 52224
    s_add_u32 s63, s62, 98304
    buffer_load_dwordx4 v6, s[84:87], s63 offen lds
    s_waitcnt lgkmcnt(0)
    v_mfma_f32_32x32x16_bf16 v[112:127], a[76:79], a[112:115], v[112:127]
    v_add_u32 v8, 0x8000, v8
    v_add_u32 v12, 0x8000, v12
    v_add_u32 v9, 0x8000, v9
    v_add_u32 v13, 0x8000, v13
    v_add_u32 v10, 0x8000, v10
    v_add_u32 v14, 0x8000, v14
    v_add_u32 v11, 0x8000, v11
    v_add_u32 v15, 0x8000, v15
    s_waitcnt vmcnt(16)
    s_barrier
    ds_read_b128 a[48:51], v8
    ds_read_b64_tr_b16 a[0:1], v12 offset:0
    ds_read_b64_tr_b16 a[2:3], v12 offset:1024
    ds_read_b64_tr_b16 a[4:5], v13 offset:0
    ds_read_b64_tr_b16 a[6:7], v13 offset:1024
    ds_read_b64_tr_b16 a[8:9], v14 offset:0
    ds_read_b64_tr_b16 a[10:11], v14 offset:1024
    ds_read_b64_tr_b16 a[12:13], v15 offset:0
    ds_read_b64_tr_b16 a[14:15], v15 offset:1024
    s_add_u32 s100, s100, 1
    s_min_u32 s59, s100, 7
    s_waitcnt lgkmcnt(6)
    v_mfma_f32_32x32x16_bf16 v[64:79], a[0:3], a[48:51], v[64:79]
    ds_read_b128 a[112:115], v9
    ds_read_b64_tr_b16 a[64:65], v12 offset:4096
    ds_read_b64_tr_b16 a[66:67], v12 offset:5120
    s_lshl_b32 s60, s45, 12
    s_lshl_b32 s61, s59, 7
    s_add_u32 s61, s61, s55
    s_add_u32 m0, s60, 65536
    s_nop 0
    buffer_load_dwordx4 v2, s[36:39], s61 offen lds
    s_waitcnt lgkmcnt(7)
    v_mfma_f32_32x32x16_bf16 v[80:95], a[4:7], a[48:51], v[80:95]
    ds_read_b64_tr_b16 a[68:69], v13 offset:4096
    ds_read_b64_tr_b16 a[70:71], v13 offset:5120
    s_waitcnt lgkmcnt(7)
    v_mfma_f32_32x32x16_bf16 v[96:111], a[8:11], a[48:51], v[96:111]
    ds_read_b64_tr_b16 a[72:73], v14 offset:4096
    ds_read_b64_tr_b16 a[74:75], v14 offset:5120
    s_add_u32 m0, s60, 66560
    s_nop 0
    buffer_load_dwordx4 v3, s[36:39], s61 offen lds
    s_waitcnt lgkmcnt(7)
    v_mfma_f32_32x32x16_bf16 v[112:127], a[12:15], a[48:51], v[112:127]
    ds_read_b64_tr_b16 a[76:77], v15 offset:4096
    ds_read_b64_tr_b16 a[78:79], v15 offset:5120
    s_waitcnt lgkmcnt(6)
    v_mfma_f32_32x32x16_bf16 v[64:79], a[64:67], a[112:115], v[64:79]
    ds_read_b128 a[48:51], v10
    ds_read_b64_tr_b16 a[0:1], v12 offset:8192
    ds_read_b64_tr_b16 a[2:3], v12 offset:9216
    s_add_u32 m0, s60, 67584
    s_nop 0
    buffer_load_dwordx4 v4, s[36:39], s61 offen lds
    s_waitcnt lgkmcnt(7)
    v_mfma_f32_32x32x16_bf16 v[80:95], a[68:71], a[112:115], v[80:95]
    ds_read_b64_tr_b16 a[4:5], v13 offset:8192
    ds_read_b64_tr_b16 a[6:7], v13 offset:9216
    s_waitcnt lgkmcnt(7)
    v_mfma_f32_32x32x16_bf16 v[96:111], a[72:75], a[112:115], v[96:111]
    ds_read_b64_tr_b16 a[8:9], v14 offset:8192
    ds_read_b64_tr_b16 a[10:11], v14 offset:9216
    s_add_u32 m0, s60, 68608
    s_nop 0
    buffer_load_dwordx4 v5, s[36:39], s61 offen lds
    s_waitcnt lgkmcnt(7)
    v_mfma_f32_32x32x16_bf16 v[112:127], a[76:79], a[112:115], v[112:127]
    ds_read_b64_tr_b16 a[12:13], v15 offset:8192
    ds_read_b64_tr_b16 a[14:15], v15 offset:9216
    s_waitcnt lgkmcnt(6)
    v_mfma_f32_32x32x16_bf16 v[64:79], a[0:3], a[48:51], v[64:79]
    ds_read_b128 a[112:115], v11
    ds_read_b64_tr_b16 a[64:65], v12 offset:12288
    ds_read_b64_tr_b16 a[66:67], v12 offset:13312
    s_lshl_b32 s61, s59, 6
    s_lshl_b32 s62, s45, 4
    s_add_u32 s61, s61, s62
    s_mul_i32 s61, s61, 8192
    s_add_u32 s62, s61, s56
    s_add_u32 m0, s60, 81920
    s_add_u32 s63, s62, 0
    buffer_load_dwordx4 v6, s[84:87], s63 offen lds
    s_waitcnt lgkmcnt(7)
    v_mfma_f32_32x32x16_bf16 v[80:95], a[4:7], a[48:51], v[80:95]
    ds_read_b64_tr_b16 a[68:69], v13 offset:12288
    ds_read_b64_tr_b16 a[70:71], v13 offset:13312
    s_waitcnt lgkmcnt(7)
    v_mfma_f32_32x32x16_bf16 v[96:111], a[8:11], a[48:51], v[96:111]
    ds_read_b64_tr_b16 a[72:73], v14 offset:12288
    ds_read_b64_tr_b16 a[74:75], v14 offset:13312
    s_add_u32 m0, s60, 82944
    s_add_u32 s63, s62, 32768
    buffer_load_dwordx4 v6, s[84:87], s63 offen lds
    s_waitcnt lgkmcnt(7)
    v_mfma_f32_32x32x16_bf16 v[112:127], a[12:15], a[48:51], v[112:127]
    ds_read_b64_tr_b16 a[76:77], v15 offset:12288
    ds_read_b64_tr_b16 a[78:79], v15 offset:13312
    s_waitcnt lgkmcnt(6)
    v_mfma_f32_32x32x16_bf16 v[64:79], a[64:67], a[112:115], v[64:79]
    s_add_u32 m0, s60, 83968
    s_add_u32 s63, s62, 65536
    buffer_load_dwordx4 v6, s[84:87], s63 offen lds
    s_waitcnt lgkmcnt(4)
    v_mfma_f32_32x32x16_bf16 v[80:95], a[68:71], a[112:115], v[80:95]
    s_waitcnt lgkmcnt(2)
    v_mfma_f32_32x32x16_bf16 v[96:111], a[72:75], a[112:115], v[96:111]
    s_add_u32 m0, s60, 84992
    s_add_u32 s63, s62, 98304
    buffer_load_dwordx4 v6, s[84:87], s63 offen lds
    s_waitcnt lgkmcnt(0)
    v_mfma_f32_32x32x16_bf16 v[112:127], a[76:79], a[112:115], v[112:127]
    v_add_u32 v8, 0xfffe8000, v8
    v_add_u32 v12, 0xfffe8000, v12
    v_add_u32 v9, 0xfffe8000, v9
    v_add_u32 v13, 0xfffe8000, v13
    v_add_u32 v10, 0xfffe8000, v10
    v_add_u32 v14, 0xfffe8000, v14
    v_add_u32 v11, 0xfffe8000, v11
    v_add_u32 v15, 0xfffe8000, v15
    s_cmp_lt_u32 s100, 10
    s_cbranch_scc1 L_gl_bsk
    s_waitcnt vmcnt(0)
    s_nop 15
    s_lshl_b32 s60, s53, 2
    s_add_u32 s60, s60, s45
    s_lshl_b32 s60, s60, 5
    s_add_u32 s60, s60, s54
    s_lshl_b32 s60, s60, 13
    v_bfe_u32 v24, v1, 4, 1
    v_and_b32 v25, 15, v1
    v_lshrrev_b32 v26, 5, v1
    s_add_u32 s61, s60, 0x1000000
    v_lshlrev_b32 v24, 12, v24
    v_lshl_add_u32 v24, v25, 4, v24
    v_lshl_add_u32 v24, v26, 8, v24
    v_cvt_pk_bf16_f32 v64, v64, v65
    v_cvt_pk_bf16_f32 v65, v66, v67
    v_cvt_pk_bf16_f32 v66, v68, v69
    v_cvt_pk_bf16_f32 v67, v70, v71
    v_cvt_pk_bf16_f32 v68, v72, v73
    v_cvt_pk_bf16_f32 v69, v74, v75
    v_cvt_pk_bf16_f32 v70, v76, v77
    v_cvt_pk_bf16_f32 v71, v78, v79
    s_nop 1
    v_permlane32_swap_b32 v64, v66
    v_permlane32_swap_b32 v65, v67
    v_permlane32_swap_b32 v68, v70
    v_permlane32_swap_b32 v69, v71
    s_nop 0
    buffer_store_dwordx4 v[64:67], v24, s[32:35], s61 offen offset:0 sc1
    buffer_store_dwordx4 v[68:71], v24, s[32:35], s61 offen offset:512 sc1
    v_cvt_pk_bf16_f32 v80, v80, v81
    v_cvt_pk_bf16_f32 v81, v82, v83
    v_cvt_pk_bf16_f32 v82, v84, v85
    v_cvt_pk_bf16_f32 v83, v86, v87
    v_cvt_pk_bf16_f32 v84, v88, v89
    v_cvt_pk_bf16_f32 v85, v90, v91
    v_cvt_pk_bf16_f32 v86, v92, v93
    v_cvt_pk_bf16_f32 v87, v94, v95
    s_nop 1
    v_permlane32_swap_b32 v80, v82
    v_permlane32_swap_b32 v81, v83
    v_permlane32_swap_b32 v84, v86
    v_permlane32_swap_b32 v85, v87
    s_nop 0
    buffer_store_dwordx4 v[80:83], v24, s[32:35], s61 offen offset:1024 sc1
    buffer_store_dwordx4 v[84:87], v24, s[32:35], s61 offen offset:1536 sc1
    v_cvt_pk_bf16_f32 v96, v96, v97
    v_cvt_pk_bf16_f32 v97, v98, v99
    v_cvt_pk_bf16_f32 v98, v100, v101
    v_cvt_pk_bf16_f32 v99, v102, v103
    v_cvt_pk_bf16_f32 v100, v104, v105
    v_cvt_pk_bf16_f32 v101, v106, v107
    v_cvt_pk_bf16_f32 v102, v108, v109
    v_cvt_pk_bf16_f32 v103, v110, v111
    s_nop 1
    v_permlane32_swap_b32 v96, v98
    v_permlane32_swap_b32 v97, v99
    v_permlane32_swap_b32 v100, v102
    v_permlane32_swap_b32 v101, v103
    s_nop 0
    buffer_store_dwordx4 v[96:99], v24, s[32:35], s61 offen offset:2048 sc1
    buffer_store_dwordx4 v[100:103], v24, s[32:35], s61 offen offset:2560 sc1
    v_cvt_pk_bf16_f32 v112, v112, v113
    v_cvt_pk_bf16_f32 v113, v114, v115
    v_cvt_pk_bf16_f32 v114, v116, v117
    v_cvt_pk_bf16_f32 v115, v118, v119
    v_cvt_pk_bf16_f32 v116, v120, v121
    v_cvt_pk_bf16_f32 v117, v122, v123
    v_cvt_pk_bf16_f32 v118, v124, v125
    v_cvt_pk_bf16_f32 v119, v126, v127
    s_nop 1
    v_permlane32_swap_b32 v112, v114
    v_permlane32_swap_b32 v113, v115
    v_permlane32_swap_b32 v116, v118
    v_permlane32_swap_b32 v117, v119
    s_nop 0
    buffer_store_dwordx4 v[112:115], v24, s[32:35], s61 offen offset:3072 sc1
    buffer_store_dwordx4 v[116:119], v24, s[32:35], s61 offen offset:3584 sc1
    s_branch L_bs_done
L_bs_q:
    v_mov_b64 v[64:65], 0
    v_mov_b64 v[66:67], 0
    v_mov_b64 v[68:69], 0
    v_mov_b64 v[70:71], 0
    v_mov_b64 v[72:73], 0
    v_mov_b64 v[74:75], 0
    v_mov_b64 v[76:77], 0
    v_mov_b64 v[78:79], 0
    v_mov_b64 v[80:81], 0
    v_mov_b64 v[82:83], 0
    v_mov_b64 v[84:85], 0
    v_mov_b64 v[86:87], 0
    v_mov_b64 v[88:89], 0
    v_mov_b64 v[90:91], 0
    v_mov_b64 v[92:93], 0
    v_mov_b64 v[94:95], 0
    v_mov_b64 v[96:97], 0
    v_mov_b64 v[98:99], 0
    v_mov_b64 v[100:101], 0
    v_mov_b64 v[102:103], 0
    v_mov_b64 v[104:105], 0
    v_mov_b64 v[106:107], 0
    v_mov_b64 v[108:109], 0
    v_mov_b64 v[110:111], 0
    v_mov_b64 v[112:113], 0
    v_mov_b64 v[114:115], 0
    v_mov_b64 v[116:117], 0
    v_mov_b64 v[118:119], 0
    v_mov_b64 v[120:121], 0
    v_mov_b64 v[122:123], 0
    v_mov_b64 v[124:125], 0
    v_mov_b64 v[126:127], 0
    s_mov_b32 s59, 0
    s_lshl_b32 s60, s45, 12
    s_lshl_b32 s61, s59, 7
    s_add_u32 s61, s61, s55
    s_add_u32 m0, s60, 0
    s_nop 0
    buffer_load_dwordx4 v2, s[36:39], s61 offen lds
    s_add_u32 m0, s60, 1024
    s_nop 0
    buffer_load_dwordx4 v3, s[36:39], s61 offen lds
    s_add_u32 m0, s60, 2048
    s_nop 0
    buffer_load_dwordx4 v4, s[36:39], s61 offen lds
    s_add_u32 m0, s60, 3072
    s_nop 0
    buffer_load_dwordx4 v5, s[36:39], s61 offen lds
    s_lshl_b32 s61, s59, 6
    s_lshl_b32 s62, s45, 4
    s_add_u32 s61, s61, s62
    s_mul_i32 s61, s61, 8192
    s_add_u32 s62, s61, s56
    s_add_u32 m0, s60, 16384
    s_add_u32 s63, s62, 0
    buffer_load_dwordx4 v6, s[80:83], s63 offen lds
    s_add_u32 m0, s60, 17408
    s_add_u32 s63, s62, 32768
    buffer_load_dwordx4 v6, s[80:83], s63 offen lds
    s_add_u32 m0, s60, 18432
    s_add_u32 s63, s62, 65536
    buffer_load_dwordx4 v6, s[80:83], s63 offen lds
    s_add_u32 m0, s60, 19456
    s_add_u32 s63, s62, 98304
    buffer_load_dwordx4 v6, s[80:83], s63 offen lds
    s_mov_b32 s59, 1
    s_lshl_b32 s60, s45, 12
    s_lshl_b32 s61, s59, 7
    s_add_u32 s61, s61, s55
    s_add_u32 m0, s60, 32768
    s_nop 0
    buffer_load_dwordx4 v2, s[36:39], s61 offen lds
    s_add_u32 m0, s60, 33792
    s_nop 0
    buffer_load_dwordx4 v3, s[36:39], s61 offen lds
    s_add_u32 m0, s60, 34816
    s_nop 0
    buffer_load_dwordx4 v4, s[36:39], s61 offen lds
    s_add_u32 m0, s60, 35840
    s_nop 0
    buffer_load_dwordx4 v5, s[36:39], s61 offen lds
    s_lshl_b32 s61, s59, 6
    s_lshl_b32 s62, s45, 4
    s_add_u32 s61, s61, s62
    s_mul_i32 s61, s61, 8192
    s_add_u32 s62, s61, s56
    s_add_u32 m0, s60, 49152
    s_add_u32 s63, s62, 0
    buffer_load_dwordx4 v6, s[80:83], s63 offen lds
    s_add_u32 m0, s60, 50176
    s_add_u32 s63, s62, 32768
    buffer_load_dwordx4 v6, s[80:83], s63 offen lds
    s_add_u32 m0, s60, 51200
    s_add_u32 s63, s62, 65536
    buffer_load_dwordx4 v6, s[80:83], s63 offen lds
    s_add_u32 m0, s60, 52224
    s_add_u32 s63, s62, 98304
    buffer_load_dwordx4 v6, s[80:83], s63 offen lds
    s_mov_b32 s59, 2
    s_lshl_b32 s60, s45, 12
    s_lshl_b32 s61, s59, 7
    s_add_u32 s61, s61, s55
    s_add_u32 m0, s60, 65536
    s_nop 0
    buffer_load_dwordx4 v2, s[36:39], s61 offen lds
    s_add_u32 m0, s60, 66560
    s_nop 0
    buffer_load_dwordx4 v3, s[36:39], s61 offen lds
    s_add_u32 m0, s60, 67584
    s_nop 0
    buffer_load_dwordx4 v4, s[36:39], s61 offen lds
    s_add_u32 m0, s60, 68608
    s_nop 0
    buffer_load_dwordx4 v5, s[36:39], s61 offen lds
    s_lshl_b32 s61, s59, 6
    s_lshl_b32 s62, s45, 4
    s_add_u32 s61, s61, s62
    s_mul_i32 s61, s61, 8192
    s_add_u32 s62, s61, s56
    s_add_u32 m0, s60, 81920
    s_add_u32 s63, s62, 0
    buffer_load_dwordx4 v6, s[80:83], s63 offen lds
    s_add_u32 m0, s60, 82944
    s_add_u32 s63, s62, 32768
    buffer_load_dwordx4 v6, s[80:83], s63 offen lds
    s_add_u32 m0, s60, 83968
    s_add_u32 s63, s62, 65536
    buffer_load_dwordx4 v6, s[80:83], s63 offen lds
    s_add_u32 m0, s60, 84992
    s_add_u32 s63, s62, 98304
    buffer_load_dwordx4 v6, s[80:83], s63 offen lds
    s_mov_b32 s100, 2
L_gl_bsq:
    s_waitcnt vmcnt(16)
L_gl_bsq_in:
    s_barrier
    ds_read_b128 a[48:51], v8
    ds_read_b64_tr_b16 a[0:1], v12 offset:0
    ds_read_b64_tr_b16 a[2:3], v12 offset:1024
    ds_read_b64_tr_b16 a[4:5], v13 offset:0
    ds_read_b64_tr_b16 a[6:7], v13 offset:1024
    ds_read_b64_tr_b16 a[8:9], v14 offset:0
    ds_read_b64_tr_b16 a[10:11], v14 offset:1024
    ds_read_b64_tr_b16 a[12:13], v15 offset:0
    ds_read_b64_tr_b16 a[14:15], v15 offset:1024
    s_add_u32 s100, s100, 1
    s_min_u32 s59, s100, 7
    s_waitcnt lgkmcnt(6)
    v_mfma_f32_32x32x16_bf16 v[64:79], a[0:3], a[48:51], v[64:79]
    ds_read_b128 a[112:115], v9
    ds_read_b64_tr_b16 a[64:65], v12 offset:4096
    ds_read_b64_tr_b16 a[66:67], v12 offset:5120
    s_lshl_b32 s60, s45, 12
    s_lshl_b32 s61, s59, 7
    s_add_u32 s61, s61, s55
    s_add_u32 m0, s60, 98304
    s_nop 0
    buffer_load_dwordx4 v2, s[36:39], s61 offen lds
    s_waitcnt lgkmcnt(7)
    v_mfma_f32_32x32x16_bf16 v[80:95], a[4:7], a[48:51], v[80:95]
    ds_read_b64_tr_b16 a[68:69], v13 offset:4096
    ds_read_b64_tr_b16 a[70:71], v13 offset:5120
    s_waitcnt lgkmcnt(7)
    v_mfma_f32_32x32x16_bf16 v[96:111], a[8:11], a[48:51], v[96:111]
    ds_read_b64_tr_b16 a[72:73], v14 offset:4096
    ds_read_b64_tr_b16 a[74:75], v14 offset:5120
    s_add_u32 m0, s60, 99328
    s_nop 0
    buffer_load_dwordx4 v3, s[36:39], s61 offen lds
    s_waitcnt lgkmcnt(7)
    v_mfma_f32_32x32x16_bf16 v[112:127], a[12:15], a[48:51], v[112:127]
    ds_read_b64_tr_b16 a[76:77], v15 offset:4096
    ds_read_b64_tr_b16 a[78:79], v15 offset:5120
    s_waitcnt lgkmcnt(6)
    v_mfma_f32_32x32x16_bf16 v[64:79], a[64:67], a[112:115], v[64:79]
    ds_read_b128 a[48:51], v10
    ds_read_b64_tr_b16 a[0:1], v12 offset:8192
    ds_read_b64_tr_b16 a[2:3], v12 offset:9216
    s_add_u32 m0, s60, 100352
    s_nop 0
    buffer_load_dwordx4 v4, s[36:39], s61 offen lds
    s_waitcnt lgkmcnt(7)
    v_mfma_f32_32x32x16_bf16 v[80:95], a[68:71], a[112:115], v[80:95]
    ds_read_b64_tr_b16 a[4:5], v13 offset:8192
    ds_read_b64_tr_b16 a[6:7], v13 offset:9216
    s_waitcnt lgkmcnt(7)
    v_mfma_f32_32x32x16_bf16 v[96:111], a[72:75], a[112:115], v[96:111]
    ds_read_b64_tr_b16 a[8:9], v14 offset:8192
    ds_read_b64_tr_b16 a[10:11], v14 offset:9216
    s_add_u32 m0, s60, 101376
    s_nop 0
    buffer_load_dwordx4 v5, s[36:39], s61 offen lds
    s_waitcnt lgkmcnt(7)
    v_mfma_f32_32x32x16_bf16 v[112:127], a[76:79], a[112:115], v[112:127]
    ds_read_b64_tr_b16 a[12:13], v15 offset:8192
    ds_read_b64_tr_b16 a[14:15], v15 offset:9216
    s_waitcnt lgkmcnt(6)
    v_mfma_f32_32x32x16_bf16 v[64:79], a[0:3], a[48:51], v[64:79]
    ds_read_b128 a[112:115], v11
    ds_read_b64_tr_b16 a[64:65], v12 offset:12288
    ds_read_b64_tr_b16 a[66:67], v12 offset:13312
    s_lshl_b32 s61, s59, 6
    s_lshl_b32 s62, s45, 4
    s_add_u32 s61, s61, s62
    s_mul_i32 s61, s61, 8192
    s_add_u32 s62, s61, s56
    s_add_u32 m0, s60, 114688
    s_add_u32 s63, s62, 0
    buffer_load_dwordx4 v6, s[80:83], s63 offen lds
    s_waitcnt lgkmcnt(7)
    v_mfma_f32_32x32x16_bf16 v[80:95], a[4:7], a[48:51], v[80:95]
    ds_read_b64_tr_b16 a[68:69], v13 offset:12288
    ds_read_b64_tr_b16 a[70:71], v13 offset:13312
    s_waitcnt lgkmcnt(7)
    v_mfma_f32_32x32x16_bf16 v[96:111], a[8:11], a[48:51], v[96:111]
    ds_read_b64_tr_b16 a[72:73], v14 offset:12288
    ds_read_b64_tr_b16 a[74:75], v14 offset:13312
    s_add_u32 m0, s60, 115712
    s_add_u32 s63, s62, 32768
    buffer_load_dwordx4 v6, s[80:83], s63 offen lds
    s_waitcnt lgkmcnt(7)
    v_mfma_f32_32x32x16_bf16 v[112:127], a[12:15], a[48:51], v[112:127]
    ds_read_b64_tr_b16 a[76:77], v15 offset:12288
    ds_read_b64_tr_b16 a[78:79], v15 offset:13312
    s_waitcnt lgkmcnt(6)
    v_mfma_f32_32x32x16_bf16 v[64:79], a[64:67], a[112:115], v[64:79]
    s_add_u32 m0, s60, 116736
    s_add_u32 s63, s62, 65536
    buffer_load_dwordx4 v6, s[80:83], s63 offen lds
    s_waitcnt lgkmcnt(4)
    v_mfma_f32_32x32x16_bf16 v[80:95], a[68:71], a[112:115], v[80:95]
    s_waitcnt lgkmcnt(2)
    v_mfma_f32_32x32x16_bf16 v[96:111], a[72:75], a[112:115], v[96:111]
    s_add_u32 m0, s60, 117760
    s_add_u32 s63, s62, 98304
    buffer_load_dwordx4 v6, s[80:83], s63 offen lds
    s_waitcnt lgkmcnt(0)
    v_mfma_f32_32x32x16_bf16 v[112:127], a[76:79], a[112:115], v[112:127]
    v_add_u32 v8, 0x8000, v8
    v_add_u32 v12, 0x8000, v12
    v_add_u32 v9, 0x8000, v9
    v_add_u32 v13, 0x8000, v13
    v_add_u32 v10, 0x8000, v10
    v_add_u32 v14, 0x8000, v14
    v_add_u32 v11, 0x8000, v11
    v_add_u32 v15, 0x8000, v15
    s_waitcnt vmcnt(16)
    s_barrier
    ds_read_b128 a[48:51], v8
    ds_read_b64_tr_b16 a[0:1], v12 offset:0
    ds_read_b64_tr_b16 a[2:3], v12 offset:1024
    ds_read_b64_tr_b16 a[4:5], v13 offset:0
    ds_read_b64_tr_b16 a[6:7], v13 offset:1024
    ds_read_b64_tr_b16 a[8:9], v14 offset:0
    ds_read_b64_tr_b16 a[10:11], v14 offset:1024
    ds_read_b64_tr_b16 a[12:13], v15 offset:0
    ds_read_b64_tr_b16 a[14:15], v15 offset:1024
    s_add_u32 s100, s100, 1
    s_min_u32 s59, s100, 7
    s_waitcnt lgkmcnt(6)
    v_mfma_f32_32x32x16_bf16 v[64:79], a[0:3], a[48:51], v[64:79]
    ds_read_b128 a[112:115], v9
    ds_read_b64_tr_b16 a[64:65], v12 offset:4096
    ds_read_b64_tr_b16 a[66:67], v12 offset:5120
    s_lshl_b32 s60, s45, 12
    s_lshl_b32 s61, s59, 7
    s_add_u32 s61, s61, s55
    s_add_u32 m0, s60, 0
    s_nop 0
    buffer_load_dwordx4 v2, s[36:39], s61 offen lds
    s_waitcnt lgkmcnt(7)
    v_mfma_f32_32x32x16_bf16 v[80:95], a[4:7], a[48:51], v[80:95]
    ds_read_b64_tr_b16 a[68:69], v13 offset:4096
    ds_read_b64_tr_b16 a[70:71], v13 offset:5120
    s_waitcnt lgkmcnt(7)
    v_mfma_f32_32x32x16_bf16 v[96:111], a[8:11], a[48:51], v[96:111]
    ds_read_b64_tr_b16 a[72:73], v14 offset:4096
    ds_read_b64_tr_b16 a[74:75], v14 offset:5120
    s_add_u32 m0, s60, 1024
    s_nop 0
    buffer_load_dwordx4 v3, s[36:39], s61 offen lds
    s_waitcnt lgkmcnt(7)
    v_mfma_f32_32x32x16_bf16 v[112:127], a[12:15], a[48:51], v[112:127]
    ds_read_b64_tr_b16 a[76:77], v15 offset:4096
    ds_read_b64_tr_b16 a[78:79], v15 offset:5120
    s_waitcnt lgkmcnt(6)
    v_mfma_f32_32x32x16_bf16 v[64:79], a[64:67], a[112:115], v[64:79]
    ds_read_b128 a[48:51], v10
    ds_read_b64_tr_b16 a[0:1], v12 offset:8192
    ds_read_b64_tr_b16 a[2:3], v12 offset:9216
    s_add_u32 m0, s60, 2048
    s_nop 0
    buffer_load_dwordx4 v4, s[36:39], s61 offen lds
    s_waitcnt lgkmcnt(7)
    v_mfma_f32_32x32x16_bf16 v[80:95], a[68:71], a[112:115], v[80:95]
    ds_read_b64_tr_b16 a[4:5], v13 offset:8192
    ds_read_b64_tr_b16 a[6:7], v13 offset:9216
    s_waitcnt lgkmcnt(7)
    v_mfma_f32_32x32x16_bf16 v[96:111], a[72:75], a[112:115], v[96:111]
    ds_read_b64_tr_b16 a[8:9], v14 offset:8192
    ds_read_b64_tr_b16 a[10:11], v14 offset:9216
    s_add_u32 m0, s60, 3072
    s_nop 0
    buffer_load_dwordx4 v5, s[36:39], s61 offen lds
    s_waitcnt lgkmcnt(7)
    v_mfma_f32_32x32x16_bf16 v[112:127], a[76:79], a[112:115], v[112:127]
    ds_read_b64_tr_b16 a[12:13], v15 offset:8192
    ds_read_b64_tr_b16 a[14:15], v15 offset:9216
    s_waitcnt lgkmcnt(6)
    v_mfma_f32_32x32x16_bf16 v[64:79], a[0:3], a[48:51], v[64:79]
    ds_read_b128 a[112:115], v11
    ds_read_b64_tr_b16 a[64:65], v12 offset:12288
    ds_read_b64_tr_b16 a[66:67], v12 offset:13312
    s_lshl_b32 s61, s59, 6
    s_lshl_b32 s62, s45, 4
    s_add_u32 s61, s61, s62
    s_mul_i32 s61, s61, 8192
    s_add_u32 s62, s61, s56
    s_add_u32 m0, s60, 16384
    s_add_u32 s63, s62, 0
    buffer_load_dwordx4 v6, s[80:83], s63 offen lds
    s_waitcnt lgkmcnt(7)
    v_mfma_f32_32x32x16_bf16 v[80:95], a[4:7], a[48:51], v[80:95]
    ds_read_b64_tr_b16 a[68:69], v13 offset:12288
    ds_read_b64_tr_b16 a[70:71], v13 offset:13312
    s_waitcnt lgkmcnt(7)
    v_mfma_f32_32x32x16_bf16 v[96:111], a[8:11], a[48:51], v[96:111]
    ds_read_b64_tr_b16 a[72:73], v14 offset:12288
    ds_read_b64_tr_b16 a[74:75], v14 offset:13312
    s_add_u32 m0, s60, 17408
    s_add_u32 s63, s62, 32768
    buffer_load_dwordx4 v6, s[80:83], s63 offen lds
    s_waitcnt lgkmcnt(7)
    v_mfma_f32_32x32x16_bf16 v[112:127], a[12:15], a[48:51], v[112:127]
    ds_read_b64_tr_b16 a[76:77], v15 offset:12288
    ds_read_b64_tr_b16 a[78:79], v15 offset:13312
    s_waitcnt lgkmcnt(6)
    v_mfma_f32_32x32x16_bf16 v[64:79], a[64:67], a[112:115], v[64:79]
    s_add_u32 m0, s60, 18432
    s_add_u32 s63, s62, 65536
    buffer_load_dwordx4 v6, s[80:83], s63 offen lds
    s_waitcnt lgkmcnt(4)
    v_mfma_f32_32x32x16_bf16 v[80:95], a[68:71], a[112:115], v[80:95]
    s_waitcnt lgkmcnt(2)
    v_mfma_f32_32x32x16_bf16 v[96:111], a[72:75], a[112:115], v[96:111]
    s_add_u32 m0, s60, 19456
    s_add_u32 s63, s62, 98304
    buffer_load_dwordx4 v6, s[80:83], s63 offen lds
    s_waitcnt lgkmcnt(0)
    v_mfma_f32_32x32x16_bf16 v[112:127], a[76:79], a[112:115], v[112:127]
    v_add_u32 v8, 0x8000, v8
    v_add_u32 v12, 0x8000, v12
    v_add_u32 v9, 0x8000, v9
    v_add_u32 v13, 0x8000, v13
    v_add_u32 v10, 0x8000, v10
    v_add_u32 v14, 0x8000, v14
    v_add_u32 v11, 0x8000, v11
    v_add_u32 v15, 0x8000, v15
    s_waitcnt vmcnt(16)
    s_barrier
    ds_read_b128 a[48:51], v8
    ds_read_b64_tr_b16 a[0:1], v12 offset:0
    ds_read_b64_tr_b16 a[2:3], v12 offset:1024
    ds_read_b64_tr_b16 a[4:5], v13 offset:0
    ds_read_b64_tr_b16 a[6:7], v13 offset:1024
    ds_read_b64_tr_b16 a[8:9], v14 offset:0
    ds_read_b64_tr_b16 a[10:11], v14 offset:1024
    ds_read_b64_tr_b16 a[12:13], v15 offset:0
    ds_read_b64_tr_b16 a[14:15], v15 offset:1024
    s_add_u32 s100, s100, 1
    s_min_u32 s59, s100, 7
    s_waitcnt lgkmcnt(6)
    v_mfma_f32_32x32x16_bf16 v[64:79], a[0:3], a[48:51], v[64:79]
    ds_read_b128 a[112:115], v9
    ds_read_b64_tr_b16 a[64:65], v12 offset:4096
    ds_read_b64_tr_b16 a[66:67], v12 offset:5120
    s_lshl_b32 s60, s45, 12
    s_lshl_b32 s61, s59, 7
    s_add_u32 s61, s61, s55
    s_add_u32 m0, s60, 32768
    s_nop 0
    buffer_load_dwordx4 v2, s[36:39], s61 offen lds
    s_waitcnt lgkmcnt(7)
    v_mfma_f32_32x32x16_bf16 v[80:95], a[4:7], a[48:51], v[80:95]
    ds_read_b64_tr_b16 a[68:69], v13 offset:4096
    ds_read_b64_tr_b16 a[70:71], v13 offset:5120
    s_waitcnt lgkmcnt(7)
    v_mfma_f32_32x32x16_bf16 v[96:111], a[8:11], a[48:51], v[96:111]
    ds_read_b64_tr_b16 a[72:73], v14 offset:4096
    ds_read_b64_tr_b16 a[74:75], v14 offset:5120
    s_add_u32 m0, s60, 33792
    s_nop 0
    buffer_load_dwordx4 v3, s[36:39], s61 offen lds
    s_waitcnt lgkmcnt(7)
    v_mfma_f32_32x32x16_bf16 v[112:127], a[12:15], a[48:51], v[112:127]
    ds_read_b64_tr_b16 a[76:77], v15 offset:4096
    ds_read_b64_tr_b16 a[78:79], v15 offset:5120
    s_waitcnt lgkmcnt(6)
    v_mfma_f32_32x32x16_bf16 v[64:79], a[64:67], a[112:115], v[64:79]
    ds_read_b128 a[48:51], v10
    ds_read_b64_tr_b16 a[0:1], v12 offset:8192
    ds_read_b64_tr_b16 a[2:3], v12 offset:9216
    s_add_u32 m0, s60, 34816
    s_nop 0
    buffer_load_dwordx4 v4, s[36:39], s61 offen lds
    s_waitcnt lgkmcnt(7)
    v_mfma_f32_32x32x16_bf16 v[80:95], a[68:71], a[112:115], v[80:95]
    ds_read_b64_tr_b16 a[4:5], v13 offset:8192
    ds_read_b64_tr_b16 a[6:7], v13 offset:9216
    s_waitcnt lgkmcnt(7)
    v_mfma_f32_32x32x16_bf16 v[96:111], a[72:75], a[112:115], v[96:111]
    ds_read_b64_tr_b16 a[8:9], v14 offset:8192
    ds_read_b64_tr_b16 a[10:11], v14 offset:9216
    s_add_u32 m0, s60, 35840
    s_nop 0
    buffer_load_dwordx4 v5, s[36:39], s61 offen lds
    s_waitcnt lgkmcnt(7)
    v_mfma_f32_32x32x16_bf16 v[112:127], a[76:79], a[112:115], v[112:127]
    ds_read_b64_tr_b16 a[12:13], v15 offset:8192
    ds_read_b64_tr_b16 a[14:15], v15 offset:9216
    s_waitcnt lgkmcnt(6)
    v_mfma_f32_32x32x16_bf16 v[64:79], a[0:3], a[48:51], v[64:79]
    ds_read_b128 a[112:115], v11
    ds_read_b64_tr_b16 a[64:65], v12 offset:12288
    ds_read_b64_tr_b16 a[66:67], v12 offset:13312
    s_lshl_b32 s61, s59, 6
    s_lshl_b32 s62, s45, 4
    s_add_u32 s61, s61, s62
    s_mul_i32 s61, s61, 8192
    s_add_u32 s62, s61, s56
    s_add_u32 m0, s60, 49152
    s_add_u32 s63, s62, 0
    buffer_load_dwordx4 v6, s[80:83], s63 offen lds
    s_waitcnt lgkmcnt(7)
    v_mfma_f32_32x32x16_bf16 v[80:95], a[4:7], a[48:51], v[80:95]
    ds_read_b64_tr_b16 a[68:69], v13 offset:12288
    ds_read_b64_tr_b16 a[70:71], v13 offset:13312
    s_waitcnt lgkmcnt(7)
    v_mfma_f32_32x32x16_bf16 v[96:111], a[8:11], a[48:51], v[96:111]
    ds_read_b64_tr_b16 a[72:73], v14 offset:12288
    ds_read_b64_tr_b16 a[74:75], v14 offset:13312
    s_add_u32 m0, s60, 50176
    s_add_u32 s63, s62, 32768
    buffer_load_dwordx4 v6, s[80:83], s63 offen lds
    s_waitcnt lgkmcnt(7)
    v_mfma_f32_32x32x16_bf16 v[112:127], a[12:15], a[48:51], v[112:127]
    ds_read_b64_tr_b16 a[76:77], v15 offset:12288
    ds_read_b64_tr_b16 a[78:79], v15 offset:13312
    s_waitcnt lgkmcnt(6)
    v_mfma_f32_32x32x16_bf16 v[64:79], a[64:67], a[112:115], v[64:79]
    s_add_u32 m0, s60, 51200
    s_add_u32 s63, s62, 65536
    buffer_load_dwordx4 v6, s[80:83], s63 offen lds
    s_waitcnt lgkmcnt(4)
    v_mfma_f32_32x32x16_bf16 v[80:95], a[68:71], a[112:115], v[80:95]
    s_waitcnt lgkmcnt(2)
    v_mfma_f32_32x32x16_bf16 v[96:111], a[72:75], a[112:115], v[96:111]
    s_add_u32 m0, s60, 52224
    s_add_u32 s63, s62, 98304
    buffer_load_dwordx4 v6, s[80:83], s63 offen lds
    s_waitcnt lgkmcnt(0)
    v_mfma_f32_32x32x16_bf16 v[112:127], a[76:79], a[112:115], v[112:127]
    v_add_u32 v8, 0x8000, v8
    v_add_u32 v12, 0x8000, v12
    v_add_u32 v9, 0x8000, v9
    v_add_u32 v13, 0x8000, v13
    v_add_u32 v10, 0x8000, v10
    v_add_u32 v14, 0x8000, v14
    v_add_u32 v11, 0x8000, v11
    v_add_u32 v15, 0x8000, v15
    s_waitcnt vmcnt(16)
    s_barrier
    ds_read_b128 a[48:51], v8
    ds_read_b64_tr_b16 a[0:1], v12 offset:0
    ds_read_b64_tr_b16 a[2:3], v12 offset:1024
    ds_read_b64_tr_b16 a[4:5], v13 offset:0
    ds_read_b64_tr_b16 a[6:7], v13 offset:1024
    ds_read_b64_tr_b16 a[8:9], v14 offset:0
    ds_read_b64_tr_b16 a[10:11], v14 offset:1024
    ds_read_b64_tr_b16 a[12:13], v15 offset:0
    ds_read_b64_tr_b16 a[14:15], v15 offset:1024
    s_add_u32 s100, s100, 1
    s_min_u32 s59, s100, 7
    s_waitcnt lgkmcnt(6)
    v_mfma_f32_32x32x16_bf16 v[64:79], a[0:3], a[48:51], v[64:79]
    ds_read_b128 a[112:115], v9
    ds_read_b64_tr_b16 a[64:65], v12 offset:4096
    ds_read_b64_tr_b16 a[66:67], v12 offset:5120
    s_lshl_b32 s60, s45, 12
    s_lshl_b32 s61, s59, 7
    s_add_u32 s61, s61, s55
    s_add_u32 m0, s60, 65536
    s_nop 0
    buffer_load_dwordx4 v2, s[36:39], s61 offen lds
    s_waitcnt lgkmcnt(7)
    v_mfma_f32_32x32x16_bf16 v[80:95], a[4:7], a[48:51], v[80:95]
    ds_read_b64_tr_b16 a[68:69], v13 offset:4096
    ds_read_b64_tr_b16 a[70:71], v13 offset:5120
    s_waitcnt lgkmcnt(7)
    v_mfma_f32_32x32x16_bf16 v[96:111], a[8:11], a[48:51], v[96:111]
    ds_read_b64_tr_b16 a[72:73], v14 offset:4096
    ds_read_b64_tr_b16 a[74:75], v14 offset:5120
    s_add_u32 m0, s60, 66560
    s_nop 0
    buffer_load_dwordx4 v3, s[36:39], s61 offen lds
    s_waitcnt lgkmcnt(7)
    v_mfma_f32_32x32x16_bf16 v[112:127], a[12:15], a[48:51], v[112:127]
    ds_read_b64_tr_b16 a[76:77], v15 offset:4096
    ds_read_b64_tr_b16 a[78:79], v15 offset:5120
    s_waitcnt lgkmcnt(6)
    v_mfma_f32_32x32x16_bf16 v[64:79], a[64:67], a[112:115], v[64:79]
    ds_read_b128 a[48:51], v10
    ds_read_b64_tr_b16 a[0:1], v12 offset:8192
    ds_read_b64_tr_b16 a[2:3], v12 offset:9216
    s_add_u32 m0, s60, 67584
    s_nop 0
    buffer_load_dwordx4 v4, s[36:39], s61 offen lds
    s_waitcnt lgkmcnt(7)
    v_mfma_f32_32x32x16_bf16 v[80:95], a[68:71], a[112:115], v[80:95]
    ds_read_b64_tr_b16 a[4:5], v13 offset:8192
    ds_read_b64_tr_b16 a[6:7], v13 offset:9216
    s_waitcnt lgkmcnt(7)
    v_mfma_f32_32x32x16_bf16 v[96:111], a[72:75], a[112:115], v[96:111]
    ds_read_b64_tr_b16 a[8:9], v14 offset:8192
    ds_read_b64_tr_b16 a[10:11], v14 offset:9216
    s_add_u32 m0, s60, 68608
    s_nop 0
    buffer_load_dwordx4 v5, s[36:39], s61 offen lds
    s_waitcnt lgkmcnt(7)
    v_mfma_f32_32x32x16_bf16 v[112:127], a[76:79], a[112:115], v[112:127]
    ds_read_b64_tr_b16 a[12:13], v15 offset:8192
    ds_read_b64_tr_b16 a[14:15], v15 offset:9216
    s_waitcnt lgkmcnt(6)
    v_mfma_f32_32x32x16_bf16 v[64:79], a[0:3], a[48:51], v[64:79]
    ds_read_b128 a[112:115], v11
    ds_read_b64_tr_b16 a[64:65], v12 offset:12288
    ds_read_b64_tr_b16 a[66:67], v12 offset:13312
    s_lshl_b32 s61, s59, 6
    s_lshl_b32 s62, s45, 4
    s_add_u32 s61, s61, s62
    s_mul_i32 s61, s61, 8192
    s_add_u32 s62, s61, s56
    s_add_u32 m0, s60, 81920
    s_add_u32 s63, s62, 0
    buffer_load_dwordx4 v6, s[80:83], s63 offen lds
    s_waitcnt lgkmcnt(7)
    v_mfma_f32_32x32x16_bf16 v[80:95], a[4:7], a[48:51], v[80:95]
    ds_read_b64_tr_b16 a[68:69], v13 offset:12288
    ds_read_b64_tr_b16 a[70:71], v13 offset:13312
    s_waitcnt lgkmcnt(7)
    v_mfma_f32_32x32x16_bf16 v[96:111], a[8:11], a[48:51], v[96:111]
    ds_read_b64_tr_b16 a[72:73], v14 offset:12288
    ds_read_b64_tr_b16 a[74:75], v14 offset:13312
    s_add_u32 m0, s60, 82944
    s_add_u32 s63, s62, 32768
    buffer_load_dwordx4 v6, s[80:83], s63 offen lds
    s_waitcnt lgkmcnt(7)
    v_mfma_f32_32x32x16_bf16 v[112:127], a[12:15], a[48:51], v[112:127]
    ds_read_b64_tr_b16 a[76:77], v15 offset:12288
    ds_read_b64_tr_b16 a[78:79], v15 offset:13312
    s_waitcnt lgkmcnt(6)
    v_mfma_f32_32x32x16_bf16 v[64:79], a[64:67], a[112:115], v[64:79]
    s_add_u32 m0, s60, 83968
    s_add_u32 s63, s62, 65536
    buffer_load_dwordx4 v6, s[80:83], s63 offen lds
    s_waitcnt lgkmcnt(4)
    v_mfma_f32_32x32x16_bf16 v[80:95], a[68:71], a[112:115], v[80:95]
    s_waitcnt lgkmcnt(2)
    v_mfma_f32_32x32x16_bf16 v[96:111], a[72:75], a[112:115], v[96:111]
    s_add_u32 m0, s60, 84992
    s_add_u32 s63, s62, 98304
    buffer_load_dwordx4 v6, s[80:83], s63 offen lds
    s_waitcnt lgkmcnt(0)
    v_mfma_f32_32x32x16_bf16 v[112:127], a[76:79], a[112:115], v[112:127]
    v_add_u32 v8, 0xfffe8000, v8
    v_add_u32 v12, 0xfffe8000, v12
    v_add_u32 v9, 0xfffe8000, v9
    v_add_u32 v13, 0xfffe8000, v13
    v_add_u32 v10, 0xfffe8000, v10
    v_add_u32 v14, 0xfffe8000, v14
    v_add_u32 v11, 0xfffe8000, v11
    v_add_u32 v15, 0xfffe8000, v15
    s_cmp_lt_u32 s100, 10
    s_cbranch_scc1 L_gl_bsq
    s_waitcnt vmcnt(0)
    s_nop 15
    s_lshl_b32 s60, s53, 2
    s_add_u32 s60, s60, s45
    s_lshl_b32 s60, s60, 5
    s_add_u32 s60, s60, s54
    s_lshl_b32 s60, s60, 13
    v_bfe_u32 v24, v1, 4, 1
    v_and_b32 v25, 15, v1
    v_lshrrev_b32 v26, 5, v1
    s_add_u32 s61, s60, 0x3000000
    v_lshlrev_b32 v24, 12, v24
    v_lshl_add_u32 v24, v25, 4, v24
    v_lshl_add_u32 v24, v26, 8, v24
    v_cvt_pk_bf16_f32 v64, v64, v65
    v_cvt_pk_bf16_f32 v65, v66, v67
    v_cvt_pk_bf16_f32 v66, v68, v69
    v_cvt_pk_bf16_f32 v67, v70, v71
    v_cvt_pk_bf16_f32 v68, v72, v73
    v_cvt_pk_bf16_f32 v69, v74, v75
    v_cvt_pk_bf16_f32 v70, v76, v77
    v_cvt_pk_bf16_f32 v71, v78, v79
    s_nop 1
    v_permlane32_swap_b32 v64, v66
    v_permlane32_swap_b32 v65, v67
    v_permlane32_swap_b32 v68, v70
    v_permlane32_swap_b32 v69, v71
    s_nop 0
    buffer_store_dwordx4 v[64:67], v24, s[32:35], s61 offen offset:0 sc1
    buffer_store_dwordx4 v[68:71], v24, s[32:35], s61 offen offset:512 sc1
    v_cvt_pk_bf16_f32 v80, v80, v81
    v_cvt_pk_bf16_f32 v81, v82, v83
    v_cvt_pk_bf16_f32 v82, v84, v85
    v_cvt_pk_bf16_f32 v83, v86, v87
    v_cvt_pk_bf16_f32 v84, v88, v89
    v_cvt_pk_bf16_f32 v85, v90, v91
    v_cvt_pk_bf16_f32 v86, v92, v93
    v_cvt_pk_bf16_f32 v87, v94, v95
    s_nop 1
    v_permlane32_swap_b32 v80, v82
    v_permlane32_swap_b32 v81, v83
    v_permlane32_swap_b32 v84, v86
    v_permlane32_swap_b32 v85, v87
    s_nop 0
    buffer_store_dwordx4 v[80:83], v24, s[32:35], s61 offen offset:1024 sc1
    buffer_store_dwordx4 v[84:87], v24, s[32:35], s61 offen offset:1536 sc1
    v_cvt_pk_bf16_f32 v96, v96, v97
    v_cvt_pk_bf16_f32 v97, v98, v99
    v_cvt_pk_bf16_f32 v98, v100, v101
    v_cvt_pk_bf16_f32 v99, v102, v103
    v_cvt_pk_bf16_f32 v100, v104, v105
    v_cvt_pk_bf16_f32 v101, v106, v107
    v_cvt_pk_bf16_f32 v102, v108, v109
    v_cvt_pk_bf16_f32 v103, v110, v111
    s_nop 1
    v_permlane32_swap_b32 v96, v98
    v_permlane32_swap_b32 v97, v99
    v_permlane32_swap_b32 v100, v102
    v_permlane32_swap_b32 v101, v103
    s_nop 0
    buffer_store_dwordx4 v[96:99], v24, s[32:35], s61 offen offset:2048 sc1
    buffer_store_dwordx4 v[100:103], v24, s[32:35], s61 offen offset:2560 sc1
    v_cvt_pk_bf16_f32 v112, v112, v113
    v_cvt_pk_bf16_f32 v113, v114, v115
    v_cvt_pk_bf16_f32 v114, v116, v117
    v_cvt_pk_bf16_f32 v115, v118, v119
    v_cvt_pk_bf16_f32 v116, v120, v121
    v_cvt_pk_bf16_f32 v117, v122, v123
    v_cvt_pk_bf16_f32 v118, v124, v125
    v_cvt_pk_bf16_f32 v119, v126, v127
    s_nop 1
    v_permlane32_swap_b32 v112, v114
    v_permlane32_swap_b32 v113, v115
    v_permlane32_swap_b32 v116, v118
    v_permlane32_swap_b32 v117, v119
    s_nop 0
    buffer_store_dwordx4 v[112:115], v24, s[32:35], s61 offen offset:3072 sc1
    buffer_store_dwordx4 v[116:119], v24, s[32:35], s61 offen offset:3584 sc1
    s_branch L_bs_done
L_bs_v:
    v_mov_b64 v[64:65], 0
    v_mov_b64 v[66:67], 0
    v_mov_b64 v[68:69], 0
    v_mov_b64 v[70:71], 0
    v_mov_b64 v[72:73], 0
    v_mov_b64 v[74:75], 0
    v_mov_b64 v[76:77], 0
    v_mov_b64 v[78:79], 0
    v_mov_b64 v[80:81], 0
    v_mov_b64 v[82:83], 0
    v_mov_b64 v[84:85], 0
    v_mov_b64 v[86:87], 0
    v_mov_b64 v[88:89], 0
    v_mov_b64 v[90:91], 0
    v_mov_b64 v[92:93], 0
    v_mov_b64 v[94:95], 0
    v_mov_b64 v[96:97], 0
    v_mov_b64 v[98:99], 0
    v_mov_b64 v[100:101], 0
    v_mov_b64 v[102:103], 0
    v_mov_b64 v[104:105], 0
    v_mov_b64 v[106:107], 0
    v_mov_b64 v[108:109], 0
    v_mov_b64 v[110:111], 0
    v_mov_b64 v[112:113], 0
    v_mov_b64 v[114:115], 0
    v_mov_b64 v[116:117], 0
    v_mov_b64 v[118:119], 0
    v_mov_b64 v[120:121], 0
    v_mov_b64 v[122:123], 0
    v_mov_b64 v[124:125], 0
    v_mov_b64 v[126:127], 0
    s_mov_b32 s59, 0
    s_lshl_b32 s60, s45, 12
    s_lshl_b32 s61, s59, 7
    s_add_u32 s61, s61, s55
    s_add_u32 m0, s60, 0
    s_nop 0
    buffer_load_dwordx4 v2, s[36:39], s61 offen lds
    s_add_u32 m0, s60, 1024
    s_nop 0
    buffer_load_dwordx4 v3, s[36:39], s61 offen lds
    s_add_u32 m0, s60, 2048
    s_nop 0
    buffer_load_dwordx4 v4, s[36:39], s61 offen lds
    s_add_u32 m0, s60, 3072
    s_nop 0
    buffer_load_dwordx4 v5, s[36:39], s61 offen lds
    s_lshl_b32 s61, s59, 6
    s_lshl_b32 s62, s45, 4
    s_add_u32 s61, s61, s62
    s_mul_i32 s61, s61, 8192
    s_add_u32 s62, s61, s56
    s_add_u32 m0, s60, 16384
    s_add_u32 s63, s62, 0
    buffer_load_dwordx4 v6, s[88:91], s63 offen lds
    s_add_u32 m0, s60, 17408
    s_add_u32 s63, s62, 32768
    buffer_load_dwordx4 v6, s[88:91], s63 offen lds
    s_add_u32 m0, s60, 18432
    s_add_u32 s63, s62, 65536
    buffer_load_dwordx4 v6, s[88:91], s63 offen lds
    s_add_u32 m0, s60, 19456
    s_add_u32 s63, s62, 98304
    buffer_load_dwordx4 v6, s[88:91], s63 offen lds
    s_mov_b32 s59, 1
    s_lshl_b32 s60, s45, 12
    s_lshl_b32 s61, s59, 7
    s_add_u32 s61, s61, s55
    s_add_u32 m0, s60, 32768
    s_nop 0
    buffer_load_dwordx4 v2, s[36:39], s61 offen lds
    s_add_u32 m0, s60, 33792
    s_nop 0
    buffer_load_dwordx4 v3, s[36:39], s61 offen lds
    s_add_u32 m0, s60, 34816
    s_nop 0
    buffer_load_dwordx4 v4, s[36:39], s61 offen lds
    s_add_u32 m0, s60, 35840
    s_nop 0
    buffer_load_dwordx4 v5, s[36:39], s61 offen lds
    s_lshl_b32 s61, s59, 6
    s_lshl_b32 s62, s45, 4
    s_add_u32 s61, s61, s62
    s_mul_i32 s61, s61, 8192
    s_add_u32 s62, s61, s56
    s_add_u32 m0, s60, 49152
    s_add_u32 s63, s62, 0
    buffer_load_dwordx4 v6, s[88:91], s63 offen lds
    s_add_u32 m0, s60, 50176
    s_add_u32 s63, s62, 32768
    buffer_load_dwordx4 v6, s[88:91], s63 offen lds
    s_add_u32 m0, s60, 51200
    s_add_u32 s63, s62, 65536
    buffer_load_dwordx4 v6, s[88:91], s63 offen lds
    s_add_u32 m0, s60, 52224
    s_add_u32 s63, s62, 98304
    buffer_load_dwordx4 v6, s[88:91], s63 offen lds
    s_mov_b32 s59, 2
    s_lshl_b32 s60, s45, 12
    s_lshl_b32 s61, s59, 7
    s_add_u32 s61, s61, s55
    s_add_u32 m0, s60, 65536
    s_nop 0
    buffer_load_dwordx4 v2, s[36:39], s61 offen lds
    s_add_u32 m0, s60, 66560
    s_nop 0
    buffer_load_dwordx4 v3, s[36:39], s61 offen lds
    s_add_u32 m0, s60, 67584
    s_nop 0
    buffer_load_dwordx4 v4, s[36:39], s61 offen lds
    s_add_u32 m0, s60, 68608
    s_nop 0
    buffer_load_dwordx4 v5, s[36:39], s61 offen lds
    s_lshl_b32 s61, s59, 6
    s_lshl_b32 s62, s45, 4
    s_add_u32 s61, s61, s62
    s_mul_i32 s61, s61, 8192
    s_add_u32 s62, s61, s56
    s_add_u32 m0, s60, 81920
    s_add_u32 s63, s62, 0
    buffer_load_dwordx4 v6, s[88:91], s63 offen lds
    s_add_u32 m0, s60, 82944
    s_add_u32 s63, s62, 32768
    buffer_load_dwordx4 v6, s[88:91], s63 offen lds
    s_add_u32 m0, s60, 83968
    s_add_u32 s63, s62, 65536
    buffer_load_dwordx4 v6, s[88:91], s63 offen lds
    s_add_u32 m0, s60, 84992
    s_add_u32 s63, s62, 98304
    buffer_load_dwordx4 v6, s[88:91], s63 offen lds
    s_mov_b32 s100, 2
L_gl_bsv:
    s_waitcnt vmcnt(16)
L_gl_bsv_in:
    s_barrier
    ds_read_b128 a[48:51], v8
    ds_read_b64_tr_b16 a[0:1], v12 offset:0
    ds_read_b64_tr_b16 a[2:3], v12 offset:1024
    ds_read_b64_tr_b16 a[4:5], v13 offset:0
    ds_read_b64_tr_b16 a[6:7], v13 offset:1024
    ds_read_b64_tr_b16 a[8:9], v14 offset:0
    ds_read_b64_tr_b16 a[10:11], v14 offset:1024
    ds_read_b64_tr_b16 a[12:13], v15 offset:0
    ds_read_b64_tr_b16 a[14:15], v15 offset:1024
    s_add_u32 s100, s100, 1
    s_min_u32 s59, s100, 7
    s_waitcnt lgkmcnt(6)
    v_mfma_f32_32x32x16_bf16 v[64:79], a[48:51], a[0:3], v[64:79]
    ds_read_b128 a[112:115], v9
    ds_read_b64_tr_b16 a[64:65], v12 offset:4096
    ds_read_b64_tr_b16 a[66:67], v12 offset:5120
    s_lshl_b32 s60, s45, 12
    s_lshl_b32 s61, s59, 7
    s_add_u32 s61, s61, s55
    s_add_u32 m0, s60, 98304
    s_nop 0
    buffer_load_dwordx4 v2, s[36:39], s61 offen lds
    s_waitcnt lgkmcnt(7)
    v_mfma_f32_32x32x16_bf16 v[80:95], a[48:51], a[4:7], v[80:95]
    ds_read_b64_tr_b16 a[68:69], v13 offset:4096
    ds_read_b64_tr_b16 a[70:71], v13 offset:5120
    s_waitcnt lgkmcnt(7)
    v_mfma_f32_32x32x16_bf16 v[96:111], a[48:51], a[8:11], v[96:111]
    ds_read_b64_tr_b16 a[72:73], v14 offset:4096
    ds_read_b64_tr_b16 a[74:75], v14 offset:5120
    s_add_u32 m0, s60, 99328
    s_nop 0
    buffer_load_dwordx4 v3, s[36:39], s61 offen lds
    s_waitcnt lgkmcnt(7)
    v_mfma_f32_32x32x16_bf16 v[112:127], a[48:51], a[12:15], v[112:127]
    ds_read_b64_tr_b16 a[76:77], v15 offset:4096
    ds_read_b64_tr_b16 a[78:79], v15 offset:5120
    s_waitcnt lgkmcnt(6)
    v_mfma_f32_32x32x16_bf16 v[64:79], a[112:115], a[64:67], v[64:79]
    ds_read_b128 a[48:51], v10
    ds_read_b64_tr_b16 a[0:1], v12 offset:8192
    ds_read_b64_tr_b16 a[2:3], v12 offset:9216
    s_add_u32 m0, s60, 100352
    s_nop 0
    buffer_load_dwordx4 v4, s[36:39], s61 offen lds
    s_waitcnt lgkmcnt(7)
    v_mfma_f32_32x32x16_bf16 v[80:95], a[112:115], a[68:71], v[80:95]
    ds_read_b64_tr_b16 a[4:5], v13 offset:8192
    ds_read_b64_tr_b16 a[6:7], v13 offset:9216
    s_waitcnt lgkmcnt(7)
    v_mfma_f32_32x32x16_bf16 v[96:111], a[112:115], a[72:75], v[96:111]
    ds_read_b64_tr_b16 a[8:9], v14 offset:8192
    ds_read_b64_tr_b16 a[10:11], v14 offset:9216
    s_add_u32 m0, s60, 101376
    s_nop 0
    buffer_load_dwordx4 v5, s[36:39], s61 offen lds
    s_waitcnt lgkmcnt(7)
    v_mfma_f32_32x32x16_bf16 v[112:127], a[112:115], a[76:79], v[112:127]
    ds_read_b64_tr_b16 a[12:13], v15 offset:8192
    ds_read_b64_tr_b16 a[14:15], v15 offset:9216
    s_waitcnt lgkmcnt(6)
    v_mfma_f32_32x32x16_bf16 v[64:79], a[48:51], a[0:3], v[64:79]
    ds_read_b128 a[112:115], v11
    ds_read_b64_tr_b16 a[64:65], v12 offset:12288
    ds_read_b64_tr_b16 a[66:67], v12 offset:13312
    s_lshl_b32 s61, s59, 6
    s_lshl_b32 s62, s45, 4
    s_add_u32 s61, s61, s62
    s_mul_i32 s61, s61, 8192
    s_add_u32 s62, s61, s56
    s_add_u32 m0, s60, 114688
    s_add_u32 s63, s62, 0
    buffer_load_dwordx4 v6, s[88:91], s63 offen lds
    s_waitcnt lgkmcnt(7)
    v_mfma_f32_32x32x16_bf16 v[80:95], a[48:51], a[4:7], v[80:95]
    ds_read_b64_tr_b16 a[68:69], v13 offset:12288
    ds_read_b64_tr_b16 a[70:71], v13 offset:13312
    s_waitcnt lgkmcnt(7)
    v_mfma_f32_32x32x16_bf16 v[96:111], a[48:51], a[8:11], v[96:111]
    ds_read_b64_tr_b16 a[72:73], v14 offset:12288
    ds_read_b64_tr_b16 a[74:75], v14 offset:13312
    s_add_u32 m0, s60, 115712
    s_add_u32 s63, s62, 32768
    buffer_load_dwordx4 v6, s[88:91], s63 offen lds
    s_waitcnt lgkmcnt(7)
    v_mfma_f32_32x32x16_bf16 v[112:127], a[48:51], a[12:15], v[112:127]
    ds_read_b64_tr_b16 a[76:77], v15 offset:12288
    ds_read_b64_tr_b16 a[78:79], v15 offset:13312
    s_waitcnt lgkmcnt(6)
    v_mfma_f32_32x32x16_bf16 v[64:79], a[112:115], a[64:67], v[64:79]
    s_add_u32 m0, s60, 116736
    s_add_u32 s63, s62, 65536
    buffer_load_dwordx4 v6, s[88:91], s63 offen lds
    s_waitcnt lgkmcnt(4)
    v_mfma_f32_32x32x16_bf16 v[80:95], a[112:115], a[68:71], v[80:95]
    s_waitcnt lgkmcnt(2)
    v_mfma_f32_32x32x16_bf16 v[96:111], a[112:115], a[72:75], v[96:111]
    s_add_u32 m0, s60, 117760
    s_add_u32 s63, s62, 98304
    buffer_load_dwordx4 v6, s[88:91], s63 offen lds
    s_waitcnt lgkmcnt(0)
    v_mfma_f32_32x32x16_bf16 v[112:127], a[112:115], a[76:79], v[112:127]
    v_add_u32 v8, 0x8000, v8
    v_add_u32 v12, 0x8000, v12
    v_add_u32 v9, 0x8000, v9
    v_add_u32 v13, 0x8000, v13
    v_add_u32 v10, 0x8000, v10
    v_add_u32 v14, 0x8000, v14
    v_add_u32 v11, 0x8000, v11
    v_add_u32 v15, 0x8000, v15
    s_waitcnt vmcnt(16)
    s_barrier
    ds_read_b128 a[48:51], v8
    ds_read_b64_tr_b16 a[0:1], v12 offset:0
    ds_read_b64_tr_b16 a[2:3], v12 offset:1024
    ds_read_b64_tr_b16 a[4:5], v13 offset:0
    ds_read_b64_tr_b16 a[6:7], v13 offset:1024
    ds_read_b64_tr_b16 a[8:9], v14 offset:0
    ds_read_b64_tr_b16 a[10:11], v14 offset:1024
    ds_read_b64_tr_b16 a[12:13], v15 offset:0
    ds_read_b64_tr_b16 a[14:15], v15 offset:1024
    s_add_u32 s100, s100, 1
    s_min_u32 s59, s100, 7
    s_waitcnt lgkmcnt(6)
    v_mfma_f32_32x32x16_bf16 v[64:79], a[48:51], a[0:3], v[64:79]
    ds_read_b128 a[112:115], v9
    ds_read_b64_tr_b16 a[64:65], v12 offset:4096
    ds_read_b64_tr_b16 a[66:67], v12 offset:5120
    s_lshl_b32 s60, s45, 12
    s_lshl_b32 s61, s59, 7
    s_add_u32 s61, s61, s55
    s_add_u32 m0, s60, 0
    s_nop 0
    buffer_load_dwordx4 v2, s[36:39], s61 offen lds
    s_waitcnt lgkmcnt(7)
    v_mfma_f32_32x32x16_bf16 v[80:95], a[48:51], a[4:7], v[80:95]
    ds_read_b64_tr_b16 a[68:69], v13 offset:4096
    ds_read_b64_tr_b16 a[70:71], v13 offset:5120
    s_waitcnt lgkmcnt(7)
    v_mfma_f32_32x32x16_bf16 v[96:111], a[48:51], a[8:11], v[96:111]
    ds_read_b64_tr_b16 a[72:73], v14 offset:4096
    ds_read_b64_tr_b16 a[74:75], v14 offset:5120
    s_add_u32 m0, s60, 1024
    s_nop 0
    buffer_load_dwordx4 v3, s[36:39], s61 offen lds
    s_waitcnt lgkmcnt(7)
    v_mfma_f32_32x32x16_bf16 v[112:127], a[48:51], a[12:15], v[112:127]
    ds_read_b64_tr_b16 a[76:77], v15 offset:4096
    ds_read_b64_tr_b16 a[78:79], v15 offset:5120
    s_waitcnt lgkmcnt(6)
    v_mfma_f32_32x32x16_bf16 v[64:79], a[112:115], a[64:67], v[64:79]
    ds_read_b128 a[48:51], v10
    ds_read_b64_tr_b16 a[0:1], v12 offset:8192
    ds_read_b64_tr_b16 a[2:3], v12 offset:9216
    s_add_u32 m0, s60, 2048
    s_nop 0
    buffer_load_dwordx4 v4, s[36:39], s61 offen lds
    s_waitcnt lgkmcnt(7)
    v_mfma_f32_32x32x16_bf16 v[80:95], a[112:115], a[68:71], v[80:95]
    ds_read_b64_tr_b16 a[4:5], v13 offset:8192
    ds_read_b64_tr_b16 a[6:7], v13 offset:9216
    s_waitcnt lgkmcnt(7)
    v_mfma_f32_32x32x16_bf16 v[96:111], a[112:115], a[72:75], v[96:111]
    ds_read_b64_tr_b16 a[8:9], v14 offset:8192
    ds_read_b64_tr_b16 a[10:11], v14 offset:9216
    s_add_u32 m0, s60, 3072
    s_nop 0
    buffer_load_dwordx4 v5, s[36:39], s61 offen lds
    s_waitcnt lgkmcnt(7)
    v_mfma_f32_32x32x16_bf16 v[112:127], a[112:115], a[76:79], v[112:127]
    ds_read_b64_tr_b16 a[12:13], v15 offset:8192
    ds_read_b64_tr_b16 a[14:15], v15 offset:9216
    s_waitcnt lgkmcnt(6)
    v_mfma_f32_32x32x16_bf16 v[64:79], a[48:51], a[0:3], v[64:79]
    ds_read_b128 a[112:115], v11
    ds_read_b64_tr_b16 a[64:65], v12 offset:12288
    ds_read_b64_tr_b16 a[66:67], v12 offset:13312
    s_lshl_b32 s61, s59, 6
    s_lshl_b32 s62, s45, 4
    s_add_u32 s61, s61, s62
    s_mul_i32 s61, s61, 8192
    s_add_u32 s62, s61, s56
    s_add_u32 m0, s60, 16384
    s_add_u32 s63, s62, 0
    buffer_load_dwordx4 v6, s[88:91], s63 offen lds
    s_waitcnt lgkmcnt(7)
    v_mfma_f32_32x32x16_bf16 v[80:95], a[48:51], a[4:7], v[80:95]
    ds_read_b64_tr_b16 a[68:69], v13 offset:12288
    ds_read_b64_tr_b16 a[70:71], v13 offset:13312
    s_waitcnt lgkmcnt(7)
    v_mfma_f32_32x32x16_bf16 v[96:111], a[48:51], a[8:11], v[96:111]
    ds_read_b64_tr_b16 a[72:73], v14 offset:12288
    ds_read_b64_tr_b16 a[74:75], v14 offset:13312
    s_add_u32 m0, s60, 17408
    s_add_u32 s63, s62, 32768
    buffer_load_dwordx4 v6, s[88:91], s63 offen lds
    s_waitcnt lgkmcnt(7)
    v_mfma_f32_32x32x16_bf16 v[112:127], a[48:51], a[12:15], v[112:127]
    ds_read_b64_tr_b16 a[76:77], v15 offset:12288
    ds_read_b64_tr_b16 a[78:79], v15 offset:13312
    s_waitcnt lgkmcnt(6)
    v_mfma_f32_32x32x16_bf16 v[64:79], a[112:115], a[64:67], v[64:79]
    s_add_u32 m0, s60, 18432
    s_add_u32 s63, s62, 65536
    buffer_load_dwordx4 v6, s[88:91], s63 offen lds
    s_waitcnt lgkmcnt(4)
    v_mfma_f32_32x32x16_bf16 v[80:95], a[112:115], a[68:71], v[80:95]
    s_waitcnt lgkmcnt(2)
    v_mfma_f32_32x32x16_bf16 v[96:111], a[112:115], a[72:75], v[96:111]
    s_add_u32 m0, s60, 19456
    s_add_u32 s63, s62, 98304
    buffer_load_dwordx4 v6, s[88:91], s63 offen lds
    s_waitcnt lgkmcnt(0)
    v_mfma_f32_32x32x16_bf16 v[112:127], a[112:115], a[76:79], v[112:127]
    v_add_u32 v8, 0x8000, v8
    v_add_u32 v12, 0x8000, v12
    v_add_u32 v9, 0x8000, v9
    v_add_u32 v13, 0x8000, v13
    v_add_u32 v10, 0x8000, v10
    v_add_u32 v14, 0x8000, v14
    v_add_u32 v11, 0x8000, v11
    v_add_u32 v15, 0x8000, v15
    s_waitcnt vmcnt(16)
    s_barrier
    ds_read_b128 a[48:51], v8
    ds_read_b64_tr_b16 a[0:1], v12 offset:0
    ds_read_b64_tr_b16 a[2:3], v12 offset:1024
    ds_read_b64_tr_b16 a[4:5], v13 offset:0
    ds_read_b64_tr_b16 a[6:7], v13 offset:1024
    ds_read_b64_tr_b16 a[8:9], v14 offset:0
    ds_read_b64_tr_b16 a[10:11], v14 offset:1024
    ds_read_b64_tr_b16 a[12:13], v15 offset:0
    ds_read_b64_tr_b16 a[14:15], v15 offset:1024
    s_add_u32 s100, s100, 1
    s_min_u32 s59, s100, 7
    s_waitcnt lgkmcnt(6)
    v_mfma_f32_32x32x16_bf16 v[64:79], a[48:51], a[0:3], v[64:79]
    ds_read_b128 a[112:115], v9
    ds_read_b64_tr_b16 a[64:65], v12 offset:4096
    ds_read_b64_tr_b16 a[66:67], v12 offset:5120
    s_lshl_b32 s60, s45, 12
    s_lshl_b32 s61, s59, 7
    s_add_u32 s61, s61, s55
    s_add_u32 m0, s60, 32768
    s_nop 0
    buffer_load_dwordx4 v2, s[36:39], s61 offen lds
    s_waitcnt lgkmcnt(7)
    v_mfma_f32_32x32x16_bf16 v[80:95], a[48:51], a[4:7], v[80:95]
    ds_read_b64_tr_b16 a[68:69], v13 offset:4096
    ds_read_b64_tr_b16 a[70:71], v13 offset:5120
    s_waitcnt lgkmcnt(7)
    v_mfma_f32_32x32x16_bf16 v[96:111], a[48:51], a[8:11], v[96:111]
    ds_read_b64_tr_b16 a[72:73], v14 offset:4096
    ds_read_b64_tr_b16 a[74:75], v14 offset:5120
    s_add_u32 m0, s60, 33792
    s_nop 0
    buffer_load_dwordx4 v3, s[36:39], s61 offen lds
    s_waitcnt lgkmcnt(7)
    v_mfma_f32_32x32x16_bf16 v[112:127], a[48:51], a[12:15], v[112:127]
    ds_read_b64_tr_b16 a[76:77], v15 offset:4096
    ds_read_b64_tr_b16 a[78:79], v15 offset:5120
    s_waitcnt lgkmcnt(6)
    v_mfma_f32_32x32x16_bf16 v[64:79], a[112:115], a[64:67], v[64:79]
    ds_read_b128 a[48:51], v10
    ds_read_b64_tr_b16 a[0:1], v12 offset:8192
    ds_read_b64_tr_b16 a[2:3], v12 offset:9216
    s_add_u32 m0, s60, 34816
    s_nop 0
    buffer_load_dwordx4 v4, s[36:39], s61 offen lds
    s_waitcnt lgkmcnt(7)
    v_mfma_f32_32x32x16_bf16 v[80:95], a[112:115], a[68:71], v[80:95]
    ds_read_b64_tr_b16 a[4:5], v13 offset:8192
    ds_read_b64_tr_b16 a[6:7], v13 offset:9216
    s_waitcnt lgkmcnt(7)
    v_mfma_f32_32x32x16_bf16 v[96:111], a[112:115], a[72:75], v[96:111]
    ds_read_b64_tr_b16 a[8:9], v14 offset:8192
    ds_read_b64_tr_b16 a[10:11], v14 offset:9216
    s_add_u32 m0, s60, 35840
    s_nop 0
    buffer_load_dwordx4 v5, s[36:39], s61 offen lds
    s_waitcnt lgkmcnt(7)
    v_mfma_f32_32x32x16_bf16 v[112:127], a[112:115], a[76:79], v[112:127]
    ds_read_b64_tr_b16 a[12:13], v15 offset:8192
    ds_read_b64_tr_b16 a[14:15], v15 offset:9216
    s_waitcnt lgkmcnt(6)
    v_mfma_f32_32x32x16_bf16 v[64:79], a[48:51], a[0:3], v[64:79]
    ds_read_b128 a[112:115], v11
    ds_read_b64_tr_b16 a[64:65], v12 offset:12288
    ds_read_b64_tr_b16 a[66:67], v12 offset:13312
    s_lshl_b32 s61, s59, 6
    s_lshl_b32 s62, s45, 4
    s_add_u32 s61, s61, s62
    s_mul_i32 s61, s61, 8192
    s_add_u32 s62, s61, s56
    s_add_u32 m0, s60, 49152
    s_add_u32 s63, s62, 0
    buffer_load_dwordx4 v6, s[88:91], s63 offen lds
    s_waitcnt lgkmcnt(7)
    v_mfma_f32_32x32x16_bf16 v[80:95], a[48:51], a[4:7], v[80:95]
    ds_read_b64_tr_b16 a[68:69], v13 offset:12288
    ds_read_b64_tr_b16 a[70:71], v13 offset:13312
    s_waitcnt lgkmcnt(7)
    v_mfma_f32_32x32x16_bf16 v[96:111], a[48:51], a[8:11], v[96:111]
    ds_read_b64_tr_b16 a[72:73], v14 offset:12288
    ds_read_b64_tr_b16 a[74:75], v14 offset:13312
    s_add_u32 m0, s60, 50176
    s_add_u32 s63, s62, 32768
    buffer_load_dwordx4 v6, s[88:91], s63 offen lds
    s_waitcnt lgkmcnt(7)
    v_mfma_f32_32x32x16_bf16 v[112:127], a[48:51], a[12:15], v[112:127]
    ds_read_b64_tr_b16 a[76:77], v15 offset:12288
    ds_read_b64_tr_b16 a[78:79], v15 offset:13312
    s_waitcnt lgkmcnt(6)
    v_mfma_f32_32x32x16_bf16 v[64:79], a[112:115], a[64:67], v[64:79]
    s_add_u32 m0, s60, 51200
    s_add_u32 s63, s62, 65536
    buffer_load_dwordx4 v6, s[88:91], s63 offen lds
    s_waitcnt lgkmcnt(4)
    v_mfma_f32_32x32x16_bf16 v[80:95], a[112:115], a[68:71], v[80:95]
    s_waitcnt lgkmcnt(2)
    v_mfma_f32_32x32x16_bf16 v[96:111], a[112:115], a[72:75], v[96:111]
    s_add_u32 m0, s60, 52224
    s_add_u32 s63, s62, 98304
    buffer_load_dwordx4 v6, s[88:91], s63 offen lds
    s_waitcnt lgkmcnt(0)
    v_mfma_f32_32x32x16_bf16 v[112:127], a[112:115], a[76:79], v[112:127]
    v_add_u32 v8, 0x8000, v8
    v_add_u32 v12, 0x8000, v12
    v_add_u32 v9, 0x8000, v9
    v_add_u32 v13, 0x8000, v13
    v_add_u32 v10, 0x8000, v10
    v_add_u32 v14, 0x8000, v14
    v_add_u32 v11, 0x8000, v11
    v_add_u32 v15, 0x8000, v15
    s_waitcnt vmcnt(16)
    s_barrier
    ds_read_b128 a[48:51], v8
    ds_read_b64_tr_b16 a[0:1], v12 offset:0
    ds_read_b64_tr_b16 a[2:3], v12 offset:1024
    ds_read_b64_tr_b16 a[4:5], v13 offset:0
    ds_read_b64_tr_b16 a[6:7], v13 offset:1024
    ds_read_b64_tr_b16 a[8:9], v14 offset:0
    ds_read_b64_tr_b16 a[10:11], v14 offset:1024
    ds_read_b64_tr_b16 a[12:13], v15 offset:0
    ds_read_b64_tr_b16 a[14:15], v15 offset:1024
    s_add_u32 s100, s100, 1
    s_min_u32 s59, s100, 7
    s_waitcnt lgkmcnt(6)
    v_mfma_f32_32x32x16_bf16 v[64:79], a[48:51], a[0:3], v[64:79]
    ds_read_b128 a[112:115], v9
    ds_read_b64_tr_b16 a[64:65], v12 offset:4096
    ds_read_b64_tr_b16 a[66:67], v12 offset:5120
    s_lshl_b32 s60, s45, 12
    s_lshl_b32 s61, s59, 7
    s_add_u32 s61, s61, s55
    s_add_u32 m0, s60, 65536
    s_nop 0
    buffer_load_dwordx4 v2, s[36:39], s61 offen lds
    s_waitcnt lgkmcnt(7)
    v_mfma_f32_32x32x16_bf16 v[80:95], a[48:51], a[4:7], v[80:95]
    ds_read_b64_tr_b16 a[68:69], v13 offset:4096
    ds_read_b64_tr_b16 a[70:71], v13 offset:5120
    s_waitcnt lgkmcnt(7)
    v_mfma_f32_32x32x16_bf16 v[96:111], a[48:51], a[8:11], v[96:111]
    ds_read_b64_tr_b16 a[72:73], v14 offset:4096
    ds_read_b64_tr_b16 a[74:75], v14 offset:5120
    s_add_u32 m0, s60, 66560
    s_nop 0
    buffer_load_dwordx4 v3, s[36:39], s61 offen lds
    s_waitcnt lgkmcnt(7)
    v_mfma_f32_32x32x16_bf16 v[112:127], a[48:51], a[12:15], v[112:127]
    ds_read_b64_tr_b16 a[76:77], v15 offset:4096
    ds_read_b64_tr_b16 a[78:79], v15 offset:5120
    s_waitcnt lgkmcnt(6)
    v_mfma_f32_32x32x16_bf16 v[64:79], a[112:115], a[64:67], v[64:79]
    ds_read_b128 a[48:51], v10
    ds_read_b64_tr_b16 a[0:1], v12 offset:8192
    ds_read_b64_tr_b16 a[2:3], v12 offset:9216
    s_add_u32 m0, s60, 67584
    s_nop 0
    buffer_load_dwordx4 v4, s[36:39], s61 offen lds
    s_waitcnt lgkmcnt(7)
    v_mfma_f32_32x32x16_bf16 v[80:95], a[112:115], a[68:71], v[80:95]
    ds_read_b64_tr_b16 a[4:5], v13 offset:8192
    ds_read_b64_tr_b16 a[6:7], v13 offset:9216
    s_waitcnt lgkmcnt(7)
    v_mfma_f32_32x32x16_bf16 v[96:111], a[112:115], a[72:75], v[96:111]
    ds_read_b64_tr_b16 a[8:9], v14 offset:8192
    ds_read_b64_tr_b16 a[10:11], v14 offset:9216
    s_add_u32 m0, s60, 68608
    s_nop 0
    buffer_load_dwordx4 v5, s[36:39], s61 offen lds
    s_waitcnt lgkmcnt(7)
    v_mfma_f32_32x32x16_bf16 v[112:127], a[112:115], a[76:79], v[112:127]
    ds_read_b64_tr_b16 a[12:13], v15 offset:8192
    ds_read_b64_tr_b16 a[14:15], v15 offset:9216
    s_waitcnt lgkmcnt(6)
    v_mfma_f32_32x32x16_bf16 v[64:79], a[48:51], a[0:3], v[64:79]
    ds_read_b128 a[112:115], v11
    ds_read_b64_tr_b16 a[64:65], v12 offset:12288
    ds_read_b64_tr_b16 a[66:67], v12 offset:13312
    s_lshl_b32 s61, s59, 6
    s_lshl_b32 s62, s45, 4
    s_add_u32 s61, s61, s62
    s_mul_i32 s61, s61, 8192
    s_add_u32 s62, s61, s56
    s_add_u32 m0, s60, 81920
    s_add_u32 s63, s62, 0
    buffer_load_dwordx4 v6, s[88:91], s63 offen lds
    s_waitcnt lgkmcnt(7)
    v_mfma_f32_32x32x16_bf16 v[80:95], a[48:51], a[4:7], v[80:95]
    ds_read_b64_tr_b16 a[68:69], v13 offset:12288
    ds_read_b64_tr_b16 a[70:71], v13 offset:13312
    s_waitcnt lgkmcnt(7)
    v_mfma_f32_32x32x16_bf16 v[96:111], a[48:51], a[8:11], v[96:111]
    ds_read_b64_tr_b16 a[72:73], v14 offset:12288
    ds_read_b64_tr_b16 a[74:75], v14 offset:13312
    s_add_u32 m0, s60, 82944
    s_add_u32 s63, s62, 32768
    buffer_load_dwordx4 v6, s[88:91], s63 offen lds
    s_waitcnt lgkmcnt(7)
    v_mfma_f32_32x32x16_bf16 v[112:127], a[48:51], a[12:15], v[112:127]
    ds_read_b64_tr_b16 a[76:77], v15 offset:12288
    ds_read_b64_tr_b16 a[78:79], v15 offset:13312
    s_waitcnt lgkmcnt(6)
    v_mfma_f32_32x32x16_bf16 v[64:79], a[112:115], a[64:67], v[64:79]
    s_add_u32 m0, s60, 83968
    s_add_u32 s63, s62, 65536
    buffer_load_dwordx4 v6, s[88:91], s63 offen lds
    s_waitcnt lgkmcnt(4)
    v_mfma_f32_32x32x16_bf16 v[80:95], a[112:115], a[68:71], v[80:95]
    s_waitcnt lgkmcnt(2)
    v_mfma_f32_32x32x16_bf16 v[96:111], a[112:115], a[72:75], v[96:111]
    s_add_u32 m0, s60, 84992
    s_add_u32 s63, s62, 98304
    buffer_load_dwordx4 v6, s[88:91], s63 offen lds
    s_waitcnt lgkmcnt(0)
    v_mfma_f32_32x32x16_bf16 v[112:127], a[112:115], a[76:79], v[112:127]
    v_add_u32 v8, 0xfffe8000, v8
    v_add_u32 v12, 0xfffe8000, v12
    v_add_u32 v9, 0xfffe8000, v9
    v_add_u32 v13, 0xfffe8000, v13
    v_add_u32 v10, 0xfffe8000, v10
    v_add_u32 v14, 0xfffe8000, v14
    v_add_u32 v11, 0xfffe8000, v11
    v_add_u32 v15, 0xfffe8000, v15
    s_cmp_lt_u32 s100, 10
    s_cbranch_scc1 L_gl_bsv
    s_waitcnt vmcnt(0)
    s_nop 15
    s_lshl_b32 s60, s53, 2
    s_add_u32 s60, s60, s45
    s_lshl_b32 s60, s60, 5
    s_add_u32 s60, s60, s54
    s_lshl_b32 s60, s60, 13
    v_bfe_u32 v24, v1, 4, 1
    v_and_b32 v25, 15, v1
    v_lshrrev_b32 v26, 5, v1
    s_add_u32 s63, s60, 0x2000000
    v_lshl_add_u32 v27, v24, 2, v26
    v_lshlrev_b32 v27, 8, v27
    v_lshl_add_u32 v27, v25, 4, v27
    v_cvt_pk_bf16_f32 v16, v64, v65
    v_cvt_pk_bf16_f32 v17, v66, v67
    v_cvt_pk_bf16_f32 v18, v72, v73
    v_cvt_pk_bf16_f32 v19, v74, v75
    v_cvt_pk_bf16_f32 v20, v68, v69
    v_cvt_pk_bf16_f32 v21, v70, v71
    v_cvt_pk_bf16_f32 v22, v76, v77
    v_cvt_pk_bf16_f32 v23, v78, v79
    buffer_store_dwordx4 v[16:19], v27, s[32:35], s63 offen offset:0 sc1
    buffer_store_dwordx4 v[20:23], v27, s[32:35], s63 offen offset:512 sc1
    s_nop 1
    v_cvt_pk_bf16_f32 v16, v80, v81
    v_cvt_pk_bf16_f32 v17, v82, v83
    v_cvt_pk_bf16_f32 v18, v88, v89
    v_cvt_pk_bf16_f32 v19, v90, v91
    v_cvt_pk_bf16_f32 v20, v84, v85
    v_cvt_pk_bf16_f32 v21, v86, v87
    v_cvt_pk_bf16_f32 v22, v92, v93
    v_cvt_pk_bf16_f32 v23, v94, v95
    buffer_store_dwordx4 v[16:19], v27, s[32:35], s63 offen offset:2048 sc1
    buffer_store_dwordx4 v[20:23], v27, s[32:35], s63 offen offset:2560 sc1
    s_nop 1
    s_add_u32 s63, s63, 4096
    v_cvt_pk_bf16_f32 v16, v96, v97
    v_cvt_pk_bf16_f32 v17, v98, v99
    v_cvt_pk_bf16_f32 v18, v104, v105
    v_cvt_pk_bf16_f32 v19, v106, v107
    v_cvt_pk_bf16_f32 v20, v100, v101
    v_cvt_pk_bf16_f32 v21, v102, v103
    v_cvt_pk_bf16_f32 v22, v108, v109
    v_cvt_pk_bf16_f32 v23, v110, v111
    buffer_store_dwordx4 v[16:19], v27, s[32:35], s63 offen offset:0 sc1
    buffer_store_dwordx4 v[20:23], v27, s[32:35], s63 offen offset:512 sc1
    s_nop 1
    v_cvt_pk_bf16_f32 v16, v112, v113
    v_cvt_pk_bf16_f32 v17, v114, v115
    v_cvt_pk_bf16_f32 v18, v120, v121
    v_cvt_pk_bf16_f32 v19, v122, v123
    v_cvt_pk_bf16_f32 v20, v116, v117
    v_cvt_pk_bf16_f32 v21, v118, v119
    v_cvt_pk_bf16_f32 v22, v124, v125
    v_cvt_pk_bf16_f32 v23, v126, v127
    buffer_store_dwordx4 v[16:19], v27, s[32:35], s63 offen offset:2048 sc1
    buffer_store_dwordx4 v[20:23], v27, s[32:35], s63 offen offset:2560 sc1
    s_nop 1
L_bs_done:
    s_lshl_b32 s60, s54, 7
    s_lshl_b32 s61, s53, 2
    s_add_u32 s60, s60, s61
    s_add_u32 s60, s60, 0x0
    s_waitcnt vmcnt(0)
    s_barrier
    s_cmp_lg_u32 s45, 0
    s_cbranch_scc1 L_w0_23
    s_cmp_lg_u32 s98, 0
    s_cbranch_scc1 L_id_25
    v_mov_b32 v16, 128
L_iw_24:
    s_add_u32 s101, s101, 1
    s_cmp_gt_u32 s101, 0x200000
    s_cbranch_scc1 L_exit
    global_load_dword v17, v16, s[26:27] sc1
    s_waitcnt vmcnt(0)
    v_readfirstlane_b32 s61, v17
    s_nop 2
    s_cmp_lt_u32 s61, 32
    s_cbranch_scc1 L_iw_24
    s_mov_b32 s98, 1
L_id_25:
    s_mov_b64 exec, 1
    v_mov_b32 v16, 0
    v_mov_b32 v17, 1
    buffer_atomic_add v17, v16, s[32:35], s60 offen
    s_mov_b64 exec, -1
L_w0_23:
    s_and_b32 s52, s52, 0x1ff
    s_branch L_next
L_t_bproj:
    s_lshr_b32 s53, s52, 5
    s_and_b32 s54, s52, 31
    s_cmp_lt_u32 s53, 2
    s_cbranch_scc1 L_gate_26
    s_cmp_lg_u32 s45, 0
    s_cbranch_scc1 L_w0_27
    s_lshl_b32 s60, s54, 7
    s_add_u32 s60, s60, 0x0
    s_cmp_lg_u32 s98, 0
    s_cbranch_scc1 L_id_29
    v_mov_b32 v16, 128
L_iw_28:
    s_add_u32 s101, s101, 1
    s_cmp_gt_u32 s101, 0x200000
    s_cbranch_scc1 L_exit
    global_load_dword v17, v16, s[26:27] sc1
    s_waitcnt vmcnt(0)
    v_readfirstlane_b32 s61, v17
    s_nop 2
    s_cmp_lt_u32 s61, 32
    s_cbranch_scc1 L_iw_28
    s_mov_b32 s98, 1
L_id_29:
    v_mov_b32 v16, 0
L_wait_30:
    s_add_u32 s101, s101, 1
    s_cmp_gt_u32 s101, 0x200000
    s_cbranch_scc1 L_exit
    buffer_load_dword v17, v16, s[32:35], s60 offen sc1
    s_waitcnt vmcnt(0)
    v_readfirstlane_b32 s61, v17
    s_nop 2
    s_cmp_ge_u32 s61, 3
    s_cbranch_scc1 L_waitd_31
    s_sleep 8
    s_branch L_wait_30
L_waitd_31:
L_w0_27:
    s_barrier
L_gate_26:
    s_mov_b32 s36, s10
    s_and_b32 s37, s11, 0xffff
    s_mov_b32 s38, 0x200000
    s_mov_b32 s39, 0x00020000
    s_mov_b32 s80, s14
    s_and_b32 s81, s15, 0xffff
    s_mov_b32 s82, 0x400000
    s_mov_b32 s83, 0x00020000
    s_mov_b32 s84, s16
    s_and_b32 s85, s17, 0xffff
    s_mov_b32 s86, 0x400000
    s_mov_b32 s87, 0x00020000
    s_mov_b32 s88, s18
    s_and_b32 s89, s19, 0xffff
    s_mov_b32 s90, 0x400000
    s_mov_b32 s91, 0x00020000
    v_lshrrev_b32 v16, 3, v1
    s_mov_b32 s60, 1024
    v_mul_lo_u32 v16, v16, s60
    v_and_b32 v17, 7, v1
    v_lshrrev_b32 v18, 4, v1
    v_xor_b32 v17, v17, v18
    v_lshl_add_u32 v16, v17, 4, v16
    v_xor_b32 v2, 0, v16
    v_xor_b32 v3, 64, v16
    v_add_u32 v3, 8192, v3
    v_xor_b32 v4, 0, v16
    v_add_u32 v4, 16384, v4
    v_xor_b32 v5, 64, v16
    v_add_u32 v5, 24576, v5
    s_mov_b32 s60, 8192
    v_mul_lo_u32 v16, v18, s60
    v_and_b32 v17, 15, v1
    v_lshlrev_b32 v19, 2, v18
    v_xor_b32 v17, v17, v19
    v_lshl_add_u32 v6, v17, 4, v16
    s_lshl_b32 s55, s53, 17
    s_lshl_b32 s60, s45, 15
    s_add_u32 s55, s55, s60
    s_lshl_b32 s56, s54, 8
    s_lshl_b32 s57, s54, 8
    s_lshl_b32 s58, s54, 8
    v_mov_b64 v[64:65], 0
    v_mov_b64 v[66:67], 0
    v_mov_b64 v[68:69], 0
    v_mov_b64 v[70:71], 0
    v_mov_b64 v[72:73], 0
    v_mov_b64 v[74:75], 0
    v_mov_b64 v[76:77], 0
    v_mov_b64 v[78:79], 0
    v_mov_b64 v[80:81], 0
    v_mov_b64 v[82:83], 0
    v_mov_b64 v[84:85], 0
    v_mov_b64 v[86:87], 0
    v_mov_b64 v[88:89], 0
    v_mov_b64 v[90:91], 0
    v_mov_b64 v[92:93], 0
    v_mov_b64 v[94:95], 0
    v_mov_b64 v[96:97], 0
    v_mov_b64 v[98:99], 0
    v_mov_b64 v[100:101], 0
    v_mov_b64 v[102:103], 0
    v_mov_b64 v[104:105], 0
    v_mov_b64 v[106:107], 0
    v_mov_b64 v[108:109], 0
    v_mov_b64 v[110:111], 0
    v_mov_b64 v[112:113], 0
    v_mov_b64 v[114:115], 0
    v_mov_b64 v[116:117], 0
    v_mov_b64 v[118:119], 0
    v_mov_b64 v[120:121], 0
    v_mov_b64 v[122:123], 0
    v_mov_b64 v[124:125], 0
    v_mov_b64 v[126:127], 0
    v_mov_b64 v[128:129], 0
    v_mov_b64 v[130:131], 0
    v_mov_b64 v[132:133], 0
    v_mov_b64 v[134:135], 0
    v_mov_b64 v[136:137], 0
    v_mov_b64 v[138:139], 0
    v_mov_b64 v[140:141], 0
    v_mov_b64 v[142:143], 0
    v_mov_b64 v[144:145], 0
    v_mov_b64 v[146:147], 0
    v_mov_b64 v[148:149], 0
    v_mov_b64 v[150:151], 0
    v_mov_b64 v[152:153], 0
    v_mov_b64 v[154:155], 0
    v_mov_b64 v[156:157], 0
    v_mov_b64 v[158:159], 0
    v_mov_b64 v[160:161], 0
    v_mov_b64 v[162:163], 0
    v_mov_b64 v[164:165], 0
    v_mov_b64 v[166:167], 0
    v_mov_b64 v[168:169], 0
    v_mov_b64 v[170:171], 0
    v_mov_b64 v[172:173], 0
    v_mov_b64 v[174:175], 0
    v_mov_b64 v[176:177], 0
    v_mov_b64 v[178:179], 0
    v_mov_b64 v[180:181], 0
    v_mov_b64 v[182:183], 0
    v_mov_b64 v[184:185], 0
    v_mov_b64 v[186:187], 0
    v_mov_b64 v[188:189], 0
    v_mov_b64 v[190:191], 0
    v_mov_b64 v[192:193], 0
    v_mov_b64 v[194:195], 0
    v_mov_b64 v[196:197], 0
    v_mov_b64 v[198:199], 0
    v_mov_b64 v[200:201], 0
    v_mov_b64 v[202:203], 0
    v_mov_b64 v[204:205], 0
    v_mov_b64 v[206:207], 0
    v_mov_b64 v[208:209], 0
    v_mov_b64 v[210:211], 0
    v_mov_b64 v[212:213], 0
    v_mov_b64 v[214:215], 0
    v_mov_b64 v[216:217], 0
    v_mov_b64 v[218:219], 0
    v_mov_b64 v[220:221], 0
    v_mov_b64 v[222:223], 0
    v_mov_b64 v[224:225], 0
    v_mov_b64 v[226:227], 0
    v_mov_b64 v[228:229], 0
    v_mov_b64 v[230:231], 0
    v_mov_b64 v[232:233], 0
    v_mov_b64 v[234:235], 0
    v_mov_b64 v[236:237], 0
    v_mov_b64 v[238:239], 0
    v_mov_b64 v[240:241], 0
    v_mov_b64 v[242:243], 0
    v_mov_b64 v[244:245], 0
    v_mov_b64 v[246:247], 0
    v_mov_b64 v[248:249], 0
    v_mov_b64 v[250:251], 0
    v_mov_b64 v[252:253], 0
    v_mov_b64 v[254:255], 0
    s_mov_b32 s59, 0
    s_lshl_b32 s60, s45, 12
    s_lshl_b32 s61, s59, 7
    s_add_u32 s61, s61, s55
    s_add_u32 m0, s60, 0
    s_nop 0
    buffer_load_dwordx4 v2, s[36:39], s61 offen lds
    s_add_u32 m0, s60, 1024
    s_nop 0
    buffer_load_dwordx4 v3, s[36:39], s61 offen lds
    s_add_u32 m0, s60, 2048
    s_nop 0
    buffer_load_dwordx4 v4, s[36:39], s61 offen lds
    s_add_u32 m0, s60, 3072
    s_nop 0
    buffer_load_dwordx4 v5, s[36:39], s61 offen lds
    s_lshl_b32 s61, s59, 6
    s_lshl_b32 s62, s45, 4
    s_add_u32 s61, s61, s62
    s_mul_i32 s61, s61, 8192
    s_add_u32 s62, s61, s56
    s_add_u32 m0, s60, 16384
    s_add_u32 s63, s62, 0
    buffer_load_dwordx4 v6, s[80:83], s63 offen lds
    s_add_u32 m0, s60, 17408
    s_add_u32 s63, s62, 32768
    buffer_load_dwordx4 v6, s[80:83], s63 offen lds
    s_add_u32 m0, s60, 18432
    s_add_u32 s63, s62, 65536
    buffer_load_dwordx4 v6, s[80:83], s63 offen lds
    s_add_u32 m0, s60, 19456
    s_add_u32 s63, s62, 98304
    buffer_load_dwordx4 v6, s[80:83], s63 offen lds
    s_add_u32 s62, s61, s57
    s_add_u32 m0, s60, 32768
    s_add_u32 s63, s62, 0
    buffer_load_dwordx4 v6, s[84:87], s63 offen lds
    s_add_u32 m0, s60, 33792
    s_add_u32 s63, s62, 32768
    buffer_load_dwordx4 v6, s[84:87], s63 offen lds
    s_add_u32 m0, s60, 34816
    s_add_u32 s63, s62, 65536
    buffer_load_dwordx4 v6, s[84:87], s63 offen lds
    s_add_u32 m0, s60, 35840
    s_add_u32 s63, s62, 98304
    buffer_load_dwordx4 v6, s[84:87], s63 offen lds
    s_add_u32 s62, s61, s58
    s_add_u32 m0, s60, 49152
    s_add_u32 s63, s62, 0
    buffer_load_dwordx4 v6, s[88:91], s63 offen lds
    s_add_u32 m0, s60, 50176
    s_add_u32 s63, s62, 32768
    buffer_load_dwordx4 v6, s[88:91], s63 offen lds
    s_add_u32 m0, s60, 51200
    s_add_u32 s63, s62, 65536
    buffer_load_dwordx4 v6, s[88:91], s63 offen lds
    s_add_u32 m0, s60, 52224
    s_add_u32 s63, s62, 98304
    buffer_load_dwordx4 v6, s[88:91], s63 offen lds
    s_mov_b32 s100, 0
L_gl_bp:
    s_waitcnt vmcnt(0)
L_gl_bp_in:
    s_barrier
    ds_read_b128 a[48:51], v8
    ds_read_b64_tr_b16 a[0:1], v12 offset:0
    ds_read_b64_tr_b16 a[2:3], v12 offset:1024
    ds_read_b64_tr_b16 a[4:5], v13 offset:0
    ds_read_b64_tr_b16 a[6:7], v13 offset:1024
    ds_read_b64_tr_b16 a[8:9], v14 offset:0
    ds_read_b64_tr_b16 a[10:11], v14 offset:1024
    ds_read_b64_tr_b16 a[12:13], v15 offset:0
    ds_read_b64_tr_b16 a[14:15], v15 offset:1024
    ds_read_b64_tr_b16 a[16:17], v12 offset:16384
    ds_read_b64_tr_b16 a[18:19], v12 offset:17408
    ds_read_b64_tr_b16 a[20:21], v13 offset:16384
    ds_read_b64_tr_b16 a[22:23], v13 offset:17408
    ds_read_b64_tr_b16 a[24:25], v14 offset:16384
    ds_read_b64_tr_b16 a[26:27], v14 offset:17408
    ds_read_b64_tr_b16 a[28:29], v15 offset:16384
    ds_read_b64_tr_b16 a[30:31], v15 offset:17408
    ds_read_b64_tr_b16 a[32:33], v12 offset:32768
    ds_read_b64_tr_b16 a[34:35], v12 offset:33792
    ds_read_b64_tr_b16 a[36:37], v13 offset:32768
    ds_read_b64_tr_b16 a[38:39], v13 offset:33792
    ds_read_b64_tr_b16 a[40:41], v14 offset:32768
    ds_read_b64_tr_b16 a[42:43], v14 offset:33792
    ds_read_b64_tr_b16 a[44:45], v15 offset:32768
    ds_read_b64_tr_b16 a[46:47], v15 offset:33792
    s_add_u32 s100, s100, 1
    s_min_u32 s59, s100, 7
    s_waitcnt lgkmcnt(15)
    v_mfma_f32_32x32x16_bf16 v[64:79], a[0:3], a[48:51], v[64:79]
    ds_read_b128 a[112:115], v9
    ds_read_b64_tr_b16 a[64:65], v12 offset:4096
    ds_read_b64_tr_b16 a[66:67], v12 offset:5120
    s_lshl_b32 s60, s45, 12
    s_lshl_b32 s61, s59, 7
    s_add_u32 s61, s61, s55
    s_add_u32 m0, s60, 65536
    s_nop 0
    buffer_load_dwordx4 v2, s[36:39], s61 offen lds
    s_waitcnt lgkmcnt(15)
    v_mfma_f32_32x32x16_bf16 v[80:95], a[4:7], a[48:51], v[80:95]
    ds_read_b64_tr_b16 a[68:69], v13 offset:4096
    ds_read_b64_tr_b16 a[70:71], v13 offset:5120
    s_waitcnt lgkmcnt(15)
    v_mfma_f32_32x32x16_bf16 v[96:111], a[8:11], a[48:51], v[96:111]
    ds_read_b64_tr_b16 a[72:73], v14 offset:4096
    ds_read_b64_tr_b16 a[74:75], v14 offset:5120
    s_add_u32 m0, s60, 66560
    s_nop 0
    buffer_load_dwordx4 v3, s[36:39], s61 offen lds
    s_waitcnt lgkmcnt(15)
    v_mfma_f32_32x32x16_bf16 v[112:127], a[12:15], a[48:51], v[112:127]
    ds_read_b64_tr_b16 a[76:77], v15 offset:4096
    ds_read_b64_tr_b16 a[78:79], v15 offset:5120
    s_waitcnt lgkmcnt(15)
    v_mfma_f32_32x32x16_bf16 v[128:143], a[16:19], a[48:51], v[128:143]
    ds_read_b64_tr_b16 a[80:81], v12 offset:20480
    ds_read_b64_tr_b16 a[82:83], v12 offset:21504
    s_add_u32 m0, s60, 67584
    s_nop 0
    buffer_load_dwordx4 v4, s[36:39], s61 offen lds
    s_waitcnt lgkmcnt(15)
    v_mfma_f32_32x32x16_bf16 v[144:159], a[20:23], a[48:51], v[144:159]
    ds_read_b64_tr_b16 a[84:85], v13 offset:20480
    ds_read_b64_tr_b16 a[86:87], v13 offset:21504
    s_waitcnt lgkmcnt(15)
    v_mfma_f32_32x32x16_bf16 v[160:175], a[24:27], a[48:51], v[160:175]
    ds_read_b64_tr_b16 a[88:89], v14 offset:20480
    ds_read_b64_tr_b16 a[90:91], v14 offset:21504
    s_add_u32 m0, s60, 68608
    s_nop 0
    buffer_load_dwordx4 v5, s[36:39], s61 offen lds
    s_waitcnt lgkmcnt(15)
    v_mfma_f32_32x32x16_bf16 v[176:191], a[28:31], a[48:51], v[176:191]
    ds_read_b64_tr_b16 a[92:93], v15 offset:20480
    ds_read_b64_tr_b16 a[94:95], v15 offset:21504
    s_waitcnt lgkmcnt(15)
    v_mfma_f32_32x32x16_bf16 v[192:207], a[48:51], a[32:35], v[192:207]
    ds_read_b64_tr_b16 a[96:97], v12 offset:36864
    ds_read_b64_tr_b16 a[98:99], v12 offset:37888
    s_lshl_b32 s61, s59, 6
    s_lshl_b32 s62, s45, 4
    s_add_u32 s61, s61, s62
    s_mul_i32 s61, s61, 8192
    s_add_u32 s62, s61, s56
    s_add_u32 m0, s60, 81920
    s_add_u32 s63, s62, 0
    buffer_load_dwordx4 v6, s[80:83], s63 offen lds
    s_waitcnt lgkmcnt(15)
    v_mfma_f32_32x32x16_bf16 v[208:223], a[48:51], a[36:39], v[208:223]
    ds_read_b64_tr_b16 a[100:101], v13 offset:36864
    ds_read_b64_tr_b16 a[102:103], v13 offset:37888
    s_waitcnt lgkmcnt(15)
    v_mfma_f32_32x32x16_bf16 v[224:239], a[48:51], a[40:43], v[224:239]
    ds_read_b64_tr_b16 a[104:105], v14 offset:36864
    ds_read_b64_tr_b16 a[106:107], v14 offset:37888
    s_add_u32 m0, s60, 82944
    s_add_u32 s63, s62, 32768
    buffer_load_dwordx4 v6, s[80:83], s63 offen lds
    s_waitcnt lgkmcnt(15)
    v_mfma_f32_32x32x16_bf16 v[240:255], a[48:51], a[44:47], v[240:255]
    ds_read_b64_tr_b16 a[108:109], v15 offset:36864
    ds_read_b64_tr_b16 a[110:111], v15 offset:37888
    s_waitcnt lgkmcnt(15)
    v_mfma_f32_32x32x16_bf16 v[64:79], a[64:67], a[112:115], v[64:79]
    ds_read_b128 a[48:51], v10
    ds_read_b64_tr_b16 a[0:1], v12 offset:8192
    ds_read_b64_tr_b16 a[2:3], v12 offset:9216
    s_add_u32 m0, s60, 83968
    s_add_u32 s63, s62, 65536
    buffer_load_dwordx4 v6, s[80:83], s63 offen lds
    s_waitcnt lgkmcnt(15)
    v_mfma_f32_32x32x16_bf16 v[80:95], a[68:71], a[112:115], v[80:95]
    ds_read_b64_tr_b16 a[4:5], v13 offset:8192
    ds_read_b64_tr_b16 a[6:7], v13 offset:9216
    s_waitcnt lgkmcnt(15)
    v_mfma_f32_32x32x16_bf16 v[96:111], a[72:75], a[112:115], v[96:111]
    ds_read_b64_tr_b16 a[8:9], v14 offset:8192
    ds_read_b64_tr_b16 a[10:11], v14 offset:9216
    s_add_u32 m0, s60, 84992
    s_add_u32 s63, s62, 98304
    buffer_load_dwordx4 v6, s[80:83], s63 offen lds
    s_waitcnt lgkmcnt(15)
    v_mfma_f32_32x32x16_bf16 v[112:127], a[76:79], a[112:115], v[112:127]
    ds_read_b64_tr_b16 a[12:13], v15 offset:8192
    ds_read_b64_tr_b16 a[14:15], v15 offset:9216
    s_waitcnt lgkmcnt(15)
    v_mfma_f32_32x32x16_bf16 v[128:143], a[80:83], a[112:115], v[128:143]
    ds_read_b64_tr_b16 a[16:17], v12 offset:24576
    ds_read_b64_tr_b16 a[18:19], v12 offset:25600
    s_add_u32 s62, s61, s57
    s_add_u32 m0, s60, 98304
    s_add_u32 s63, s62, 0
    buffer_load_dwordx4 v6, s[84:87], s63 offen lds
    s_waitcnt lgkmcnt(15)
    v_mfma_f32_32x32x16_bf16 v[144:159], a[84:87], a[112:115], v[144:159]
    ds_read_b64_tr_b16 a[20:21], v13 offset:24576
    ds_read_b64_tr_b16 a[22:23], v13 offset:25600
    s_waitcnt lgkmcnt(15)
    v_mfma_f32_32x32x16_bf16 v[160:175], a[88:91], a[112:115], v[160:175]
    ds_read_b64_tr_b16 a[24:25], v14 offset:24576
    ds_read_b64_tr_b16 a[26:27], v14 offset:25600
    s_add_u32 m0, s60, 99328
    s_add_u32 s63, s62, 32768
    buffer_load_dwordx4 v6, s[84:87], s63 offen lds
    s_waitcnt lgkmcnt(15)
    v_mfma_f32_32x32x16_bf16 v[176:191], a[92:95], a[112:115], v[176:191]
    ds_read_b64_tr_b16 a[28:29], v15 offset:24576
    ds_read_b64_tr_b16 a[30:31], v15 offset:25600
    s_waitcnt lgkmcnt(15)
    v_mfma_f32_32x32x16_bf16 v[192:207], a[112:115], a[96:99], v[192:207]
    ds_read_b64_tr_b16 a[32:33], v12 offset:40960
    ds_read_b64_tr_b16 a[34:35], v12 offset:41984
    s_add_u32 m0, s60, 100352
    s_add_u32 s63, s62, 65536
    buffer_load_dwordx4 v6, s[84:87], s63 offen lds
    s_waitcnt lgkmcnt(15)
    v_mfma_f32_32x32x16_bf16 v[208:223], a[112:115], a[100:103], v[208:223]
    ds_read_b64_tr_b16 a[36:37], v13 offset:40960
    ds_read_b64_tr_b16 a[38:39], v13 offset:41984
    s_waitcnt lgkmcnt(15)
    v_mfma_f32_32x32x16_bf16 v[224:239], a[112:115], a[104:107], v[224:239]
    ds_read_b64_tr_b16 a[40:41], v14 offset:40960
    ds_read_b64_tr_b16 a[42:43], v14 offset:41984
    s_add_u32 m0, s60, 101376
    s_add_u32 s63, s62, 98304
    buffer_load_dwordx4 v6, s[84:87], s63 offen lds
    s_waitcnt lgkmcnt(15)
    v_mfma_f32_32x32x16_bf16 v[240:255], a[112:115], a[108:111], v[240:255]
    ds_read_b64_tr_b16 a[44:45], v15 offset:40960
    ds_read_b64_tr_b16 a[46:47], v15 offset:41984
    s_waitcnt lgkmcnt(15)
    v_mfma_f32_32x32x16_bf16 v[64:79], a[0:3], a[48:51], v[64:79]
    ds_read_b128 a[112:115], v11
    ds_read_b64_tr_b16 a[64:65], v12 offset:12288
    ds_read_b64_tr_b16 a[66:67], v12 offset:13312
    s_add_u32 s62, s61, s58
    s_add_u32 m0, s60, 114688
    s_add_u32 s63, s62, 0
    buffer_load_dwordx4 v6, s[88:91], s63 offen lds
    s_waitcnt lgkmcnt(15)
    v_mfma_f32_32x32x16_bf16 v[80:95], a[4:7], a[48:51], v[80:95]
    ds_read_b64_tr_b16 a[68:69], v13 offset:12288
    ds_read_b64_tr_b16 a[70:71], v13 offset:13312
    s_waitcnt lgkmcnt(15)
    v_mfma_f32_32x32x16_bf16 v[96:111], a[8:11], a[48:51], v[96:111]
    ds_read_b64_tr_b16 a[72:73], v14 offset:12288
    ds_read_b64_tr_b16 a[74:75], v14 offset:13312
    s_add_u32 m0, s60, 115712
    s_add_u32 s63, s62, 32768
    buffer_load_dwordx4 v6, s[88:91], s63 offen lds
    s_waitcnt lgkmcnt(15)
    v_mfma_f32_32x32x16_bf16 v[112:127], a[12:15], a[48:51], v[112:127]
    ds_read_b64_tr_b16 a[76:77], v15 offset:12288
    ds_read_b64_tr_b16 a[78:79], v15 offset:13312
    s_waitcnt lgkmcnt(15)
    v_mfma_f32_32x32x16_bf16 v[128:143], a[16:19], a[48:51], v[128:143]
    ds_read_b64_tr_b16 a[80:81], v12 offset:28672
    ds_read_b64_tr_b16 a[82:83], v12 offset:29696
    s_add_u32 m0, s60, 116736
    s_add_u32 s63, s62, 65536
    buffer_load_dwordx4 v6, s[88:91], s63 offen lds
    s_waitcnt lgkmcnt(15)
    v_mfma_f32_32x32x16_bf16 v[144:159], a[20:23], a[48:51], v[144:159]
    ds_read_b64_tr_b16 a[84:85], v13 offset:28672
    ds_read_b64_tr_b16 a[86:87], v13 offset:29696
    s_waitcnt lgkmcnt(15)
    v_mfma_f32_32x32x16_bf16 v[160:175], a[24:27], a[48:51], v[160:175]
    ds_read_b64_tr_b16 a[88:89], v14 offset:28672
    ds_read_b64_tr_b16 a[90:91], v14 offset:29696
    s_add_u32 m0, s60, 117760
    s_add_u32 s63, s62, 98304
    buffer_load_dwordx4 v6, s[88:91], s63 offen lds
    s_waitcnt lgkmcnt(15)
    v_mfma_f32_32x32x16_bf16 v[176:191], a[28:31], a[48:51], v[176:191]
    ds_read_b64_tr_b16 a[92:93], v15 offset:28672
    ds_read_b64_tr_b16 a[94:95], v15 offset:29696
    s_waitcnt lgkmcnt(15)
    v_mfma_f32_32x32x16_bf16 v[192:207], a[48:51], a[32:35], v[192:207]
    ds_read_b64_tr_b16 a[96:97], v12 offset:45056
    ds_read_b64_tr_b16 a[98:99], v12 offset:46080
    s_waitcnt lgkmcnt(15)
    v_mfma_f32_32x32x16_bf16 v[208:223], a[48:51], a[36:39], v[208:223]
    ds_read_b64_tr_b16 a[100:101], v13 offset:45056
    ds_read_b64_tr_b16 a[102:103], v13 offset:46080
    s_waitcnt lgkmcnt(15)
    v_mfma_f32_32x32x16_bf16 v[224:239], a[48:51], a[40:43], v[224:239]
    ds_read_b64_tr_b16 a[104:105], v14 offset:45056
    ds_read_b64_tr_b16 a[106:107], v14 offset:46080
    s_waitcnt lgkmcnt(15)
    v_mfma_f32_32x32x16_bf16 v[240:255], a[48:51], a[44:47], v[240:255]
    ds_read_b64_tr_b16 a[108:109], v15 offset:45056
    ds_read_b64_tr_b16 a[110:111], v15 offset:46080
    s_waitcnt lgkmcnt(15)
    v_mfma_f32_32x32x16_bf16 v[64:79], a[64:67], a[112:115], v[64:79]
    s_waitcnt lgkmcnt(15)
    v_mfma_f32_32x32x16_bf16 v[80:95], a[68:71], a[112:115], v[80:95]
    s_waitcnt lgkmcnt(15)
    v_mfma_f32_32x32x16_bf16 v[96:111], a[72:75], a[112:115], v[96:111]
    s_waitcnt lgkmcnt(15)
    v_mfma_f32_32x32x16_bf16 v[112:127], a[76:79], a[112:115], v[112:127]
    s_waitcnt lgkmcnt(14)
    v_mfma_f32_32x32x16_bf16 v[128:143], a[80:83], a[112:115], v[128:143]
    s_waitcnt lgkmcnt(12)
    v_mfma_f32_32x32x16_bf16 v[144:159], a[84:87], a[112:115], v[144:159]
    s_waitcnt lgkmcnt(10)
    v_mfma_f32_32x32x16_bf16 v[160:175], a[88:91], a[112:115], v[160:175]
    s_waitcnt lgkmcnt(8)
    v_mfma_f32_32x32x16_bf16 v[176:191], a[92:95], a[112:115], v[176:191]
    s_waitcnt lgkmcnt(6)
    v_mfma_f32_32x32x16_bf16 v[192:207], a[112:115], a[96:99], v[192:207]
    s_waitcnt lgkmcnt(4)
    v_mfma_f32_32x32x16_bf16 v[208:223], a[112:115], a[100:103], v[208:223]
    s_waitcnt lgkmcnt(2)
    v_mfma_f32_32x32x16_bf16 v[224:239], a[112:115], a[104:107], v[224:239]
    s_waitcnt lgkmcnt(0)
    v_mfma_f32_32x32x16_bf16 v[240:255], a[112:115], a[108:111], v[240:255]
    v_add_u32 v8, 0x10000, v8
    v_add_u32 v12, 0x10000, v12
    v_add_u32 v9, 0x10000, v9
    v_add_u32 v13, 0x10000, v13
    v_add_u32 v10, 0x10000, v10
    v_add_u32 v14, 0x10000, v14
    v_add_u32 v11, 0x10000, v11
    v_add_u32 v15, 0x10000, v15
    s_waitcnt vmcnt(0)
    s_barrier
    ds_read_b128 a[48:51], v8
    ds_read_b64_tr_b16 a[0:1], v12 offset:0
    ds_read_b64_tr_b16 a[2:3], v12 offset:1024
    ds_read_b64_tr_b16 a[4:5], v13 offset:0
    ds_read_b64_tr_b16 a[6:7], v13 offset:1024
    ds_read_b64_tr_b16 a[8:9], v14 offset:0
    ds_read_b64_tr_b16 a[10:11], v14 offset:1024
    ds_read_b64_tr_b16 a[12:13], v15 offset:0
    ds_read_b64_tr_b16 a[14:15], v15 offset:1024
    ds_read_b64_tr_b16 a[16:17], v12 offset:16384
    ds_read_b64_tr_b16 a[18:19], v12 offset:17408
    ds_read_b64_tr_b16 a[20:21], v13 offset:16384
    ds_read_b64_tr_b16 a[22:23], v13 offset:17408
    ds_read_b64_tr_b16 a[24:25], v14 offset:16384
    ds_read_b64_tr_b16 a[26:27], v14 offset:17408
    ds_read_b64_tr_b16 a[28:29], v15 offset:16384
    ds_read_b64_tr_b16 a[30:31], v15 offset:17408
    ds_read_b64_tr_b16 a[32:33], v12 offset:32768
    ds_read_b64_tr_b16 a[34:35], v12 offset:33792
    ds_read_b64_tr_b16 a[36:37], v13 offset:32768
    ds_read_b64_tr_b16 a[38:39], v13 offset:33792
    ds_read_b64_tr_b16 a[40:41], v14 offset:32768
    ds_read_b64_tr_b16 a[42:43], v14 offset:33792
    ds_read_b64_tr_b16 a[44:45], v15 offset:32768
    ds_read_b64_tr_b16 a[46:47], v15 offset:33792
    s_add_u32 s100, s100, 1
    s_min_u32 s59, s100, 7
    s_waitcnt lgkmcnt(15)
    v_mfma_f32_32x32x16_bf16 v[64:79], a[0:3], a[48:51], v[64:79]
    ds_read_b128 a[112:115], v9
    ds_read_b64_tr_b16 a[64:65], v12 offset:4096
    ds_read_b64_tr_b16 a[66:67], v12 offset:5120
    s_lshl_b32 s60, s45, 12
    s_lshl_b32 s61, s59, 7
    s_add_u32 s61, s61, s55
    s_add_u32 m0, s60, 0
    s_nop 0
    buffer_load_dwordx4 v2, s[36:39], s61 offen lds
    s_waitcnt lgkmcnt(15)
    v_mfma_f32_32x32x16_bf16 v[80:95], a[4:7], a[48:51], v[80:95]
    ds_read_b64_tr_b16 a[68:69], v13 offset:4096
    ds_read_b64_tr_b16 a[70:71], v13 offset:5120
    s_waitcnt lgkmcnt(15)
    v_mfma_f32_32x32x16_bf16 v[96:111], a[8:11], a[48:51], v[96:111]
    ds_read_b64_tr_b16 a[72:73], v14 offset:4096
    ds_read_b64_tr_b16 a[74:75], v14 offset:5120
    s_add_u32 m0, s60, 1024
    s_nop 0
    buffer_load_dwordx4 v3, s[36:39], s61 offen lds
    s_waitcnt lgkmcnt(15)
    v_mfma_f32_32x32x16_bf16 v[112:127], a[12:15], a[48:51], v[112:127]
    ds_read_b64_tr_b16 a[76:77], v15 offset:4096
    ds_read_b64_tr_b16 a[78:79], v15 offset:5120
    s_waitcnt lgkmcnt(15)
    v_mfma_f32_32x32x16_bf16 v[128:143], a[16:19], a[48:51], v[128:143]
    ds_read_b64_tr_b16 a[80:81], v12 offset:20480
    ds_read_b64_tr_b16 a[82:83], v12 offset:21504
    s_add_u32 m0, s60, 2048
    s_nop 0
    buffer_load_dwordx4 v4, s[36:39], s61 offen lds
    s_waitcnt lgkmcnt(15)
    v_mfma_f32_32x32x16_bf16 v[144:159], a[20:23], a[48:51], v[144:159]
    ds_read_b64_tr_b16 a[84:85], v13 offset:20480
    ds_read_b64_tr_b16 a[86:87], v13 offset:21504
    s_waitcnt lgkmcnt(15)
    v_mfma_f32_32x32x16_bf16 v[160:175], a[24:27], a[48:51], v[160:175]
    ds_read_b64_tr_b16 a[88:89], v14 offset:20480
    ds_read_b64_tr_b16 a[90:91], v14 offset:21504
    s_add_u32 m0, s60, 3072
    s_nop 0
    buffer_load_dwordx4 v5, s[36:39], s61 offen lds
    s_waitcnt lgkmcnt(15)
    v_mfma_f32_32x32x16_bf16 v[176:191], a[28:31], a[48:51], v[176:191]
    ds_read_b64_tr_b16 a[92:93], v15 offset:20480
    ds_read_b64_tr_b16 a[94:95], v15 offset:21504
    s_waitcnt lgkmcnt(15)
    v_mfma_f32_32x32x16_bf16 v[192:207], a[48:51], a[32:35], v[192:207]
    ds_read_b64_tr_b16 a[96:97], v12 offset:36864
    ds_read_b64_tr_b16 a[98:99], v12 offset:37888
    s_lshl_b32 s61, s59, 6
    s_lshl_b32 s62, s45, 4
    s_add_u32 s61, s61, s62
    s_mul_i32 s61, s61, 8192
    s_add_u32 s62, s61, s56
    s_add_u32 m0, s60, 16384
    s_add_u32 s63, s62, 0
    buffer_load_dwordx4 v6, s[80:83], s63 offen lds
    s_waitcnt lgkmcnt(15)
    v_mfma_f32_32x32x16_bf16 v[208:223], a[48:51], a[36:39], v[208:223]
    ds_read_b64_tr_b16 a[100:101], v13 offset:36864
    ds_read_b64_tr_b16 a[102:103], v13 offset:37888
    s_waitcnt lgkmcnt(15)
    v_mfma_f32_32x32x16_bf16 v[224:239], a[48:51], a[40:43], v[224:239]
    ds_read_b64_tr_b16 a[104:105], v14 offset:36864
    ds_read_b64_tr_b16 a[106:107], v14 offset:37888
    s_add_u32 m0, s60, 17408
    s_add_u32 s63, s62, 32768
    buffer_load_dwordx4 v6, s[80:83], s63 offen lds
    s_waitcnt lgkmcnt(15)
    v_mfma_f32_32x32x16_bf16 v[240:255], a[48:51], a[44:47], v[240:255]
    ds_read_b64_tr_b16 a[108:109], v15 offset:36864
    ds_read_b64_tr_b16 a[110:111], v15 offset:37888
    s_waitcnt lgkmcnt(15)
    v_mfma_f32_32x32x16_bf16 v[64:79], a[64:67], a[112:115], v[64:79]
    ds_read_b128 a[48:51], v10
    ds_read_b64_tr_b16 a[0:1], v12 offset:8192
    ds_read_b64_tr_b16 a[2:3], v12 offset:9216
    s_add_u32 m0, s60, 18432
    s_add_u32 s63, s62, 65536
    buffer_load_dwordx4 v6, s[80:83], s63 offen lds
    s_waitcnt lgkmcnt(15)
    v_mfma_f32_32x32x16_bf16 v[80:95], a[68:71], a[112:115], v[80:95]
    ds_read_b64_tr_b16 a[4:5], v13 offset:8192
    ds_read_b64_tr_b16 a[6:7], v13 offset:9216
    s_waitcnt lgkmcnt(15)
    v_mfma_f32_32x32x16_bf16 v[96:111], a[72:75], a[112:115], v[96:111]
    ds_read_b64_tr_b16 a[8:9], v14 offset:8192
    ds_read_b64_tr_b16 a[10:11], v14 offset:9216
    s_add_u32 m0, s60, 19456
    s_add_u32 s63, s62, 98304
    buffer_load_dwordx4 v6, s[80:83], s63 offen lds
    s_waitcnt lgkmcnt(15)
    v_mfma_f32_32x32x16_bf16 v[112:127], a[76:79], a[112:115], v[112:127]
    ds_read_b64_tr_b16 a[12:13], v15 offset:8192
    ds_read_b64_tr_b16 a[14:15], v15 offset:9216
    s_waitcnt lgkmcnt(15)
    v_mfma_f32_32x32x16_bf16 v[128:143], a[80:83], a[112:115], v[128:143]
    ds_read_b64_tr_b16 a[16:17], v12 offset:24576
    ds_read_b64_tr_b16 a[18:19], v12 offset:25600
    s_add_u32 s62, s61, s57
    s_add_u32 m0, s60, 32768
    s_add_u32 s63, s62, 0
    buffer_load_dwordx4 v6, s[84:87], s63 offen lds
    s_waitcnt lgkmcnt(15)
    v_mfma_f32_32x32x16_bf16 v[144:159], a[84:87], a[112:115], v[144:159]
    ds_read_b64_tr_b16 a[20:21], v13 offset:24576
    ds_read_b64_tr_b16 a[22:23], v13 offset:25600
    s_waitcnt lgkmcnt(15)
    v_mfma_f32_32x32x16_bf16 v[160:175], a[88:91], a[112:115], v[160:175]
    ds_read_b64_tr_b16 a[24:25], v14 offset:24576
    ds_read_b64_tr_b16 a[26:27], v14 offset:25600
    s_add_u32 m0, s60, 33792
    s_add_u32 s63, s62, 32768
    buffer_load_dwordx4 v6, s[84:87], s63 offen lds
    s_waitcnt lgkmcnt(15)
    v_mfma_f32_32x32x16_bf16 v[176:191], a[92:95], a[112:115], v[176:191]
    ds_read_b64_tr_b16 a[28:29], v15 offset:24576
    ds_read_b64_tr_b16 a[30:31], v15 offset:25600
    s_waitcnt lgkmcnt(15)
    v_mfma_f32_32x32x16_bf16 v[192:207], a[112:115], a[96:99], v[192:207]
    ds_read_b64_tr_b16 a[32:33], v12 offset:40960
    ds_read_b64_tr_b16 a[34:35], v12 offset:41984
    s_add_u32 m0, s60, 34816
    s_add_u32 s63, s62, 65536
    buffer_load_dwordx4 v6, s[84:87], s63 offen lds
    s_waitcnt lgkmcnt(15)
    v_mfma_f32_32x32x16_bf16 v[208:223], a[112:115], a[100:103], v[208:223]
    ds_read_b64_tr_b16 a[36:37], v13 offset:40960
    ds_read_b64_tr_b16 a[38:39], v13 offset:41984
    s_waitcnt lgkmcnt(15)
    v_mfma_f32_32x32x16_bf16 v[224:239], a[112:115], a[104:107], v[224:239]
    ds_read_b64_tr_b16 a[40:41], v14 offset:40960
    ds_read_b64_tr_b16 a[42:43], v14 offset:41984
    s_add_u32 m0, s60, 35840
    s_add_u32 s63, s62, 98304
    buffer_load_dwordx4 v6, s[84:87], s63 offen lds
    s_waitcnt lgkmcnt(15)
    v_mfma_f32_32x32x16_bf16 v[240:255], a[112:115], a[108:111], v[240:255]
    ds_read_b64_tr_b16 a[44:45], v15 offset:40960
    ds_read_b64_tr_b16 a[46:47], v15 offset:41984
    s_waitcnt lgkmcnt(15)
    v_mfma_f32_32x32x16_bf16 v[64:79], a[0:3], a[48:51], v[64:79]
    ds_read_b128 a[112:115], v11
    ds_read_b64_tr_b16 a[64:65], v12 offset:12288
    ds_read_b64_tr_b16 a[66:67], v12 offset:13312
    s_add_u32 s62, s61, s58
    s_add_u32 m0, s60, 49152
    s_add_u32 s63, s62, 0
    buffer_load_dwordx4 v6, s[88:91], s63 offen lds
    s_waitcnt lgkmcnt(15)
    v_mfma_f32_32x32x16_bf16 v[80:95], a[4:7], a[48:51], v[80:95]
    ds_read_b64_tr_b16 a[68:69], v13 offset:12288
    ds_read_b64_tr_b16 a[70:71], v13 offset:13312
    s_waitcnt lgkmcnt(15)
    v_mfma_f32_32x32x16_bf16 v[96:111], a[8:11], a[48:51], v[96:111]
    ds_read_b64_tr_b16 a[72:73], v14 offset:12288
    ds_read_b64_tr_b16 a[74:75], v14 offset:13312
    s_add_u32 m0, s60, 50176
    s_add_u32 s63, s62, 32768
    buffer_load_dwordx4 v6, s[88:91], s63 offen lds
    s_waitcnt lgkmcnt(15)
    v_mfma_f32_32x32x16_bf16 v[112:127], a[12:15], a[48:51], v[112:127]
    ds_read_b64_tr_b16 a[76:77], v15 offset:12288
    ds_read_b64_tr_b16 a[78:79], v15 offset:13312
    s_waitcnt lgkmcnt(15)
    v_mfma_f32_32x32x16_bf16 v[128:143], a[16:19], a[48:51], v[128:143]
    ds_read_b64_tr_b16 a[80:81], v12 offset:28672
    ds_read_b64_tr_b16 a[82:83], v12 offset:29696
    s_add_u32 m0, s60, 51200
    s_add_u32 s63, s62, 65536
    buffer_load_dwordx4 v6, s[88:91], s63 offen lds
    s_waitcnt lgkmcnt(15)
    v_mfma_f32_32x32x16_bf16 v[144:159], a[20:23], a[48:51], v[144:159]
    ds_read_b64_tr_b16 a[84:85], v13 offset:28672
    ds_read_b64_tr_b16 a[86:87], v13 offset:29696
    s_waitcnt lgkmcnt(15)
    v_mfma_f32_32x32x16_bf16 v[160:175], a[24:27], a[48:51], v[160:175]
    ds_read_b64_tr_b16 a[88:89], v14 offset:28672
    ds_read_b64_tr_b16 a[90:91], v14 offset:29696
    s_add_u32 m0, s60, 52224
    s_add_u32 s63, s62, 98304
    buffer_load_dwordx4 v6, s[88:91], s63 offen lds
    s_waitcnt lgkmcnt(15)
    v_mfma_f32_32x32x16_bf16 v[176:191], a[28:31], a[48:51], v[176:191]
    ds_read_b64_tr_b16 a[92:93], v15 offset:28672
    ds_read_b64_tr_b16 a[94:95], v15 offset:29696
    s_waitcnt lgkmcnt(15)
    v_mfma_f32_32x32x16_bf16 v[192:207], a[48:51], a[32:35], v[192:207]
    ds_read_b64_tr_b16 a[96:97], v12 offset:45056
    ds_read_b64_tr_b16 a[98:99], v12 offset:46080
    s_waitcnt lgkmcnt(15)
    v_mfma_f32_32x32x16_bf16 v[208:223], a[48:51], a[36:39], v[208:223]
    ds_read_b64_tr_b16 a[100:101], v13 offset:45056
    ds_read_b64_tr_b16 a[102:103], v13 offset:46080
    s_waitcnt lgkmcnt(15)
    v_mfma_f32_32x32x16_bf16 v[224:239], a[48:51], a[40:43], v[224:239]
    ds_read_b64_tr_b16 a[104:105], v14 offset:45056
    ds_read_b64_tr_b16 a[106:107], v14 offset:46080
    s_waitcnt lgkmcnt(15)
    v_mfma_f32_32x32x16_bf16 v[240:255], a[48:51], a[44:47], v[240:255]
    ds_read_b64_tr_b16 a[108:109], v15 offset:45056
    ds_read_b64_tr_b16 a[110:111], v15 offset:46080
    s_waitcnt lgkmcnt(15)
    v_mfma_f32_32x32x16_bf16 v[64:79], a[64:67], a[112:115], v[64:79]
    s_waitcnt lgkmcnt(15)
    v_mfma_f32_32x32x16_bf16 v[80:95], a[68:71], a[112:115], v[80:95]
    s_waitcnt lgkmcnt(15)
    v_mfma_f32_32x32x16_bf16 v[96:111], a[72:75], a[112:115], v[96:111]
    s_waitcnt lgkmcnt(15)
    v_mfma_f32_32x32x16_bf16 v[112:127], a[76:79], a[112:115], v[112:127]
    s_waitcnt lgkmcnt(14)
    v_mfma_f32_32x32x16_bf16 v[128:143], a[80:83], a[112:115], v[128:143]
    s_waitcnt lgkmcnt(12)
    v_mfma_f32_32x32x16_bf16 v[144:159], a[84:87], a[112:115], v[144:159]
    s_waitcnt lgkmcnt(10)
    v_mfma_f32_32x32x16_bf16 v[160:175], a[88:91], a[112:115], v[160:175]
    s_waitcnt lgkmcnt(8)
    v_mfma_f32_32x32x16_bf16 v[176:191], a[92:95], a[112:115], v[176:191]
    s_waitcnt lgkmcnt(6)
    v_mfma_f32_32x32x16_bf16 v[192:207], a[112:115], a[96:99], v[192:207]
    s_waitcnt lgkmcnt(4)
    v_mfma_f32_32x32x16_bf16 v[208:223], a[112:115], a[100:103], v[208:223]
    s_waitcnt lgkmcnt(2)
    v_mfma_f32_32x32x16_bf16 v[224:239], a[112:115], a[104:107], v[224:239]
    s_waitcnt lgkmcnt(0)
    v_mfma_f32_32x32x16_bf16 v[240:255], a[112:115], a[108:111], v[240:255]
    v_add_u32 v8, 0xffff0000, v8
    v_add_u32 v12, 0xffff0000, v12
    v_add_u32 v9, 0xffff0000, v9
    v_add_u32 v13, 0xffff0000, v13
    v_add_u32 v10, 0xffff0000, v10
    v_add_u32 v14, 0xffff0000, v14
    v_add_u32 v11, 0xffff0000, v11
    v_add_u32 v15, 0xffff0000, v15
    s_cmp_lt_u32 s100, 8
    s_cbranch_scc1 L_gl_bp
    s_waitcnt vmcnt(0)
    s_nop 15
    s_lshl_b32 s60, s53, 2
    s_add_u32 s60, s60, s45
    s_lshl_b32 s60, s60, 5
    s_add_u32 s60, s60, s54
    s_lshl_b32 s60, s60, 13
    s_add_u32 s61, s60, 0x3000000
    s_add_u32 s62, s60, 0x1000000
    s_add_u32 s63, s60, 0x2000000
    v_bfe_u32 v24, v1, 4, 1
    v_lshlrev_b32 v24, 12, v24
    v_and_b32 v25, 15, v1
    v_lshl_add_u32 v24, v25, 4, v24
    v_lshrrev_b32 v26, 5, v1
    v_lshl_add_u32 v24, v26, 8, v24
    v_bfe_u32 v27, v1, 4, 1
    v_lshl_add_u32 v27, v27, 2, v26
    v_lshlrev_b32 v27, 8, v27
    v_lshl_add_u32 v27, v25, 4, v27
    v_cvt_pk_bf16_f32 v64, v64, v65
    v_cvt_pk_bf16_f32 v65, v66, v67
    v_cvt_pk_bf16_f32 v66, v68, v69
    v_cvt_pk_bf16_f32 v67, v70, v71
    v_cvt_pk_bf16_f32 v68, v72, v73
    v_cvt_pk_bf16_f32 v69, v74, v75
    v_cvt_pk_bf16_f32 v70, v76, v77
    v_cvt_pk_bf16_f32 v71, v78, v79
    s_nop 1
    v_permlane32_swap_b32 v64, v66
    v_permlane32_swap_b32 v65, v67
    v_permlane32_swap_b32 v68, v70
    v_permlane32_swap_b32 v69, v71
    s_nop 0
    buffer_store_dwordx4 v[64:67], v24, s[32:35], s61 offen offset:0 sc1
    buffer_store_dwordx4 v[68:71], v24, s[32:35], s61 offen offset:512 sc1
    v_cvt_pk_bf16_f32 v128, v128, v129
    v_cvt_pk_bf16_f32 v129, v130, v131
    v_cvt_pk_bf16_f32 v130, v132, v133
    v_cvt_pk_bf16_f32 v131, v134, v135
    v_cvt_pk_bf16_f32 v132, v136, v137
    v_cvt_pk_bf16_f32 v133, v138, v139
    v_cvt_pk_bf16_f32 v134, v140, v141
    v_cvt_pk_bf16_f32 v135, v142, v143
    s_nop 1
    v_permlane32_swap_b32 v128, v130
    v_permlane32_swap_b32 v129, v131
    v_permlane32_swap_b32 v132, v134
    v_permlane32_swap_b32 v133, v135
    s_nop 0
    buffer_store_dwordx4 v[128:131], v24, s[32:35], s62 offen offset:0 sc1
    buffer_store_dwordx4 v[132:135], v24, s[32:35], s62 offen offset:512 sc1
    v_cvt_pk_bf16_f32 v80, v80, v81
    v_cvt_pk_bf16_f32 v81, v82, v83
    v_cvt_pk_bf16_f32 v82, v84, v85
    v_cvt_pk_bf16_f32 v83, v86, v87
    v_cvt_pk_bf16_f32 v84, v88, v89
    v_cvt_pk_bf16_f32 v85, v90, v91
    v_cvt_pk_bf16_f32 v86, v92, v93
    v_cvt_pk_bf16_f32 v87, v94, v95
    s_nop 1
    v_permlane32_swap_b32 v80, v82
    v_permlane32_swap_b32 v81, v83
    v_permlane32_swap_b32 v84, v86
    v_permlane32_swap_b32 v85, v87
    s_nop 0
    buffer_store_dwordx4 v[80:83], v24, s[32:35], s61 offen offset:1024 sc1
    buffer_store_dwordx4 v[84:87], v24, s[32:35], s61 offen offset:1536 sc1
    v_cvt_pk_bf16_f32 v144, v144, v145
    v_cvt_pk_bf16_f32 v145, v146, v147
    v_cvt_pk_bf16_f32 v146, v148, v149
    v_cvt_pk_bf16_f32 v147, v150, v151
    v_cvt_pk_bf16_f32 v148, v152, v153
    v_cvt_pk_bf16_f32 v149, v154, v155
    v_cvt_pk_bf16_f32 v150, v156, v157
    v_cvt_pk_bf16_f32 v151, v158, v159
    s_nop 1
    v_permlane32_swap_b32 v144, v146
    v_permlane32_swap_b32 v145, v147
    v_permlane32_swap_b32 v148, v150
    v_permlane32_swap_b32 v149, v151
    s_nop 0
    buffer_store_dwordx4 v[144:147], v24, s[32:35], s62 offen offset:1024 sc1
    buffer_store_dwordx4 v[148:151], v24, s[32:35], s62 offen offset:1536 sc1
    v_cvt_pk_bf16_f32 v96, v96, v97
    v_cvt_pk_bf16_f32 v97, v98, v99
    v_cvt_pk_bf16_f32 v98, v100, v101
    v_cvt_pk_bf16_f32 v99, v102, v103
    v_cvt_pk_bf16_f32 v100, v104, v105
    v_cvt_pk_bf16_f32 v101, v106, v107
    v_cvt_pk_bf16_f32 v102, v108, v109
    v_cvt_pk_bf16_f32 v103, v110, v111
    s_nop 1
    v_permlane32_swap_b32 v96, v98
    v_permlane32_swap_b32 v97, v99
    v_permlane32_swap_b32 v100, v102
    v_permlane32_swap_b32 v101, v103
    s_nop 0
    buffer_store_dwordx4 v[96:99], v24, s[32:35], s61 offen offset:2048 sc1
    buffer_store_dwordx4 v[100:103], v24, s[32:35], s61 offen offset:2560 sc1
    v_cvt_pk_bf16_f32 v160, v160, v161
    v_cvt_pk_bf16_f32 v161, v162, v163
    v_cvt_pk_bf16_f32 v162, v164, v165
    v_cvt_pk_bf16_f32 v163, v166, v167
    v_cvt_pk_bf16_f32 v164, v168, v169
    v_cvt_pk_bf16_f32 v165, v170, v171
    v_cvt_pk_bf16_f32 v166, v172, v173
    v_cvt_pk_bf16_f32 v167, v174, v175
    s_nop 1
    v_permlane32_swap_b32 v160, v162
    v_permlane32_swap_b32 v161, v163
    v_permlane32_swap_b32 v164, v166
    v_permlane32_swap_b32 v165, v167
    s_nop 0
    buffer_store_dwordx4 v[160:163], v24, s[32:35], s62 offen offset:2048 sc1
    buffer_store_dwordx4 v[164:167], v24, s[32:35], s62 offen offset:2560 sc1
    v_cvt_pk_bf16_f32 v112, v112, v113
    v_cvt_pk_bf16_f32 v113, v114, v115
    v_cvt_pk_bf16_f32 v114, v116, v117
    v_cvt_pk_bf16_f32 v115, v118, v119
    v_cvt_pk_bf16_f32 v116, v120, v121
    v_cvt_pk_bf16_f32 v117, v122, v123
    v_cvt_pk_bf16_f32 v118, v124, v125
    v_cvt_pk_bf16_f32 v119, v126, v127
    s_nop 1
    v_permlane32_swap_b32 v112, v114
    v_permlane32_swap_b32 v113, v115
    v_permlane32_swap_b32 v116, v118
    v_permlane32_swap_b32 v117, v119
    s_nop 0
    buffer_store_dwordx4 v[112:115], v24, s[32:35], s61 offen offset:3072 sc1
    buffer_store_dwordx4 v[116:119], v24, s[32:35], s61 offen offset:3584 sc1
    v_cvt_pk_bf16_f32 v176, v176, v177
    v_cvt_pk_bf16_f32 v177, v178, v179
    v_cvt_pk_bf16_f32 v178, v180, v181
    v_cvt_pk_bf16_f32 v179, v182, v183
    v_cvt_pk_bf16_f32 v180, v184, v185
    v_cvt_pk_bf16_f32 v181, v186, v187
    v_cvt_pk_bf16_f32 v182, v188, v189
    v_cvt_pk_bf16_f32 v183, v190, v191
    s_nop 1
    v_permlane32_swap_b32 v176, v178
    v_permlane32_swap_b32 v177, v179
    v_permlane32_swap_b32 v180, v182
    v_permlane32_swap_b32 v181, v183
    s_nop 0
    buffer_store_dwordx4 v[176:179], v24, s[32:35], s62 offen offset:3072 sc1
    buffer_store_dwordx4 v[180:183], v24, s[32:35], s62 offen offset:3584 sc1
    v_cvt_pk_bf16_f32 v16, v192, v193
    v_cvt_pk_bf16_f32 v17, v194, v195
    v_cvt_pk_bf16_f32 v18, v200, v201
    v_cvt_pk_bf16_f32 v19, v202, v203
    v_cvt_pk_bf16_f32 v20, v196, v197
    v_cvt_pk_bf16_f32 v21, v198, v199
    v_cvt_pk_bf16_f32 v22, v204, v205
    v_cvt_pk_bf16_f32 v23, v206, v207
    buffer_store_dwordx4 v[16:19], v27, s[32:35], s63 offen offset:0 sc1
    buffer_store_dwordx4 v[20:23], v27, s[32:35], s63 offen offset:512 sc1
    s_nop 1
    v_cvt_pk_bf16_f32 v16, v208, v209
    v_cvt_pk_bf16_f32 v17, v210, v211
    v_cvt_pk_bf16_f32 v18, v216, v217
    v_cvt_pk_bf16_f32 v19, v218, v219
    v_cvt_pk_bf16_f32 v20, v212, v213
    v_cvt_pk_bf16_f32 v21, v214, v215
    v_cvt_pk_bf16_f32 v22, v220, v221
    v_cvt_pk_bf16_f32 v23, v222, v223
    buffer_store_dwordx4 v[16:19], v27, s[32:35], s63 offen offset:2048 sc1
    buffer_store_dwordx4 v[20:23], v27, s[32:35], s63 offen offset:2560 sc1
    s_nop 1
    s_add_u32 s63, s63, 4096
    v_cvt_pk_bf16_f32 v16, v224, v225
    v_cvt_pk_bf16_f32 v17, v226, v227
    v_cvt_pk_bf16_f32 v18, v232, v233
    v_cvt_pk_bf16_f32 v19, v234, v235
    v_cvt_pk_bf16_f32 v20, v228, v229
    v_cvt_pk_bf16_f32 v21, v230, v231
    v_cvt_pk_bf16_f32 v22, v236, v237
    v_cvt_pk_bf16_f32 v23, v238, v239
    buffer_store_dwordx4 v[16:19], v27, s[32:35], s63 offen offset:0 sc1
    buffer_store_dwordx4 v[20:23], v27, s[32:35], s63 offen offset:512 sc1
    s_nop 1
    v_cvt_pk_bf16_f32 v16, v240, v241
    v_cvt_pk_bf16_f32 v17, v242, v243
    v_cvt_pk_bf16_f32 v18, v248, v249
    v_cvt_pk_bf16_f32 v19, v250, v251
    v_cvt_pk_bf16_f32 v20, v244, v245
    v_cvt_pk_bf16_f32 v21, v246, v247
    v_cvt_pk_bf16_f32 v22, v252, v253
    v_cvt_pk_bf16_f32 v23, v254, v255
    buffer_store_dwordx4 v[16:19], v27, s[32:35], s63 offen offset:2048 sc1
    buffer_store_dwordx4 v[20:23], v27, s[32:35], s63 offen offset:2560 sc1
    s_nop 1
    s_lshl_b32 s60, s54, 7
    s_lshl_b32 s61, s53, 2
    s_add_u32 s60, s60, s61
    s_add_u32 s60, s60, 0x0
    s_waitcnt vmcnt(0)
    s_barrier
    s_cmp_lg_u32 s45, 0
    s_cbranch_scc1 L_w0_32
    s_cmp_lg_u32 s98, 0
    s_cbranch_scc1 L_id_34
    v_mov_b32 v16, 128
L_iw_33:
    s_add_u32 s101, s101, 1
    s_cmp_gt_u32 s101, 0x200000
    s_cbranch_scc1 L_exit
    global_load_dword v17, v16, s[26:27] sc1
    s_waitcnt vmcnt(0)
    v_readfirstlane_b32 s61, v17
    s_nop 2
    s_cmp_lt_u32 s61, 32
    s_cbranch_scc1 L_iw_33
    s_mov_b32 s98, 1
L_id_34:
    s_mov_b64 exec, 1
    v_mov_b32 v16, 0
    v_mov_b32 v17, 3
    buffer_atomic_add v17, v16, s[32:35], s60 offen
    s_mov_b64 exec, -1
L_w0_32:
    s_branch L_next
L_t_aproj:
    s_sub_u32 s60, s52, 512
    s_lshr_b32 s53, s60, 2
    s_and_b32 s54, s60, 3
    s_cmp_lg_u32 s45, 0
    s_cbranch_scc1 L_w0_35
    s_mov_b32 s60, 0x200
    s_cmp_lg_u32 s98, 0
    s_cbranch_scc1 L_id_37
    v_mov_b32 v16, 128
L_iw_36:
    s_add_u32 s101, s101, 1
    s_cmp_gt_u32 s101, 0x200000
    s_cbranch_scc1 L_exit
    global_load_dword v17, v16, s[26:27] sc1
    s_waitcnt vmcnt(0)
    v_readfirstlane_b32 s61, v17
    s_nop 2
    s_cmp_lt_u32 s61, 32
    s_cbranch_scc1 L_iw_36
    s_mov_b32 s98, 1
L_id_37:
    v_mov_b32 v16, 0
L_wait_38:
    s_add_u32 s101, s101, 1
    s_cmp_gt_u32 s101, 0x200000
    s_cbranch_scc1 L_exit
    buffer_load_dword v17, v16, s[32:35], s60 offen sc1
    s_waitcnt vmcnt(0)
    v_readfirstlane_b32 s61, v17
    s_nop 2
    s_cmp_ge_u32 s61, 3
    s_cbranch_scc1 L_waitd_39
    s_sleep 8
    s_branch L_wait_38
L_waitd_39:
L_w0_35:
    s_barrier
    s_mov_b32 s36, s4
    s_and_b32 s37, s5, 0xffff
    s_mov_b32 s38, 0x200000
    s_mov_b32 s39, 0x00020000
    s_mov_b32 s80, s6
    s_and_b32 s81, s7, 0xffff
    s_mov_b32 s82, 0x180000
    s_mov_b32 s83, 0x00020000
    v_lshrrev_b32 v16, 3, v1
    s_mov_b32 s60, 1024
    v_mul_lo_u32 v16, v16, s60
    v_and_b32 v17, 7, v1
    v_lshrrev_b32 v18, 4, v1
    v_xor_b32 v17, v17, v18
    v_lshl_add_u32 v16, v17, 4, v16
    v_xor_b32 v2, 0, v16
    v_xor_b32 v3, 64, v16
    v_add_u32 v3, 8192, v3
    v_xor_b32 v4, 0, v16
    v_add_u32 v4, 16384, v4
    v_xor_b32 v5, 64, v16
    v_add_u32 v5, 24576, v5
    s_mov_b32 s60, 3072
    v_mul_lo_u32 v16, v18, s60
    v_and_b32 v17, 15, v1
    v_lshlrev_b32 v19, 2, v18
    v_xor_b32 v17, v17, v19
    v_lshl_add_u32 v6, v17, 4, v16
    s_lshl_b32 s55, s53, 17
    s_lshl_b32 s60, s45, 15
    s_add_u32 s55, s55, s60
    s_lshl_b32 s56, s54, 8
    s_add_u32 s57, s56, 1024
    s_add_u32 s58, s56, 2048
    v_mov_b64 v[64:65], 0
    v_mov_b64 v[66:67], 0
    v_mov_b64 v[68:69], 0
    v_mov_b64 v[70:71], 0
    v_mov_b64 v[72:73], 0
    v_mov_b64 v[74:75], 0
    v_mov_b64 v[76:77], 0
    v_mov_b64 v[78:79], 0
    v_mov_b64 v[80:81], 0
    v_mov_b64 v[82:83], 0
    v_mov_b64 v[84:85], 0
    v_mov_b64 v[86:87], 0
    v_mov_b64 v[88:89], 0
    v_mov_b64 v[90:91], 0
    v_mov_b64 v[92:93], 0
    v_mov_b64 v[94:95], 0
    v_mov_b64 v[96:97], 0
    v_mov_b64 v[98:99], 0
    v_mov_b64 v[100:101], 0
    v_mov_b64 v[102:103], 0
    v_mov_b64 v[104:105], 0
    v_mov_b64 v[106:107], 0
    v_mov_b64 v[108:109], 0
    v_mov_b64 v[110:111], 0
    v_mov_b64 v[112:113], 0
    v_mov_b64 v[114:115], 0
    v_mov_b64 v[116:117], 0
    v_mov_b64 v[118:119], 0
    v_mov_b64 v[120:121], 0
    v_mov_b64 v[122:123], 0
    v_mov_b64 v[124:125], 0
    v_mov_b64 v[126:127], 0
    v_mov_b64 v[128:129], 0
    v_mov_b64 v[130:131], 0
    v_mov_b64 v[132:133], 0
    v_mov_b64 v[134:135], 0
    v_mov_b64 v[136:137], 0
    v_mov_b64 v[138:139], 0
    v_mov_b64 v[140:141], 0
    v_mov_b64 v[142:143], 0
    v_mov_b64 v[144:145], 0
    v_mov_b64 v[146:147], 0
    v_mov_b64 v[148:149], 0
    v_mov_b64 v[150:151], 0
    v_mov_b64 v[152:153], 0
    v_mov_b64 v[154:155], 0
    v_mov_b64 v[156:157], 0
    v_mov_b64 v[158:159], 0
    v_mov_b64 v[160:161], 0
    v_mov_b64 v[162:163], 0
    v_mov_b64 v[164:165], 0
    v_mov_b64 v[166:167], 0
    v_mov_b64 v[168:169], 0
    v_mov_b64 v[170:171], 0
    v_mov_b64 v[172:173], 0
    v_mov_b64 v[174:175], 0
    v_mov_b64 v[176:177], 0
    v_mov_b64 v[178:179], 0
    v_mov_b64 v[180:181], 0
    v_mov_b64 v[182:183], 0
    v_mov_b64 v[184:185], 0
    v_mov_b64 v[186:187], 0
    v_mov_b64 v[188:189], 0
    v_mov_b64 v[190:191], 0
    v_mov_b64 v[192:193], 0
    v_mov_b64 v[194:195], 0
    v_mov_b64 v[196:197], 0
    v_mov_b64 v[198:199], 0
    v_mov_b64 v[200:201], 0
    v_mov_b64 v[202:203], 0
    v_mov_b64 v[204:205], 0
    v_mov_b64 v[206:207], 0
    v_mov_b64 v[208:209], 0
    v_mov_b64 v[210:211], 0
    v_mov_b64 v[212:213], 0
    v_mov_b64 v[214:215], 0
    v_mov_b64 v[216:217], 0
    v_mov_b64 v[218:219], 0
    v_mov_b64 v[220:221], 0
    v_mov_b64 v[222:223], 0
    v_mov_b64 v[224:225], 0
    v_mov_b64 v[226:227], 0
    v_mov_b64 v[228:229], 0
    v_mov_b64 v[230:231], 0
    v_mov_b64 v[232:233], 0
    v_mov_b64 v[234:235], 0
    v_mov_b64 v[236:237], 0
    v_mov_b64 v[238:239], 0
    v_mov_b64 v[240:241], 0
    v_mov_b64 v[242:243], 0
    v_mov_b64 v[244:245], 0
    v_mov_b64 v[246:247], 0
    v_mov_b64 v[248:249], 0
    v_mov_b64 v[250:251], 0
    v_mov_b64 v[252:253], 0
    v_mov_b64 v[254:255], 0
    s_mov_b32 s59, 0
    s_lshl_b32 s60, s45, 12
    s_lshl_b32 s61, s59, 7
    s_add_u32 s61, s61, s55
    s_add_u32 m0, s60, 0
    s_nop 0
    buffer_load_dwordx4 v2, s[36:39], s61 offen lds
    s_add_u32 m0, s60, 1024
    s_nop 0
    buffer_load_dwordx4 v3, s[36:39], s61 offen lds
    s_add_u32 m0, s60, 2048
    s_nop 0
    buffer_load_dwordx4 v4, s[36:39], s61 offen lds
    s_add_u32 m0, s60, 3072
    s_nop 0
    buffer_load_dwordx4 v5, s[36:39], s61 offen lds
    s_lshl_b32 s61, s59, 6
    s_lshl_b32 s62, s45, 4
    s_add_u32 s61, s61, s62
    s_mul_i32 s61, s61, 3072
    s_add_u32 s62, s61, s56
    s_add_u32 m0, s60, 16384
    s_add_u32 s63, s62, 0
    buffer_load_dwordx4 v6, s[80:83], s63 offen lds
    s_add_u32 m0, s60, 17408
    s_add_u32 s63, s62, 12288
    buffer_load_dwordx4 v6, s[80:83], s63 offen lds
    s_add_u32 m0, s60, 18432
    s_add_u32 s63, s62, 24576
    buffer_load_dwordx4 v6, s[80:83], s63 offen lds
    s_add_u32 m0, s60, 19456
    s_add_u32 s63, s62, 36864
    buffer_load_dwordx4 v6, s[80:83], s63 offen lds
    s_add_u32 s62, s61, s57
    s_add_u32 m0, s60, 32768
    s_add_u32 s63, s62, 0
    buffer_load_dwordx4 v6, s[80:83], s63 offen lds
    s_add_u32 m0, s60, 33792
    s_add_u32 s63, s62, 12288
    buffer_load_dwordx4 v6, s[80:83], s63 offen lds
    s_add_u32 m0, s60, 34816
    s_add_u32 s63, s62, 24576
    buffer_load_dwordx4 v6, s[80:83], s63 offen lds
    s_add_u32 m0, s60, 35840
    s_add_u32 s63, s62, 36864
    buffer_load_dwordx4 v6, s[80:83], s63 offen lds
    s_add_u32 s62, s61, s58
    s_add_u32 m0, s60, 49152
    s_add_u32 s63, s62, 0
    buffer_load_dwordx4 v6, s[80:83], s63 offen lds
    s_add_u32 m0, s60, 50176
    s_add_u32 s63, s62, 12288
    buffer_load_dwordx4 v6, s[80:83], s63 offen lds
    s_add_u32 m0, s60, 51200
    s_add_u32 s63, s62, 24576
    buffer_load_dwordx4 v6, s[80:83], s63 offen lds
    s_add_u32 m0, s60, 52224
    s_add_u32 s63, s62, 36864
    buffer_load_dwordx4 v6, s[80:83], s63 offen lds
    s_mov_b32 s100, 0
L_gl_ap:
    s_waitcnt vmcnt(0)
L_gl_ap_in:
    s_barrier
    ds_read_b128 a[48:51], v8
    ds_read_b64_tr_b16 a[0:1], v12 offset:0
    ds_read_b64_tr_b16 a[2:3], v12 offset:1024
    ds_read_b64_tr_b16 a[4:5], v13 offset:0
    ds_read_b64_tr_b16 a[6:7], v13 offset:1024
    ds_read_b64_tr_b16 a[8:9], v14 offset:0
    ds_read_b64_tr_b16 a[10:11], v14 offset:1024
    ds_read_b64_tr_b16 a[12:13], v15 offset:0
    ds_read_b64_tr_b16 a[14:15], v15 offset:1024
    ds_read_b64_tr_b16 a[16:17], v12 offset:16384
    ds_read_b64_tr_b16 a[18:19], v12 offset:17408
    ds_read_b64_tr_b16 a[20:21], v13 offset:16384
    ds_read_b64_tr_b16 a[22:23], v13 offset:17408
    ds_read_b64_tr_b16 a[24:25], v14 offset:16384
    ds_read_b64_tr_b16 a[26:27], v14 offset:17408
    ds_read_b64_tr_b16 a[28:29], v15 offset:16384
    ds_read_b64_tr_b16 a[30:31], v15 offset:17408
    ds_read_b64_tr_b16 a[32:33], v12 offset:32768
    ds_read_b64_tr_b16 a[34:35], v12 offset:33792
    ds_read_b64_tr_b16 a[36:37], v13 offset:32768
    ds_read_b64_tr_b16 a[38:39], v13 offset:33792
    ds_read_b64_tr_b16 a[40:41], v14 offset:32768
    ds_read_b64_tr_b16 a[42:43], v14 offset:33792
    ds_read_b64_tr_b16 a[44:45], v15 offset:32768
    ds_read_b64_tr_b16 a[46:47], v15 offset:33792
    s_add_u32 s100, s100, 1
    s_min_u32 s59, s100, 7
    s_waitcnt lgkmcnt(15)
    v_mfma_f32_32x32x16_bf16 v[64:79], a[0:3], a[48:51], v[64:79]
    ds_read_b128 a[112:115], v9
    ds_read_b64_tr_b16 a[64:65], v12 offset:4096
    ds_read_b64_tr_b16 a[66:67], v12 offset:5120
    s_lshl_b32 s60, s45, 12
    s_lshl_b32 s61, s59, 7
    s_add_u32 s61, s61, s55
    s_add_u32 m0, s60, 65536
    s_nop 0
    buffer_load_dwordx4 v2, s[36:39], s61 offen lds
    s_waitcnt lgkmcnt(15)
    v_mfma_f32_32x32x16_bf16 v[80:95], a[4:7], a[48:51], v[80:95]
    ds_read_b64_tr_b16 a[68:69], v13 offset:4096
    ds_read_b64_tr_b16 a[70:71], v13 offset:5120
    s_waitcnt lgkmcnt(15)
    v_mfma_f32_32x32x16_bf16 v[96:111], a[8:11], a[48:51], v[96:111]
    ds_read_b64_tr_b16 a[72:73], v14 offset:4096
    ds_read_b64_tr_b16 a[74:75], v14 offset:5120
    s_add_u32 m0, s60, 66560
    s_nop 0
    buffer_load_dwordx4 v3, s[36:39], s61 offen lds
    s_waitcnt lgkmcnt(15)
    v_mfma_f32_32x32x16_bf16 v[112:127], a[12:15], a[48:51], v[112:127]
    ds_read_b64_tr_b16 a[76:77], v15 offset:4096
    ds_read_b64_tr_b16 a[78:79], v15 offset:5120
    s_waitcnt lgkmcnt(15)
    v_mfma_f32_32x32x16_bf16 v[128:143], a[16:19], a[48:51], v[128:143]
    ds_read_b64_tr_b16 a[80:81], v12 offset:20480
    ds_read_b64_tr_b16 a[82:83], v12 offset:21504
    s_add_u32 m0, s60, 67584
    s_nop 0
    buffer_load_dwordx4 v4, s[36:39], s61 offen lds
    s_waitcnt lgkmcnt(15)
    v_mfma_f32_32x32x16_bf16 v[144:159], a[20:23], a[48:51], v[144:159]
    ds_read_b64_tr_b16 a[84:85], v13 offset:20480
    ds_read_b64_tr_b16 a[86:87], v13 offset:21504
    s_waitcnt lgkmcnt(15)
    v_mfma_f32_32x32x16_bf16 v[160:175], a[24:27], a[48:51], v[160:175]
    ds_read_b64_tr_b16 a[88:89], v14 offset:20480
    ds_read_b64_tr_b16 a[90:91], v14 offset:21504
    s_add_u32 m0, s60, 68608
    s_nop 0
    buffer_load_dwordx4 v5, s[36:39], s61 offen lds
    s_waitcnt lgkmcnt(15)
    v_mfma_f32_32x32x16_bf16 v[176:191], a[28:31], a[48:51], v[176:191]
    ds_read_b64_tr_b16 a[92:93], v15 offset:20480
    ds_read_b64_tr_b16 a[94:95], v15 offset:21504
    s_waitcnt lgkmcnt(15)
    v_mfma_f32_32x32x16_bf16 v[192:207], a[48:51], a[32:35], v[192:207]
    ds_read_b64_tr_b16 a[96:97], v12 offset:36864
    ds_read_b64_tr_b16 a[98:99], v12 offset:37888
    s_lshl_b32 s61, s59, 6
    s_lshl_b32 s62, s45, 4
    s_add_u32 s61, s61, s62
    s_mul_i32 s61, s61, 3072
    s_add_u32 s62, s61, s56
    s_add_u32 m0, s60, 81920
    s_add_u32 s63, s62, 0
    buffer_load_dwordx4 v6, s[80:83], s63 offen lds
    s_waitcnt lgkmcnt(15)
    v_mfma_f32_32x32x16_bf16 v[208:223], a[48:51], a[36:39], v[208:223]
    ds_read_b64_tr_b16 a[100:101], v13 offset:36864
    ds_read_b64_tr_b16 a[102:103], v13 offset:37888
    s_waitcnt lgkmcnt(15)
    v_mfma_f32_32x32x16_bf16 v[224:239], a[48:51], a[40:43], v[224:239]
    ds_read_b64_tr_b16 a[104:105], v14 offset:36864
    ds_read_b64_tr_b16 a[106:107], v14 offset:37888
    s_add_u32 m0, s60, 82944
    s_add_u32 s63, s62, 12288
    buffer_load_dwordx4 v6, s[80:83], s63 offen lds
    s_waitcnt lgkmcnt(15)
    v_mfma_f32_32x32x16_bf16 v[240:255], a[48:51], a[44:47], v[240:255]
    ds_read_b64_tr_b16 a[108:109], v15 offset:36864
    ds_read_b64_tr_b16 a[110:111], v15 offset:37888
    s_waitcnt lgkmcnt(15)
    v_mfma_f32_32x32x16_bf16 v[64:79], a[64:67], a[112:115], v[64:79]
    ds_read_b128 a[48:51], v10
    ds_read_b64_tr_b16 a[0:1], v12 offset:8192
    ds_read_b64_tr_b16 a[2:3], v12 offset:9216
    s_add_u32 m0, s60, 83968
    s_add_u32 s63, s62, 24576
    buffer_load_dwordx4 v6, s[80:83], s63 offen lds
    s_waitcnt lgkmcnt(15)
    v_mfma_f32_32x32x16_bf16 v[80:95], a[68:71], a[112:115], v[80:95]
    ds_read_b64_tr_b16 a[4:5], v13 offset:8192
    ds_read_b64_tr_b16 a[6:7], v13 offset:9216
    s_waitcnt lgkmcnt(15)
    v_mfma_f32_32x32x16_bf16 v[96:111], a[72:75], a[112:115], v[96:111]
    ds_read_b64_tr_b16 a[8:9], v14 offset:8192
    ds_read_b64_tr_b16 a[10:11], v14 offset:9216
    s_add_u32 m0, s60, 84992
    s_add_u32 s63, s62, 36864
    buffer_load_dwordx4 v6, s[80:83], s63 offen lds
    s_waitcnt lgkmcnt(15)
    v_mfma_f32_32x32x16_bf16 v[112:127], a[76:79], a[112:115], v[112:127]
    ds_read_b64_tr_b16 a[12:13], v15 offset:8192
    ds_read_b64_tr_b16 a[14:15], v15 offset:9216
    s_waitcnt lgkmcnt(15)
    v_mfma_f32_32x32x16_bf16 v[128:143], a[80:83], a[112:115], v[128:143]
    ds_read_b64_tr_b16 a[16:17], v12 offset:24576
    ds_read_b64_tr_b16 a[18:19], v12 offset:25600
    s_add_u32 s62, s61, s57
    s_add_u32 m0, s60, 98304
    s_add_u32 s63, s62, 0
    buffer_load_dwordx4 v6, s[80:83], s63 offen lds
    s_waitcnt lgkmcnt(15)
    v_mfma_f32_32x32x16_bf16 v[144:159], a[84:87], a[112:115], v[144:159]
    ds_read_b64_tr_b16 a[20:21], v13 offset:24576
    ds_read_b64_tr_b16 a[22:23], v13 offset:25600
    s_waitcnt lgkmcnt(15)
    v_mfma_f32_32x32x16_bf16 v[160:175], a[88:91], a[112:115], v[160:175]
    ds_read_b64_tr_b16 a[24:25], v14 offset:24576
    ds_read_b64_tr_b16 a[26:27], v14 offset:25600
    s_add_u32 m0, s60, 99328
    s_add_u32 s63, s62, 12288
    buffer_load_dwordx4 v6, s[80:83], s63 offen lds
    s_waitcnt lgkmcnt(15)
    v_mfma_f32_32x32x16_bf16 v[176:191], a[92:95], a[112:115], v[176:191]
    ds_read_b64_tr_b16 a[28:29], v15 offset:24576
    ds_read_b64_tr_b16 a[30:31], v15 offset:25600
    s_waitcnt lgkmcnt(15)
    v_mfma_f32_32x32x16_bf16 v[192:207], a[112:115], a[96:99], v[192:207]
    ds_read_b64_tr_b16 a[32:33], v12 offset:40960
    ds_read_b64_tr_b16 a[34:35], v12 offset:41984
    s_add_u32 m0, s60, 100352
    s_add_u32 s63, s62, 24576
    buffer_load_dwordx4 v6, s[80:83], s63 offen lds
    s_waitcnt lgkmcnt(15)
    v_mfma_f32_32x32x16_bf16 v[208:223], a[112:115], a[100:103], v[208:223]
    ds_read_b64_tr_b16 a[36:37], v13 offset:40960
    ds_read_b64_tr_b16 a[38:39], v13 offset:41984
    s_waitcnt lgkmcnt(15)
    v_mfma_f32_32x32x16_bf16 v[224:239], a[112:115], a[104:107], v[224:239]
    ds_read_b64_tr_b16 a[40:41], v14 offset:40960
    ds_read_b64_tr_b16 a[42:43], v14 offset:41984
    s_add_u32 m0, s60, 101376
    s_add_u32 s63, s62, 36864
    buffer_load_dwordx4 v6, s[80:83], s63 offen lds
    s_waitcnt lgkmcnt(15)
    v_mfma_f32_32x32x16_bf16 v[240:255], a[112:115], a[108:111], v[240:255]
    ds_read_b64_tr_b16 a[44:45], v15 offset:40960
    ds_read_b64_tr_b16 a[46:47], v15 offset:41984
    s_waitcnt lgkmcnt(15)
    v_mfma_f32_32x32x16_bf16 v[64:79], a[0:3], a[48:51], v[64:79]
    ds_read_b128 a[112:115], v11
    ds_read_b64_tr_b16 a[64:65], v12 offset:12288
    ds_read_b64_tr_b16 a[66:67], v12 offset:13312
    s_add_u32 s62, s61, s58
    s_add_u32 m0, s60, 114688
    s_add_u32 s63, s62, 0
    buffer_load_dwordx4 v6, s[80:83], s63 offen lds
    s_waitcnt lgkmcnt(15)
    v_mfma_f32_32x32x16_bf16 v[80:95], a[4:7], a[48:51], v[80:95]
    ds_read_b64_tr_b16 a[68:69], v13 offset:12288
    ds_read_b64_tr_b16 a[70:71], v13 offset:13312
    s_waitcnt lgkmcnt(15)
    v_mfma_f32_32x32x16_bf16 v[96:111], a[8:11], a[48:51], v[96:111]
    ds_read_b64_tr_b16 a[72:73], v14 offset:12288
    ds_read_b64_tr_b16 a[74:75], v14 offset:13312
    s_add_u32 m0, s60, 115712
    s_add_u32 s63, s62, 12288
    buffer_load_dwordx4 v6, s[80:83], s63 offen lds
    s_waitcnt lgkmcnt(15)
    v_mfma_f32_32x32x16_bf16 v[112:127], a[12:15], a[48:51], v[112:127]
    ds_read_b64_tr_b16 a[76:77], v15 offset:12288
    ds_read_b64_tr_b16 a[78:79], v15 offset:13312
    s_waitcnt lgkmcnt(15)
    v_mfma_f32_32x32x16_bf16 v[128:143], a[16:19], a[48:51], v[128:143]
    ds_read_b64_tr_b16 a[80:81], v12 offset:28672
    ds_read_b64_tr_b16 a[82:83], v12 offset:29696
    s_add_u32 m0, s60, 116736
    s_add_u32 s63, s62, 24576
    buffer_load_dwordx4 v6, s[80:83], s63 offen lds
    s_waitcnt lgkmcnt(15)
    v_mfma_f32_32x32x16_bf16 v[144:159], a[20:23], a[48:51], v[144:159]
    ds_read_b64_tr_b16 a[84:85], v13 offset:28672
    ds_read_b64_tr_b16 a[86:87], v13 offset:29696
    s_waitcnt lgkmcnt(15)
    v_mfma_f32_32x32x16_bf16 v[160:175], a[24:27], a[48:51], v[160:175]
    ds_read_b64_tr_b16 a[88:89], v14 offset:28672
    ds_read_b64_tr_b16 a[90:91], v14 offset:29696
    s_add_u32 m0, s60, 117760
    s_add_u32 s63, s62, 36864
    buffer_load_dwordx4 v6, s[80:83], s63 offen lds
    s_waitcnt lgkmcnt(15)
    v_mfma_f32_32x32x16_bf16 v[176:191], a[28:31], a[48:51], v[176:191]
    ds_read_b64_tr_b16 a[92:93], v15 offset:28672
    ds_read_b64_tr_b16 a[94:95], v15 offset:29696
    s_waitcnt lgkmcnt(15)
    v_mfma_f32_32x32x16_bf16 v[192:207], a[48:51], a[32:35], v[192:207]
    ds_read_b64_tr_b16 a[96:97], v12 offset:45056
    ds_read_b64_tr_b16 a[98:99], v12 offset:46080
    s_waitcnt lgkmcnt(15)
    v_mfma_f32_32x32x16_bf16 v[208:223], a[48:51], a[36:39], v[208:223]
    ds_read_b64_tr_b16 a[100:101], v13 offset:45056
    ds_read_b64_tr_b16 a[102:103], v13 offset:46080
    s_waitcnt lgkmcnt(15)
    v_mfma_f32_32x32x16_bf16 v[224:239], a[48:51], a[40:43], v[224:239]
    ds_read_b64_tr_b16 a[104:105], v14 offset:45056
    ds_read_b64_tr_b16 a[106:107], v14 offset:46080
    s_waitcnt lgkmcnt(15)
    v_mfma_f32_32x32x16_bf16 v[240:255], a[48:51], a[44:47], v[240:255]
    ds_read_b64_tr_b16 a[108:109], v15 offset:45056
    ds_read_b64_tr_b16 a[110:111], v15 offset:46080
    s_waitcnt lgkmcnt(15)
    v_mfma_f32_32x32x16_bf16 v[64:79], a[64:67], a[112:115], v[64:79]
    s_waitcnt lgkmcnt(15)
    v_mfma_f32_32x32x16_bf16 v[80:95], a[68:71], a[112:115], v[80:95]
    s_waitcnt lgkmcnt(15)
    v_mfma_f32_32x32x16_bf16 v[96:111], a[72:75], a[112:115], v[96:111]
    s_waitcnt lgkmcnt(15)
    v_mfma_f32_32x32x16_bf16 v[112:127], a[76:79], a[112:115], v[112:127]
    s_waitcnt lgkmcnt(14)
    v_mfma_f32_32x32x16_bf16 v[128:143], a[80:83], a[112:115], v[128:143]
    s_waitcnt lgkmcnt(12)
    v_mfma_f32_32x32x16_bf16 v[144:159], a[84:87], a[112:115], v[144:159]
    s_waitcnt lgkmcnt(10)
    v_mfma_f32_32x32x16_bf16 v[160:175], a[88:91], a[112:115], v[160:175]
    s_waitcnt lgkmcnt(8)
    v_mfma_f32_32x32x16_bf16 v[176:191], a[92:95], a[112:115], v[176:191]
    s_waitcnt lgkmcnt(6)
    v_mfma_f32_32x32x16_bf16 v[192:207], a[112:115], a[96:99], v[192:207]
    s_waitcnt lgkmcnt(4)
    v_mfma_f32_32x32x16_bf16 v[208:223], a[112:115], a[100:103], v[208:223]
    s_waitcnt lgkmcnt(2)
    v_mfma_f32_32x32x16_bf16 v[224:239], a[112:115], a[104:107], v[224:239]
    s_waitcnt lgkmcnt(0)
    v_mfma_f32_32x32x16_bf16 v[240:255], a[112:115], a[108:111], v[240:255]
    v_add_u32 v8, 0x10000, v8
    v_add_u32 v12, 0x10000, v12
    v_add_u32 v9, 0x10000, v9
    v_add_u32 v13, 0x10000, v13
    v_add_u32 v10, 0x10000, v10
    v_add_u32 v14, 0x10000, v14
    v_add_u32 v11, 0x10000, v11
    v_add_u32 v15, 0x10000, v15
    s_waitcnt vmcnt(0)
    s_barrier
    ds_read_b128 a[48:51], v8
    ds_read_b64_tr_b16 a[0:1], v12 offset:0
    ds_read_b64_tr_b16 a[2:3], v12 offset:1024
    ds_read_b64_tr_b16 a[4:5], v13 offset:0
    ds_read_b64_tr_b16 a[6:7], v13 offset:1024
    ds_read_b64_tr_b16 a[8:9], v14 offset:0
    ds_read_b64_tr_b16 a[10:11], v14 offset:1024
    ds_read_b64_tr_b16 a[12:13], v15 offset:0
    ds_read_b64_tr_b16 a[14:15], v15 offset:1024
    ds_read_b64_tr_b16 a[16:17], v12 offset:16384
    ds_read_b64_tr_b16 a[18:19], v12 offset:17408
    ds_read_b64_tr_b16 a[20:21], v13 offset:16384
    ds_read_b64_tr_b16 a[22:23], v13 offset:17408
    ds_read_b64_tr_b16 a[24:25], v14 offset:16384
    ds_read_b64_tr_b16 a[26:27], v14 offset:17408
    ds_read_b64_tr_b16 a[28:29], v15 offset:16384
    ds_read_b64_tr_b16 a[30:31], v15 offset:17408
    ds_read_b64_tr_b16 a[32:33], v12 offset:32768
    ds_read_b64_tr_b16 a[34:35], v12 offset:33792
    ds_read_b64_tr_b16 a[36:37], v13 offset:32768
    ds_read_b64_tr_b16 a[38:39], v13 offset:33792
    ds_read_b64_tr_b16 a[40:41], v14 offset:32768
    ds_read_b64_tr_b16 a[42:43], v14 offset:33792
    ds_read_b64_tr_b16 a[44:45], v15 offset:32768
    ds_read_b64_tr_b16 a[46:47], v15 offset:33792
    s_add_u32 s100, s100, 1
    s_min_u32 s59, s100, 7
    s_waitcnt lgkmcnt(15)
    v_mfma_f32_32x32x16_bf16 v[64:79], a[0:3], a[48:51], v[64:79]
    ds_read_b128 a[112:115], v9
    ds_read_b64_tr_b16 a[64:65], v12 offset:4096
    ds_read_b64_tr_b16 a[66:67], v12 offset:5120
    s_lshl_b32 s60, s45, 12
    s_lshl_b32 s61, s59, 7
    s_add_u32 s61, s61, s55
    s_add_u32 m0, s60, 0
    s_nop 0
    buffer_load_dwordx4 v2, s[36:39], s61 offen lds
    s_waitcnt lgkmcnt(15)
    v_mfma_f32_32x32x16_bf16 v[80:95], a[4:7], a[48:51], v[80:95]
    ds_read_b64_tr_b16 a[68:69], v13 offset:4096
    ds_read_b64_tr_b16 a[70:71], v13 offset:5120
    s_waitcnt lgkmcnt(15)
    v_mfma_f32_32x32x16_bf16 v[96:111], a[8:11], a[48:51], v[96:111]
    ds_read_b64_tr_b16 a[72:73], v14 offset:4096
    ds_read_b64_tr_b16 a[74:75], v14 offset:5120
    s_add_u32 m0, s60, 1024
    s_nop 0
    buffer_load_dwordx4 v3, s[36:39], s61 offen lds
    s_waitcnt lgkmcnt(15)
    v_mfma_f32_32x32x16_bf16 v[112:127], a[12:15], a[48:51], v[112:127]
    ds_read_b64_tr_b16 a[76:77], v15 offset:4096
    ds_read_b64_tr_b16 a[78:79], v15 offset:5120
    s_waitcnt lgkmcnt(15)
    v_mfma_f32_32x32x16_bf16 v[128:143], a[16:19], a[48:51], v[128:143]
    ds_read_b64_tr_b16 a[80:81], v12 offset:20480
    ds_read_b64_tr_b16 a[82:83], v12 offset:21504
    s_add_u32 m0, s60, 2048
    s_nop 0
    buffer_load_dwordx4 v4, s[36:39], s61 offen lds
    s_waitcnt lgkmcnt(15)
    v_mfma_f32_32x32x16_bf16 v[144:159], a[20:23], a[48:51], v[144:159]
    ds_read_b64_tr_b16 a[84:85], v13 offset:20480
    ds_read_b64_tr_b16 a[86:87], v13 offset:21504
    s_waitcnt lgkmcnt(15)
    v_mfma_f32_32x32x16_bf16 v[160:175], a[24:27], a[48:51], v[160:175]
    ds_read_b64_tr_b16 a[88:89], v14 offset:20480
    ds_read_b64_tr_b16 a[90:91], v14 offset:21504
    s_add_u32 m0, s60, 3072
    s_nop 0
    buffer_load_dwordx4 v5, s[36:39], s61 offen lds
    s_waitcnt lgkmcnt(15)
    v_mfma_f32_32x32x16_bf16 v[176:191], a[28:31], a[48:51], v[176:191]
    ds_read_b64_tr_b16 a[92:93], v15 offset:20480
    ds_read_b64_tr_b16 a[94:95], v15 offset:21504
    s_waitcnt lgkmcnt(15)
    v_mfma_f32_32x32x16_bf16 v[192:207], a[48:51], a[32:35], v[192:207]
    ds_read_b64_tr_b16 a[96:97], v12 offset:36864
    ds_read_b64_tr_b16 a[98:99], v12 offset:37888
    s_lshl_b32 s61, s59, 6
    s_lshl_b32 s62, s45, 4
    s_add_u32 s61, s61, s62
    s_mul_i32 s61, s61, 3072
    s_add_u32 s62, s61, s56
    s_add_u32 m0, s60, 16384
    s_add_u32 s63, s62, 0
    buffer_load_dwordx4 v6, s[80:83], s63 offen lds
    s_waitcnt lgkmcnt(15)
    v_mfma_f32_32x32x16_bf16 v[208:223], a[48:51], a[36:39], v[208:223]
    ds_read_b64_tr_b16 a[100:101], v13 offset:36864
    ds_read_b64_tr_b16 a[102:103], v13 offset:37888
    s_waitcnt lgkmcnt(15)
    v_mfma_f32_32x32x16_bf16 v[224:239], a[48:51], a[40:43], v[224:239]
    ds_read_b64_tr_b16 a[104:105], v14 offset:36864
    ds_read_b64_tr_b16 a[106:107], v14 offset:37888
    s_add_u32 m0, s60, 17408
    s_add_u32 s63, s62, 12288
    buffer_load_dwordx4 v6, s[80:83], s63 offen lds
    s_waitcnt lgkmcnt(15)
    v_mfma_f32_32x32x16_bf16 v[240:255], a[48:51], a[44:47], v[240:255]
    ds_read_b64_tr_b16 a[108:109], v15 offset:36864
    ds_read_b64_tr_b16 a[110:111], v15 offset:37888
    s_waitcnt lgkmcnt(15)
    v_mfma_f32_32x32x16_bf16 v[64:79], a[64:67], a[112:115], v[64:79]
    ds_read_b128 a[48:51], v10
    ds_read_b64_tr_b16 a[0:1], v12 offset:8192
    ds_read_b64_tr_b16 a[2:3], v12 offset:9216
    s_add_u32 m0, s60, 18432
    s_add_u32 s63, s62, 24576
    buffer_load_dwordx4 v6, s[80:83], s63 offen lds
    s_waitcnt lgkmcnt(15)
    v_mfma_f32_32x32x16_bf16 v[80:95], a[68:71], a[112:115], v[80:95]
    ds_read_b64_tr_b16 a[4:5], v13 offset:8192
    ds_read_b64_tr_b16 a[6:7], v13 offset:9216
    s_waitcnt lgkmcnt(15)
    v_mfma_f32_32x32x16_bf16 v[96:111], a[72:75], a[112:115], v[96:111]
    ds_read_b64_tr_b16 a[8:9], v14 offset:8192
    ds_read_b64_tr_b16 a[10:11], v14 offset:9216
    s_add_u32 m0, s60, 19456
    s_add_u32 s63, s62, 36864
    buffer_load_dwordx4 v6, s[80:83], s63 offen lds
    s_waitcnt lgkmcnt(15)
    v_mfma_f32_32x32x16_bf16 v[112:127], a[76:79], a[112:115], v[112:127]
    ds_read_b64_tr_b16 a[12:13], v15 offset:8192
    ds_read_b64_tr_b16 a[14:15], v15 offset:9216
    s_waitcnt lgkmcnt(15)
    v_mfma_f32_32x32x16_bf16 v[128:143], a[80:83], a[112:115], v[128:143]
    ds_read_b64_tr_b16 a[16:17], v12 offset:24576
    ds_read_b64_tr_b16 a[18:19], v12 offset:25600
    s_add_u32 s62, s61, s57
    s_add_u32 m0, s60, 32768
    s_add_u32 s63, s62, 0
    buffer_load_dwordx4 v6, s[80:83], s63 offen lds
    s_waitcnt lgkmcnt(15)
    v_mfma_f32_32x32x16_bf16 v[144:159], a[84:87], a[112:115], v[144:159]
    ds_read_b64_tr_b16 a[20:21], v13 offset:24576
    ds_read_b64_tr_b16 a[22:23], v13 offset:25600
    s_waitcnt lgkmcnt(15)
    v_mfma_f32_32x32x16_bf16 v[160:175], a[88:91], a[112:115], v[160:175]
    ds_read_b64_tr_b16 a[24:25], v14 offset:24576
    ds_read_b64_tr_b16 a[26:27], v14 offset:25600
    s_add_u32 m0, s60, 33792
    s_add_u32 s63, s62, 12288
    buffer_load_dwordx4 v6, s[80:83], s63 offen lds
    s_waitcnt lgkmcnt(15)
    v_mfma_f32_32x32x16_bf16 v[176:191], a[92:95], a[112:115], v[176:191]
    ds_read_b64_tr_b16 a[28:29], v15 offset:24576
    ds_read_b64_tr_b16 a[30:31], v15 offset:25600
    s_waitcnt lgkmcnt(15)
    v_mfma_f32_32x32x16_bf16 v[192:207], a[112:115], a[96:99], v[192:207]
    ds_read_b64_tr_b16 a[32:33], v12 offset:40960
    ds_read_b64_tr_b16 a[34:35], v12 offset:41984
    s_add_u32 m0, s60, 34816
    s_add_u32 s63, s62, 24576
    buffer_load_dwordx4 v6, s[80:83], s63 offen lds
    s_waitcnt lgkmcnt(15)
    v_mfma_f32_32x32x16_bf16 v[208:223], a[112:115], a[100:103], v[208:223]
    ds_read_b64_tr_b16 a[36:37], v13 offset:40960
    ds_read_b64_tr_b16 a[38:39], v13 offset:41984
    s_waitcnt lgkmcnt(15)
    v_mfma_f32_32x32x16_bf16 v[224:239], a[112:115], a[104:107], v[224:239]
    ds_read_b64_tr_b16 a[40:41], v14 offset:40960
    ds_read_b64_tr_b16 a[42:43], v14 offset:41984
    s_add_u32 m0, s60, 35840
    s_add_u32 s63, s62, 36864
    buffer_load_dwordx4 v6, s[80:83], s63 offen lds
    s_waitcnt lgkmcnt(15)
    v_mfma_f32_32x32x16_bf16 v[240:255], a[112:115], a[108:111], v[240:255]
    ds_read_b64_tr_b16 a[44:45], v15 offset:40960
    ds_read_b64_tr_b16 a[46:47], v15 offset:41984
    s_waitcnt lgkmcnt(15)
    v_mfma_f32_32x32x16_bf16 v[64:79], a[0:3], a[48:51], v[64:79]
    ds_read_b128 a[112:115], v11
    ds_read_b64_tr_b16 a[64:65], v12 offset:12288
    ds_read_b64_tr_b16 a[66:67], v12 offset:13312
    s_add_u32 s62, s61, s58
    s_add_u32 m0, s60, 49152
    s_add_u32 s63, s62, 0
    buffer_load_dwordx4 v6, s[80:83], s63 offen lds
    s_waitcnt lgkmcnt(15)
    v_mfma_f32_32x32x16_bf16 v[80:95], a[4:7], a[48:51], v[80:95]
    ds_read_b64_tr_b16 a[68:69], v13 offset:12288
    ds_read_b64_tr_b16 a[70:71], v13 offset:13312
    s_waitcnt lgkmcnt(15)
    v_mfma_f32_32x32x16_bf16 v[96:111], a[8:11], a[48:51], v[96:111]
    ds_read_b64_tr_b16 a[72:73], v14 offset:12288
    ds_read_b64_tr_b16 a[74:75], v14 offset:13312
    s_add_u32 m0, s60, 50176
    s_add_u32 s63, s62, 12288
    buffer_load_dwordx4 v6, s[80:83], s63 offen lds
    s_waitcnt lgkmcnt(15)
    v_mfma_f32_32x32x16_bf16 v[112:127], a[12:15], a[48:51], v[112:127]
    ds_read_b64_tr_b16 a[76:77], v15 offset:12288
    ds_read_b64_tr_b16 a[78:79], v15 offset:13312
    s_waitcnt lgkmcnt(15)
    v_mfma_f32_32x32x16_bf16 v[128:143], a[16:19], a[48:51], v[128:143]
    ds_read_b64_tr_b16 a[80:81], v12 offset:28672
    ds_read_b64_tr_b16 a[82:83], v12 offset:29696
    s_add_u32 m0, s60, 51200
    s_add_u32 s63, s62, 24576
    buffer_load_dwordx4 v6, s[80:83], s63 offen lds
    s_waitcnt lgkmcnt(15)
    v_mfma_f32_32x32x16_bf16 v[144:159], a[20:23], a[48:51], v[144:159]
    ds_read_b64_tr_b16 a[84:85], v13 offset:28672
    ds_read_b64_tr_b16 a[86:87], v13 offset:29696
    s_waitcnt lgkmcnt(15)
    v_mfma_f32_32x32x16_bf16 v[160:175], a[24:27], a[48:51], v[160:175]
    ds_read_b64_tr_b16 a[88:89], v14 offset:28672
    ds_read_b64_tr_b16 a[90:91], v14 offset:29696
    s_add_u32 m0, s60, 52224
    s_add_u32 s63, s62, 36864
    buffer_load_dwordx4 v6, s[80:83], s63 offen lds
    s_waitcnt lgkmcnt(15)
    v_mfma_f32_32x32x16_bf16 v[176:191], a[28:31], a[48:51], v[176:191]
    ds_read_b64_tr_b16 a[92:93], v15 offset:28672
    ds_read_b64_tr_b16 a[94:95], v15 offset:29696
    s_waitcnt lgkmcnt(15)
    v_mfma_f32_32x32x16_bf16 v[192:207], a[48:51], a[32:35], v[192:207]
    ds_read_b64_tr_b16 a[96:97], v12 offset:45056
    ds_read_b64_tr_b16 a[98:99], v12 offset:46080
    s_waitcnt lgkmcnt(15)
    v_mfma_f32_32x32x16_bf16 v[208:223], a[48:51], a[36:39], v[208:223]
    ds_read_b64_tr_b16 a[100:101], v13 offset:45056
    ds_read_b64_tr_b16 a[102:103], v13 offset:46080
    s_waitcnt lgkmcnt(15)
    v_mfma_f32_32x32x16_bf16 v[224:239], a[48:51], a[40:43], v[224:239]
    ds_read_b64_tr_b16 a[104:105], v14 offset:45056
    ds_read_b64_tr_b16 a[106:107], v14 offset:46080
    s_waitcnt lgkmcnt(15)
    v_mfma_f32_32x32x16_bf16 v[240:255], a[48:51], a[44:47], v[240:255]
    ds_read_b64_tr_b16 a[108:109], v15 offset:45056
    ds_read_b64_tr_b16 a[110:111], v15 offset:46080
    s_waitcnt lgkmcnt(15)
    v_mfma_f32_32x32x16_bf16 v[64:79], a[64:67], a[112:115], v[64:79]
    s_waitcnt lgkmcnt(15)
    v_mfma_f32_32x32x16_bf16 v[80:95], a[68:71], a[112:115], v[80:95]
    s_waitcnt lgkmcnt(15)
    v_mfma_f32_32x32x16_bf16 v[96:111], a[72:75], a[112:115], v[96:111]
    s_waitcnt lgkmcnt(15)
    v_mfma_f32_32x32x16_bf16 v[112:127], a[76:79], a[112:115], v[112:127]
    s_waitcnt lgkmcnt(14)
    v_mfma_f32_32x32x16_bf16 v[128:143], a[80:83], a[112:115], v[128:143]
    s_waitcnt lgkmcnt(12)
    v_mfma_f32_32x32x16_bf16 v[144:159], a[84:87], a[112:115], v[144:159]
    s_waitcnt lgkmcnt(10)
    v_mfma_f32_32x32x16_bf16 v[160:175], a[88:91], a[112:115], v[160:175]
    s_waitcnt lgkmcnt(8)
    v_mfma_f32_32x32x16_bf16 v[176:191], a[92:95], a[112:115], v[176:191]
    s_waitcnt lgkmcnt(6)
    v_mfma_f32_32x32x16_bf16 v[192:207], a[112:115], a[96:99], v[192:207]
    s_waitcnt lgkmcnt(4)
    v_mfma_f32_32x32x16_bf16 v[208:223], a[112:115], a[100:103], v[208:223]
    s_waitcnt lgkmcnt(2)
    v_mfma_f32_32x32x16_bf16 v[224:239], a[112:115], a[104:107], v[224:239]
    s_waitcnt lgkmcnt(0)
    v_mfma_f32_32x32x16_bf16 v[240:255], a[112:115], a[108:111], v[240:255]
    v_add_u32 v8, 0xffff0000, v8
    v_add_u32 v12, 0xffff0000, v12
    v_add_u32 v9, 0xffff0000, v9
    v_add_u32 v13, 0xffff0000, v13
    v_add_u32 v10, 0xffff0000, v10
    v_add_u32 v14, 0xffff0000, v14
    v_add_u32 v11, 0xffff0000, v11
    v_add_u32 v15, 0xffff0000, v15
    s_cmp_lt_u32 s100, 8
    s_cbranch_scc1 L_gl_ap
    s_waitcnt vmcnt(0)
    s_nop 15
    v_and_b32 v24, 31, v1
    v_lshlrev_b32 v24, 5, v24
    v_lshrrev_b32 v26, 5, v1
    v_lshl_add_u32 v24, v26, 3, v24
    v_add_u32 v28, 65536, v24
    s_lshl_b32 s60, s53, 2
    s_add_u32 s60, s60, s45
    s_lshl_b32 s60, s60, 10
    s_lshl_b32 s61, s54, 19
    s_add_u32 s60, s60, s61
    s_add_u32 s62, s60, 0x6000000
    v_cvt_pk_bf16_f32 v64, v64, v65
    v_cvt_pk_bf16_f32 v65, v66, v67
    v_cvt_pk_bf16_f32 v68, v68, v69
    v_cvt_pk_bf16_f32 v69, v70, v71
    v_cvt_pk_bf16_f32 v72, v72, v73
    v_cvt_pk_bf16_f32 v73, v74, v75
    v_cvt_pk_bf16_f32 v76, v76, v77
    v_cvt_pk_bf16_f32 v77, v78, v79
    buffer_store_dwordx2 v[64:65], v24, s[32:35], s62 offen offset:0 sc1
    buffer_store_dwordx2 v[68:69], v24, s[32:35], s62 offen offset:16 sc1
    buffer_store_dwordx2 v[72:73], v28, s[32:35], s62 offen offset:0 sc1
    buffer_store_dwordx2 v[76:77], v28, s[32:35], s62 offen offset:16 sc1
    s_add_u32 s62, s60, 0x6200000
    v_cvt_pk_bf16_f32 v128, v128, v129
    v_cvt_pk_bf16_f32 v129, v130, v131
    v_cvt_pk_bf16_f32 v132, v132, v133
    v_cvt_pk_bf16_f32 v133, v134, v135
    v_cvt_pk_bf16_f32 v136, v136, v137
    v_cvt_pk_bf16_f32 v137, v138, v139
    v_cvt_pk_bf16_f32 v140, v140, v141
    v_cvt_pk_bf16_f32 v141, v142, v143
    buffer_store_dwordx2 v[128:129], v24, s[32:35], s62 offen offset:0 sc1
    buffer_store_dwordx2 v[132:133], v24, s[32:35], s62 offen offset:16 sc1
    buffer_store_dwordx2 v[136:137], v28, s[32:35], s62 offen offset:0 sc1
    buffer_store_dwordx2 v[140:141], v28, s[32:35], s62 offen offset:16 sc1
    s_add_u32 s62, s60, 0x6020000
    v_cvt_pk_bf16_f32 v80, v80, v81
    v_cvt_pk_bf16_f32 v81, v82, v83
    v_cvt_pk_bf16_f32 v84, v84, v85
    v_cvt_pk_bf16_f32 v85, v86, v87
    v_cvt_pk_bf16_f32 v88, v88, v89
    v_cvt_pk_bf16_f32 v89, v90, v91
    v_cvt_pk_bf16_f32 v92, v92, v93
    v_cvt_pk_bf16_f32 v93, v94, v95
    buffer_store_dwordx2 v[80:81], v24, s[32:35], s62 offen offset:0 sc1
    buffer_store_dwordx2 v[84:85], v24, s[32:35], s62 offen offset:16 sc1
    buffer_store_dwordx2 v[88:89], v28, s[32:35], s62 offen offset:0 sc1
    buffer_store_dwordx2 v[92:93], v28, s[32:35], s62 offen offset:16 sc1
    s_add_u32 s62, s60, 0x6220000
    v_cvt_pk_bf16_f32 v144, v144, v145
    v_cvt_pk_bf16_f32 v145, v146, v147
    v_cvt_pk_bf16_f32 v148, v148, v149
    v_cvt_pk_bf16_f32 v149, v150, v151
    v_cvt_pk_bf16_f32 v152, v152, v153
    v_cvt_pk_bf16_f32 v153, v154, v155
    v_cvt_pk_bf16_f32 v156, v156, v157
    v_cvt_pk_bf16_f32 v157, v158, v159
    buffer_store_dwordx2 v[144:145], v24, s[32:35], s62 offen offset:0 sc1
    buffer_store_dwordx2 v[148:149], v24, s[32:35], s62 offen offset:16 sc1
    buffer_store_dwordx2 v[152:153], v28, s[32:35], s62 offen offset:0 sc1
    buffer_store_dwordx2 v[156:157], v28, s[32:35], s62 offen offset:16 sc1
    s_add_u32 s62, s60, 0x6040000
    v_cvt_pk_bf16_f32 v96, v96, v97
    v_cvt_pk_bf16_f32 v97, v98, v99
    v_cvt_pk_bf16_f32 v100, v100, v101
    v_cvt_pk_bf16_f32 v101, v102, v103
    v_cvt_pk_bf16_f32 v104, v104, v105
    v_cvt_pk_bf16_f32 v105, v106, v107
    v_cvt_pk_bf16_f32 v108, v108, v109
    v_cvt_pk_bf16_f32 v109, v110, v111
    buffer_store_dwordx2 v[96:97], v24, s[32:35], s62 offen offset:0 sc1
    buffer_store_dwordx2 v[100:101], v24, s[32:35], s62 offen offset:16 sc1
    buffer_store_dwordx2 v[104:105], v28, s[32:35], s62 offen offset:0 sc1
    buffer_store_dwordx2 v[108:109], v28, s[32:35], s62 offen offset:16 sc1
    s_add_u32 s62, s60, 0x6240000
    v_cvt_pk_bf16_f32 v160, v160, v161
    v_cvt_pk_bf16_f32 v161, v162, v163
    v_cvt_pk_bf16_f32 v164, v164, v165
    v_cvt_pk_bf16_f32 v165, v166, v167
    v_cvt_pk_bf16_f32 v168, v168, v169
    v_cvt_pk_bf16_f32 v169, v170, v171
    v_cvt_pk_bf16_f32 v172, v172, v173
    v_cvt_pk_bf16_f32 v173, v174, v175
    buffer_store_dwordx2 v[160:161], v24, s[32:35], s62 offen offset:0 sc1
    buffer_store_dwordx2 v[164:165], v24, s[32:35], s62 offen offset:16 sc1
    buffer_store_dwordx2 v[168:169], v28, s[32:35], s62 offen offset:0 sc1
    buffer_store_dwordx2 v[172:173], v28, s[32:35], s62 offen offset:16 sc1
    s_add_u32 s62, s60, 0x6060000
    v_cvt_pk_bf16_f32 v112, v112, v113
    v_cvt_pk_bf16_f32 v113, v114, v115
    v_cvt_pk_bf16_f32 v116, v116, v117
    v_cvt_pk_bf16_f32 v117, v118, v119
    v_cvt_pk_bf16_f32 v120, v120, v121
    v_cvt_pk_bf16_f32 v121, v122, v123
    v_cvt_pk_bf16_f32 v124, v124, v125
    v_cvt_pk_bf16_f32 v125, v126, v127
    buffer_store_dwordx2 v[112:113], v24, s[32:35], s62 offen offset:0 sc1
    buffer_store_dwordx2 v[116:117], v24, s[32:35], s62 offen offset:16 sc1
    buffer_store_dwordx2 v[120:121], v28, s[32:35], s62 offen offset:0 sc1
    buffer_store_dwordx2 v[124:125], v28, s[32:35], s62 offen offset:16 sc1
    s_add_u32 s62, s60, 0x6260000
    v_cvt_pk_bf16_f32 v176, v176, v177
    v_cvt_pk_bf16_f32 v177, v178, v179
    v_cvt_pk_bf16_f32 v180, v180, v181
    v_cvt_pk_bf16_f32 v181, v182, v183
    v_cvt_pk_bf16_f32 v184, v184, v185
    v_cvt_pk_bf16_f32 v185, v186, v187
    v_cvt_pk_bf16_f32 v188, v188, v189
    v_cvt_pk_bf16_f32 v189, v190, v191
    buffer_store_dwordx2 v[176:177], v24, s[32:35], s62 offen offset:0 sc1
    buffer_store_dwordx2 v[180:181], v24, s[32:35], s62 offen offset:16 sc1
    buffer_store_dwordx2 v[184:185], v28, s[32:35], s62 offen offset:0 sc1
    buffer_store_dwordx2 v[188:189], v28, s[32:35], s62 offen offset:16 sc1
    v_bfe_u32 v27, v1, 4, 1
    v_lshlrev_b32 v27, 16, v27
    v_lshl_add_u32 v27, v26, 8, v27
    v_and_b32 v25, 15, v1
    v_lshl_add_u32 v27, v25, 4, v27
    s_add_u32 s63, s60, 0x6400000
    v_cvt_pk_bf16_f32 v16, v192, v193
    v_cvt_pk_bf16_f32 v17, v194, v195
    v_cvt_pk_bf16_f32 v18, v200, v201
    v_cvt_pk_bf16_f32 v19, v202, v203
    v_cvt_pk_bf16_f32 v20, v196, v197
    v_cvt_pk_bf16_f32 v21, v198, v199
    v_cvt_pk_bf16_f32 v22, v204, v205
    v_cvt_pk_bf16_f32 v23, v206, v207
    buffer_store_dwordx4 v[16:19], v27, s[32:35], s63 offen offset:0 sc1
    buffer_store_dwordx4 v[20:23], v27, s[32:35], s63 offen offset:512 sc1
    s_nop 1
    s_add_u32 s63, s60, 0x6420000
    v_cvt_pk_bf16_f32 v16, v208, v209
    v_cvt_pk_bf16_f32 v17, v210, v211
    v_cvt_pk_bf16_f32 v18, v216, v217
    v_cvt_pk_bf16_f32 v19, v218, v219
    v_cvt_pk_bf16_f32 v20, v212, v213
    v_cvt_pk_bf16_f32 v21, v214, v215
    v_cvt_pk_bf16_f32 v22, v220, v221
    v_cvt_pk_bf16_f32 v23, v222, v223
    buffer_store_dwordx4 v[16:19], v27, s[32:35], s63 offen offset:0 sc1
    buffer_store_dwordx4 v[20:23], v27, s[32:35], s63 offen offset:512 sc1
    s_nop 1
    s_add_u32 s63, s60, 0x6440000
    v_cvt_pk_bf16_f32 v16, v224, v225
    v_cvt_pk_bf16_f32 v17, v226, v227
    v_cvt_pk_bf16_f32 v18, v232, v233
    v_cvt_pk_bf16_f32 v19, v234, v235
    v_cvt_pk_bf16_f32 v20, v228, v229
    v_cvt_pk_bf16_f32 v21, v230, v231
    v_cvt_pk_bf16_f32 v22, v236, v237
    v_cvt_pk_bf16_f32 v23, v238, v239
    buffer_store_dwordx4 v[16:19], v27, s[32:35], s63 offen offset:0 sc1
    buffer_store_dwordx4 v[20:23], v27, s[32:35], s63 offen offset:512 sc1
    s_nop 1
    s_add_u32 s63, s60, 0x6460000
    v_cvt_pk_bf16_f32 v16, v240, v241
    v_cvt_pk_bf16_f32 v17, v242, v243
    v_cvt_pk_bf16_f32 v18, v248, v249
    v_cvt_pk_bf16_f32 v19, v250, v251
    v_cvt_pk_bf16_f32 v20, v244, v245
    v_cvt_pk_bf16_f32 v21, v246, v247
    v_cvt_pk_bf16_f32 v22, v252, v253
    v_cvt_pk_bf16_f32 v23, v254, v255
    buffer_store_dwordx4 v[16:19], v27, s[32:35], s63 offen offset:0 sc1
    buffer_store_dwordx4 v[20:23], v27, s[32:35], s63 offen offset:512 sc1
    s_nop 1
    s_lshl_b32 s60, s53, 7
    s_add_u32 s60, s60, 0x2000
    s_waitcnt vmcnt(0)
    s_barrier
    s_cmp_lg_u32 s45, 0
    s_cbranch_scc1 L_w0_40
    s_cmp_lg_u32 s98, 0
    s_cbranch_scc1 L_id_42
    v_mov_b32 v16, 128
L_iw_41:
    s_add_u32 s101, s101, 1
    s_cmp_gt_u32 s101, 0x200000
    s_cbranch_scc1 L_exit
    global_load_dword v17, v16, s[26:27] sc1
    s_waitcnt vmcnt(0)
    v_readfirstlane_b32 s61, v17
    s_nop 2
    s_cmp_lt_u32 s61, 32
    s_cbranch_scc1 L_iw_41
    s_mov_b32 s98, 1
L_id_42:
    s_mov_b64 exec, 1
    v_mov_b32 v16, 0
    v_mov_b32 v17, 1
    buffer_atomic_add v17, v16, s[32:35], s60 offen
    s_mov_b64 exec, -1
L_w0_40:
    s_branch L_next
L_t_aattn:
    s_sub_u32 s60, s52, 576
    s_lshr_b32 s55, s60, 2
    s_and_b32 s54, s60, 3
    s_lshr_b32 s53, s55, 1
    s_cmp_lg_u32 s45, 0
    s_cbranch_scc1 L_w0_43
    s_sub_u32 s60, s53, 0
    s_max_i32 s60, s60, 0
    s_lshl_b32 s60, s60, 7
    s_add_u32 s60, s60, 0x2000
    s_cmp_lg_u32 s98, 0
    s_cbranch_scc1 L_id_45
    v_mov_b32 v16, 128
L_iw_44:
    s_add_u32 s101, s101, 1
    s_cmp_gt_u32 s101, 0x200000
    s_cbranch_scc1 L_exit
    global_load_dword v17, v16, s[26:27] sc1
    s_waitcnt vmcnt(0)
    v_readfirstlane_b32 s61, v17
    s_nop 2
    s_cmp_lt_u32 s61, 32
    s_cbranch_scc1 L_iw_44
    s_mov_b32 s98, 1
L_id_45:
    v_mov_b32 v16, 0
L_wait_46:
    s_add_u32 s101, s101, 1
    s_cmp_gt_u32 s101, 0x200000
    s_cbranch_scc1 L_exit
    buffer_load_dword v17, v16, s[32:35], s60 offen sc1
    s_waitcnt vmcnt(0)
    v_readfirstlane_b32 s61, v17
    s_nop 2
    s_cmp_ge_u32 s61, 4
    s_cbranch_scc1 L_waitd_47
    s_sleep 8
    s_branch L_wait_46
L_waitd_47:
    s_sub_u32 s60, s53, 1
    s_max_i32 s60, s60, 0
    s_lshl_b32 s60, s60, 7
    s_add_u32 s60, s60, 0x2000
    s_cmp_lg_u32 s98, 0
    s_cbranch_scc1 L_id_49
    v_mov_b32 v16, 128
L_iw_48:
    s_add_u32 s101, s101, 1
    s_cmp_gt_u32 s101, 0x200000
    s_cbranch_scc1 L_exit
    global_load_dword v17, v16, s[26:27] sc1
    s_waitcnt vmcnt(0)
    v_readfirstlane_b32 s61, v17
    s_nop 2
    s_cmp_lt_u32 s61, 32
    s_cbranch_scc1 L_iw_48
    s_mov_b32 s98, 1
L_id_49:
    v_mov_b32 v16, 0
L_wait_50:
    s_add_u32 s101, s101, 1
    s_cmp_gt_u32 s101, 0x200000
    s_cbranch_scc1 L_exit
    buffer_load_dword v17, v16, s[32:35], s60 offen sc1
    s_waitcnt vmcnt(0)
    v_readfirstlane_b32 s61, v17
    s_nop 2
    s_cmp_ge_u32 s61, 4
    s_cbranch_scc1 L_waitd_51
    s_sleep 8
    s_branch L_wait_50
L_waitd_51:
    s_sub_u32 s60, s53, 2
    s_max_i32 s60, s60, 0
    s_lshl_b32 s60, s60, 7
    s_add_u32 s60, s60, 0x2000
    s_cmp_lg_u32 s98, 0
    s_cbranch_scc1 L_id_53
    v_mov_b32 v16, 128
L_iw_52:
    s_add_u32 s101, s101, 1
    s_cmp_gt_u32 s101, 0x200000
    s_cbranch_scc1 L_exit
    global_load_dword v17, v16, s[26:27] sc1
    s_waitcnt vmcnt(0)
    v_readfirstlane_b32 s61, v17
    s_nop 2
    s_cmp_lt_u32 s61, 32
    s_cbranch_scc1 L_iw_52
    s_mov_b32 s98, 1
L_id_53:
    v_mov_b32 v16, 0
L_wait_54:
    s_add_u32 s101, s101, 1
    s_cmp_gt_u32 s101, 0x200000
    s_cbranch_scc1 L_exit
    buffer_load_dword v17, v16, s[32:35], s60 offen sc1
    s_waitcnt vmcnt(0)
    v_readfirstlane_b32 s61, v17
    s_nop 2
    s_cmp_ge_u32 s61, 4
    s_cbranch_scc1 L_waitd_55
    s_sleep 8
    s_branch L_wait_54
L_waitd_55:
L_w0_43:
    s_barrier
    s_lshl_b32 s56, s55, 2
    s_add_u32 s56, s56, s45
    s_lshr_b32 s57, s56, 1
    v_and_b32 v6, 15, v1
    v_lshrrev_b32 v7, 4, v1
    v_lshlrev_b32 v2, 5, v6
    v_lshl_add_u32 v2, v7, 3, v2
    v_lshlrev_b32 v3, 4, v1
    s_and_b32 s60, s56, 1
    s_lshl_b32 s60, s60, 4
    s_add_u32 s60, s60, 256
    v_add_u32 v4, s60, v6
    v_lshlrev_b32 v8, 2, v7
    v_sub_u32 v4, v4, v8
    v_lshlrev_b32 v5, 10, v6
    v_lshl_add_u32 v5, v7, 3, v5
    s_mov_b32 s66, 0x3eb8aa3b
    s_mov_b32 s67, 0x3eb8aa3b
    s_lshl_b32 s58, s54, 3
    s_mov_b32 s59, 0
L_aa_56:
    s_lshl_b32 s60, s58, 16
    s_lshl_b32 s61, s56, 9
    s_add_u32 s61, s61, s60
    s_add_u32 s61, s61, 0x6000000
    buffer_load_dwordx2 v[10:11], v2, s[32:35], s61 offen sc1
    s_add_i32 s61, s57, -8
    s_max_i32 s61, s61, 0
    s_lshl_b32 s61, s61, 10
    s_add_u32 s61, s61, s60
    s_add_u32 s62, s61, 0x6200000
    s_add_u32 s63, s61, 0x6400000
    buffer_load_dwordx2 v[12:13], v2, s[32:35], s62 offen sc1
    buffer_load_dwordx2 v[14:15], v2, s[32:35], s62 offen offset:512 sc1
    buffer_load_dwordx4 v[48:51], v3, s[32:35], s63 offen sc1
    s_add_i32 s61, s57, -7
    s_max_i32 s61, s61, 0
    s_lshl_b32 s61, s61, 10
    s_add_u32 s61, s61, s60
    s_add_u32 s62, s61, 0x6200000
    s_add_u32 s63, s61, 0x6400000
    buffer_load_dwordx2 v[16:17], v2, s[32:35], s62 offen sc1
    buffer_load_dwordx2 v[18:19], v2, s[32:35], s62 offen offset:512 sc1
    buffer_load_dwordx4 v[52:55], v3, s[32:35], s63 offen sc1
    s_add_i32 s61, s57, -6
    s_max_i32 s61, s61, 0
    s_lshl_b32 s61, s61, 10
    s_add_u32 s61, s61, s60
    s_add_u32 s62, s61, 0x6200000
    s_add_u32 s63, s61, 0x6400000
    buffer_load_dwordx2 v[20:21], v2, s[32:35], s62 offen sc1
    buffer_load_dwordx2 v[22:23], v2, s[32:35], s62 offen offset:512 sc1
    buffer_load_dwordx4 v[56:59], v3, s[32:35], s63 offen sc1
    s_add_i32 s61, s57, -5
    s_max_i32 s61, s61, 0
    s_lshl_b32 s61, s61, 10
    s_add_u32 s61, s61, s60
    s_add_u32 s62, s61, 0x6200000
    s_add_u32 s63, s61, 0x6400000
    buffer_load_dwordx2 v[24:25], v2, s[32:35], s62 offen sc1
    buffer_load_dwordx2 v[26:27], v2, s[32:35], s62 offen offset:512 sc1
    buffer_load_dwordx4 v[60:63], v3, s[32:35], s63 offen sc1
    s_add_i32 s61, s57, -4
    s_max_i32 s61, s61, 0
    s_lshl_b32 s61, s61, 10
    s_add_u32 s61, s61, s60
    s_add_u32 s62, s61, 0x6200000
    s_add_u32 s63, s61, 0x6400000
    buffer_load_dwordx2 v[28:29], v2, s[32:35], s62 offen sc1
    buffer_load_dwordx2 v[30:31], v2, s[32:35], s62 offen offset:512 sc1
    buffer_load_dwordx4 v[64:67], v3, s[32:35], s63 offen sc1
    s_add_i32 s61, s57, -3
    s_max_i32 s61, s61, 0
    s_lshl_b32 s61, s61, 10
    s_add_u32 s61, s61, s60
    s_add_u32 s62, s61, 0x6200000
    s_add_u32 s63, s61, 0x6400000
    buffer_load_dwordx2 v[32:33], v2, s[32:35], s62 offen sc1
    buffer_load_dwordx2 v[34:35], v2, s[32:35], s62 offen offset:512 sc1
    buffer_load_dwordx4 v[68:71], v3, s[32:35], s63 offen sc1
    s_add_i32 s61, s57, -2
    s_max_i32 s61, s61, 0
    s_lshl_b32 s61, s61, 10
    s_add_u32 s61, s61, s60
    s_add_u32 s62, s61, 0x6200000
    s_add_u32 s63, s61, 0x6400000
    buffer_load_dwordx2 v[36:37], v2, s[32:35], s62 offen sc1
    buffer_load_dwordx2 v[38:39], v2, s[32:35], s62 offen offset:512 sc1
    buffer_load_dwordx4 v[72:75], v3, s[32:35], s63 offen sc1
    s_add_i32 s61, s57, -1
    s_max_i32 s61, s61, 0
    s_lshl_b32 s61, s61, 10
    s_add_u32 s61, s61, s60
    s_add_u32 s62, s61, 0x6200000
    s_add_u32 s63, s61, 0x6400000
    buffer_load_dwordx2 v[40:41], v2, s[32:35], s62 offen sc1
    buffer_load_dwordx2 v[42:43], v2, s[32:35], s62 offen offset:512 sc1
    buffer_load_dwordx4 v[76:79], v3, s[32:35], s63 offen sc1
    s_add_i32 s61, s57, 0
    s_max_i32 s61, s61, 0
    s_lshl_b32 s61, s61, 10
    s_add_u32 s61, s61, s60
    s_add_u32 s62, s61, 0x6200000
    s_add_u32 s63, s61, 0x6400000
    buffer_load_dwordx2 v[44:45], v2, s[32:35], s62 offen sc1
    buffer_load_dwordx2 v[46:47], v2, s[32:35], s62 offen offset:512 sc1
    buffer_load_dwordx4 v[80:83], v3, s[32:35], s63 offen sc1
    s_add_i32 s61, s57, -8
    s_cmp_lt_i32 s61, 0
    s_cselect_b32 s61, 0xf149f2ca, 0
    v_mov_b32 v156, s61
    v_mov_b32 v157, s61
    v_mov_b32 v158, s61
    v_mov_b32 v159, s61
    s_add_i32 s61, s57, -7
    s_cmp_lt_i32 s61, 0
    s_cselect_b32 s61, 0xf149f2ca, 0
    v_mov_b32 v160, s61
    v_mov_b32 v161, s61
    v_mov_b32 v162, s61
    v_mov_b32 v163, s61
    s_add_i32 s61, s57, -6
    s_cmp_lt_i32 s61, 0
    s_cselect_b32 s61, 0xf149f2ca, 0
    v_mov_b32 v164, s61
    v_mov_b32 v165, s61
    v_mov_b32 v166, s61
    v_mov_b32 v167, s61
    s_add_i32 s61, s57, -5
    s_cmp_lt_i32 s61, 0
    s_cselect_b32 s61, 0xf149f2ca, 0
    v_mov_b32 v168, s61
    v_mov_b32 v169, s61
    v_mov_b32 v170, s61
    v_mov_b32 v171, s61
    s_add_i32 s61, s57, -4
    s_cmp_lt_i32 s61, 0
    s_cselect_b32 s61, 0xf149f2ca, 0
    v_mov_b32 v172, s61
    v_mov_b32 v173, s61
    v_mov_b32 v174, s61
    v_mov_b32 v175, s61
    s_add_i32 s61, s57, -3
    s_cmp_lt_i32 s61, 0
    s_cselect_b32 s61, 0xf149f2ca, 0
    v_mov_b32 v176, s61
    v_mov_b32 v177, s61
    v_mov_b32 v178, s61
    v_mov_b32 v179, s61
    s_add_i32 s61, s57, -2
    s_cmp_lt_i32 s61, 0
    s_cselect_b32 s61, 0xf149f2ca, 0
    v_mov_b32 v180, s61
    v_mov_b32 v181, s61
    v_mov_b32 v182, s61
    v_mov_b32 v183, s61
    s_add_i32 s61, s57, -1
    s_cmp_lt_i32 s61, 0
    s_cselect_b32 s61, 0xf149f2ca, 0
    v_mov_b32 v184, s61
    v_mov_b32 v185, s61
    v_mov_b32 v186, s61
    v_mov_b32 v187, s61
    s_add_i32 s61, s57, 0
    s_cmp_lt_i32 s61, 0
    s_cselect_b32 s61, 0xf149f2ca, 0
    v_mov_b32 v188, s61
    v_mov_b32 v189, s61
    v_mov_b32 v190, s61
    v_mov_b32 v191, s61
    v_mov_b32 v232, 0xf149f2ca
    s_waitcnt vmcnt(0)
    v_mfma_f32_16x16x16_bf16 v[84:87], v[12:13], v[10:11], v[156:159]
    v_mfma_f32_16x16x16_bf16 v[88:91], v[14:15], v[10:11], v[156:159]
    v_mfma_f32_16x16x16_bf16 v[92:95], v[16:17], v[10:11], v[160:163]
    v_mfma_f32_16x16x16_bf16 v[96:99], v[18:19], v[10:11], v[160:163]
    v_mfma_f32_16x16x16_bf16 v[100:103], v[20:21], v[10:11], v[164:167]
    v_mfma_f32_16x16x16_bf16 v[104:107], v[22:23], v[10:11], v[164:167]
    v_mfma_f32_16x16x16_bf16 v[108:111], v[24:25], v[10:11], v[168:171]
    v_mfma_f32_16x16x16_bf16 v[112:115], v[26:27], v[10:11], v[168:171]
    v_mfma_f32_16x16x16_bf16 v[116:119], v[28:29], v[10:11], v[172:175]
    v_mfma_f32_16x16x16_bf16 v[120:123], v[30:31], v[10:11], v[172:175]
    v_mfma_f32_16x16x16_bf16 v[124:127], v[32:33], v[10:11], v[176:179]
    v_mfma_f32_16x16x16_bf16 v[128:131], v[34:35], v[10:11], v[176:179]
    v_mfma_f32_16x16x16_bf16 v[132:135], v[36:37], v[10:11], v[180:183]
    v_mfma_f32_16x16x16_bf16 v[136:139], v[38:39], v[10:11], v[180:183]
    v_mfma_f32_16x16x16_bf16 v[140:143], v[40:41], v[10:11], v[184:187]
    v_mfma_f32_16x16x16_bf16 v[144:147], v[42:43], v[10:11], v[184:187]
    v_mfma_f32_16x16x16_bf16 v[148:151], v[44:45], v[10:11], v[188:191]
    v_mfma_f32_16x16x16_bf16 v[152:155], v[46:47], v[10:11], v[188:191]
    s_nop 7
    v_cvt_pk_bf16_f32 v12, v84, v85
    v_lshlrev_b32 v84, 16, v12
    v_and_b32 v85, 0xffff0000, v12
    v_cvt_pk_bf16_f32 v13, v86, v87
    v_lshlrev_b32 v86, 16, v13
    v_and_b32 v87, 0xffff0000, v13
    v_cvt_pk_bf16_f32 v14, v88, v89
    v_lshlrev_b32 v88, 16, v14
    v_and_b32 v89, 0xffff0000, v14
    v_cvt_pk_bf16_f32 v15, v90, v91
    v_lshlrev_b32 v90, 16, v15
    v_and_b32 v91, 0xffff0000, v15
    v_cvt_pk_bf16_f32 v16, v92, v93
    v_lshlrev_b32 v92, 16, v16
    v_and_b32 v93, 0xffff0000, v16
    v_cvt_pk_bf16_f32 v17, v94, v95
    v_lshlrev_b32 v94, 16, v17
    v_and_b32 v95, 0xffff0000, v17
    v_cvt_pk_bf16_f32 v18, v96, v97
    v_lshlrev_b32 v96, 16, v18
    v_and_b32 v97, 0xffff0000, v18
    v_cvt_pk_bf16_f32 v19, v98, v99
    v_lshlrev_b32 v98, 16, v19
    v_and_b32 v99, 0xffff0000, v19
    v_cvt_pk_bf16_f32 v12, v100, v101
    v_lshlrev_b32 v100, 16, v12
    v_and_b32 v101, 0xffff0000, v12
    v_cvt_pk_bf16_f32 v13, v102, v103
    v_lshlrev_b32 v102, 16, v13
    v_and_b32 v103, 0xffff0000, v13
    v_cvt_pk_bf16_f32 v14, v104, v105
    v_lshlrev_b32 v104, 16, v14
    v_and_b32 v105, 0xffff0000, v14
    v_cvt_pk_bf16_f32 v15, v106, v107
    v_lshlrev_b32 v106, 16, v15
    v_and_b32 v107, 0xffff0000, v15
    v_cvt_pk_bf16_f32 v16, v108, v109
    v_lshlrev_b32 v108, 16, v16
    v_and_b32 v109, 0xffff0000, v16
    v_cvt_pk_bf16_f32 v17, v110, v111
    v_lshlrev_b32 v110, 16, v17
    v_and_b32 v111, 0xffff0000, v17
    v_cvt_pk_bf16_f32 v18, v112, v113
    v_lshlrev_b32 v112, 16, v18
    v_and_b32 v113, 0xffff0000, v18
    v_cvt_pk_bf16_f32 v19, v114, v115
    v_lshlrev_b32 v114, 16, v19
    v_and_b32 v115, 0xffff0000, v19
    v_cvt_pk_bf16_f32 v12, v116, v117
    v_lshlrev_b32 v116, 16, v12
    v_and_b32 v117, 0xffff0000, v12
    v_cvt_pk_bf16_f32 v13, v118, v119
    v_lshlrev_b32 v118, 16, v13
    v_and_b32 v119, 0xffff0000, v13
    v_cvt_pk_bf16_f32 v14, v120, v121
    v_lshlrev_b32 v120, 16, v14
    v_and_b32 v121, 0xffff0000, v14
    v_cvt_pk_bf16_f32 v15, v122, v123
    v_lshlrev_b32 v122, 16, v15
    v_and_b32 v123, 0xffff0000, v15
    v_cvt_pk_bf16_f32 v16, v124, v125
    v_lshlrev_b32 v124, 16, v16
    v_and_b32 v125, 0xffff0000, v16
    v_cvt_pk_bf16_f32 v17, v126, v127
    v_lshlrev_b32 v126, 16, v17
    v_and_b32 v127, 0xffff0000, v17
    v_cvt_pk_bf16_f32 v18, v128, v129
    v_lshlrev_b32 v128, 16, v18
    v_and_b32 v129, 0xffff0000, v18
    v_cvt_pk_bf16_f32 v19, v130, v131
    v_lshlrev_b32 v130, 16, v19
    v_and_b32 v131, 0xffff0000, v19
    v_cvt_pk_bf16_f32 v12, v132, v133
    v_lshlrev_b32 v132, 16, v12
    v_and_b32 v133, 0xffff0000, v12
    v_cvt_pk_bf16_f32 v13, v134, v135
    v_lshlrev_b32 v134, 16, v13
    v_and_b32 v135, 0xffff0000, v13
    v_cvt_pk_bf16_f32 v14, v136, v137
    v_lshlrev_b32 v136, 16, v14
    v_and_b32 v137, 0xffff0000, v14
    v_cvt_pk_bf16_f32 v15, v138, v139
    v_lshlrev_b32 v138, 16, v15
    v_and_b32 v139, 0xffff0000, v15
    v_cvt_pk_bf16_f32 v16, v140, v141
    v_lshlrev_b32 v140, 16, v16
    v_and_b32 v141, 0xffff0000, v16
    v_cvt_pk_bf16_f32 v17, v142, v143
    v_lshlrev_b32 v142, 16, v17
    v_and_b32 v143, 0xffff0000, v17
    v_cvt_pk_bf16_f32 v18, v144, v145
    v_lshlrev_b32 v144, 16, v18
    v_and_b32 v145, 0xffff0000, v18
    v_cvt_pk_bf16_f32 v19, v146, v147
    v_lshlrev_b32 v146, 16, v19
    v_and_b32 v147, 0xffff0000, v19
    v_cvt_pk_bf16_f32 v12, v148, v149
    v_lshlrev_b32 v148, 16, v12
    v_and_b32 v149, 0xffff0000, v12
    v_cvt_pk_bf16_f32 v13, v150, v151
    v_lshlrev_b32 v150, 16, v13
    v_and_b32 v151, 0xffff0000, v13
    v_cvt_pk_bf16_f32 v14, v152, v153
    v_lshlrev_b32 v152, 16, v14
    v_and_b32 v153, 0xffff0000, v14
    v_cvt_pk_bf16_f32 v15, v154, v155
    v_lshlrev_b32 v154, 16, v15
    v_and_b32 v155, 0xffff0000, v15
    v_subrev_u32 v228, 0, v4
    v_cmp_gt_u32 vcc, 0x100, v228
    s_nop 1
    v_cndmask_b32 v84, v232, v84, vcc
    v_subrev_u32 v228, 1, v4
    v_cmp_gt_u32 vcc, 0x100, v228
    s_nop 1
    v_cndmask_b32 v85, v232, v85, vcc
    v_subrev_u32 v228, 2, v4
    v_cmp_gt_u32 vcc, 0x100, v228
    s_nop 1
    v_cndmask_b32 v86, v232, v86, vcc
    v_subrev_u32 v228, 3, v4
    v_cmp_gt_u32 vcc, 0x100, v228
    s_nop 1
    v_cndmask_b32 v87, v232, v87, vcc
    v_subrev_u32 v228, 16, v4
    v_cmp_gt_u32 vcc, 0x100, v228
    s_nop 1
    v_cndmask_b32 v88, v232, v88, vcc
    v_subrev_u32 v228, 17, v4
    v_cmp_gt_u32 vcc, 0x100, v228
    s_nop 1
    v_cndmask_b32 v89, v232, v89, vcc
    v_subrev_u32 v228, 18, v4
    v_cmp_gt_u32 vcc, 0x100, v228
    s_nop 1
    v_cndmask_b32 v90, v232, v90, vcc
    v_subrev_u32 v228, 19, v4
    v_cmp_gt_u32 vcc, 0x100, v228
    s_nop 1
    v_cndmask_b32 v91, v232, v91, vcc
    v_subrev_u32 v228, 256, v4
    v_cmp_gt_u32 vcc, 0x100, v228
    s_nop 1
    v_cndmask_b32 v148, v232, v148, vcc
    v_subrev_u32 v228, 257, v4
    v_cmp_gt_u32 vcc, 0x100, v228
    s_nop 1
    v_cndmask_b32 v149, v232, v149, vcc
    v_subrev_u32 v228, 258, v4
    v_cmp_gt_u32 vcc, 0x100, v228
    s_nop 1
    v_cndmask_b32 v150, v232, v150, vcc
    v_subrev_u32 v228, 259, v4
    v_cmp_gt_u32 vcc, 0x100, v228
    s_nop 1
    v_cndmask_b32 v151, v232, v151, vcc
    v_subrev_u32 v228, 272, v4
    v_cmp_gt_u32 vcc, 0x100, v228
    s_nop 1
    v_cndmask_b32 v152, v232, v152, vcc
    v_subrev_u32 v228, 273, v4
    v_cmp_gt_u32 vcc, 0x100, v228
    s_nop 1
    v_cndmask_b32 v153, v232, v153, vcc
    v_subrev_u32 v228, 274, v4
    v_cmp_gt_u32 vcc, 0x100, v228
    s_nop 1
    v_cndmask_b32 v154, v232, v154, vcc
    v_subrev_u32 v228, 275, v4
    v_cmp_gt_u32 vcc, 0x100, v228
    s_nop 1
    v_cndmask_b32 v155, v232, v155, vcc
    v_max_f32 v228, v84, v85
    v_max3_f32 v228, v228, v86, v87
    v_max3_f32 v228, v228, v88, v89
    v_max3_f32 v228, v228, v90, v91
    v_max3_f32 v228, v228, v92, v93
    v_max3_f32 v228, v228, v94, v95
    v_max3_f32 v228, v228, v96, v97
    v_max3_f32 v228, v228, v98, v99
    v_max3_f32 v228, v228, v100, v101
    v_max3_f32 v228, v228, v102, v103
    v_max3_f32 v228, v228, v104, v105
    v_max3_f32 v228, v228, v106, v107
    v_max3_f32 v228, v228, v108, v109
    v_max3_f32 v228, v228, v110, v111
    v_max3_f32 v228, v228, v112, v113
    v_max3_f32 v228, v228, v114, v115
    v_max3_f32 v228, v228, v116, v117
    v_max3_f32 v228, v228, v118, v119
    v_max3_f32 v228, v228, v120, v121
    v_max3_f32 v228, v228, v122, v123
    v_max3_f32 v228, v228, v124, v125
    v_max3_f32 v228, v228, v126, v127
    v_max3_f32 v228, v228, v128, v129
    v_max3_f32 v228, v228, v130, v131
    v_max3_f32 v228, v228, v132, v133
    v_max3_f32 v228, v228, v134, v135
    v_max3_f32 v228, v228, v136, v137
    v_max3_f32 v228, v228, v138, v139
    v_max3_f32 v228, v228, v140, v141
    v_max3_f32 v228, v228, v142, v143
    v_max3_f32 v228, v228, v144, v145
    v_max3_f32 v228, v228, v146, v147
    v_max3_f32 v228, v228, v148, v149
    v_max3_f32 v228, v228, v150, v151
    v_max3_f32 v228, v228, v152, v153
    v_max3_f32 v228, v228, v154, v155
    v_mov_b32 v229, v228
    s_nop 1
    v_permlane16_swap_b32 v229, v228
    s_nop 0
    v_max_f32 v228, v228, v229
    v_mov_b32 v229, v228
    s_nop 1
    v_permlane32_swap_b32 v229, v228
    s_nop 0
    v_max_f32 v228, v228, v229
    v_mov_b32 v229, v228
    v_pk_add_f32 v[84:85], v[84:85], v[228:229] neg_lo:[0,1] neg_hi:[0,1]
    v_pk_mul_f32 v[84:85], v[84:85], s[66:67]
    v_pk_add_f32 v[86:87], v[86:87], v[228:229] neg_lo:[0,1] neg_hi:[0,1]
    v_pk_mul_f32 v[86:87], v[86:87], s[66:67]
    v_pk_add_f32 v[88:89], v[88:89], v[228:229] neg_lo:[0,1] neg_hi:[0,1]
    v_pk_mul_f32 v[88:89], v[88:89], s[66:67]
    v_pk_add_f32 v[90:91], v[90:91], v[228:229] neg_lo:[0,1] neg_hi:[0,1]
    v_pk_mul_f32 v[90:91], v[90:91], s[66:67]
    v_pk_add_f32 v[92:93], v[92:93], v[228:229] neg_lo:[0,1] neg_hi:[0,1]
    v_pk_mul_f32 v[92:93], v[92:93], s[66:67]
    v_pk_add_f32 v[94:95], v[94:95], v[228:229] neg_lo:[0,1] neg_hi:[0,1]
    v_pk_mul_f32 v[94:95], v[94:95], s[66:67]
    v_pk_add_f32 v[96:97], v[96:97], v[228:229] neg_lo:[0,1] neg_hi:[0,1]
    v_pk_mul_f32 v[96:97], v[96:97], s[66:67]
    v_pk_add_f32 v[98:99], v[98:99], v[228:229] neg_lo:[0,1] neg_hi:[0,1]
    v_pk_mul_f32 v[98:99], v[98:99], s[66:67]
    v_pk_add_f32 v[100:101], v[100:101], v[228:229] neg_lo:[0,1] neg_hi:[0,1]
    v_pk_mul_f32 v[100:101], v[100:101], s[66:67]
    v_pk_add_f32 v[102:103], v[102:103], v[228:229] neg_lo:[0,1] neg_hi:[0,1]
    v_pk_mul_f32 v[102:103], v[102:103], s[66:67]
    v_pk_add_f32 v[104:105], v[104:105], v[228:229] neg_lo:[0,1] neg_hi:[0,1]
    v_pk_mul_f32 v[104:105], v[104:105], s[66:67]
    v_pk_add_f32 v[106:107], v[106:107], v[228:229] neg_lo:[0,1] neg_hi:[0,1]
    v_pk_mul_f32 v[106:107], v[106:107], s[66:67]
    v_pk_add_f32 v[108:109], v[108:109], v[228:229] neg_lo:[0,1] neg_hi:[0,1]
    v_pk_mul_f32 v[108:109], v[108:109], s[66:67]
    v_pk_add_f32 v[110:111], v[110:111], v[228:229] neg_lo:[0,1] neg_hi:[0,1]
    v_pk_mul_f32 v[110:111], v[110:111], s[66:67]
    v_pk_add_f32 v[112:113], v[112:113], v[228:229] neg_lo:[0,1] neg_hi:[0,1]
    v_pk_mul_f32 v[112:113], v[112:113], s[66:67]
    v_pk_add_f32 v[114:115], v[114:115], v[228:229] neg_lo:[0,1] neg_hi:[0,1]
    v_pk_mul_f32 v[114:115], v[114:115], s[66:67]
    v_pk_add_f32 v[116:117], v[116:117], v[228:229] neg_lo:[0,1] neg_hi:[0,1]
    v_pk_mul_f32 v[116:117], v[116:117], s[66:67]
    v_pk_add_f32 v[118:119], v[118:119], v[228:229] neg_lo:[0,1] neg_hi:[0,1]
    v_pk_mul_f32 v[118:119], v[118:119], s[66:67]
    v_pk_add_f32 v[120:121], v[120:121], v[228:229] neg_lo:[0,1] neg_hi:[0,1]
    v_pk_mul_f32 v[120:121], v[120:121], s[66:67]
    v_pk_add_f32 v[122:123], v[122:123], v[228:229] neg_lo:[0,1] neg_hi:[0,1]
    v_pk_mul_f32 v[122:123], v[122:123], s[66:67]
    v_pk_add_f32 v[124:125], v[124:125], v[228:229] neg_lo:[0,1] neg_hi:[0,1]
    v_pk_mul_f32 v[124:125], v[124:125], s[66:67]
    v_pk_add_f32 v[126:127], v[126:127], v[228:229] neg_lo:[0,1] neg_hi:[0,1]
    v_pk_mul_f32 v[126:127], v[126:127], s[66:67]
    v_pk_add_f32 v[128:129], v[128:129], v[228:229] neg_lo:[0,1] neg_hi:[0,1]
    v_pk_mul_f32 v[128:129], v[128:129], s[66:67]
    v_pk_add_f32 v[130:131], v[130:131], v[228:229] neg_lo:[0,1] neg_hi:[0,1]
    v_pk_mul_f32 v[130:131], v[130:131], s[66:67]
    v_pk_add_f32 v[132:133], v[132:133], v[228:229] neg_lo:[0,1] neg_hi:[0,1]
    v_pk_mul_f32 v[132:133], v[132:133], s[66:67]
    v_pk_add_f32 v[134:135], v[134:135], v[228:229] neg_lo:[0,1] neg_hi:[0,1]
    v_pk_mul_f32 v[134:135], v[134:135], s[66:67]
    v_pk_add_f32 v[136:137], v[136:137], v[228:229] neg_lo:[0,1] neg_hi:[0,1]
    v_pk_mul_f32 v[136:137], v[136:137], s[66:67]
    v_pk_add_f32 v[138:139], v[138:139], v[228:229] neg_lo:[0,1] neg_hi:[0,1]
    v_pk_mul_f32 v[138:139], v[138:139], s[66:67]
    v_pk_add_f32 v[140:141], v[140:141], v[228:229] neg_lo:[0,1] neg_hi:[0,1]
    v_pk_mul_f32 v[140:141], v[140:141], s[66:67]
    v_pk_add_f32 v[142:143], v[142:143], v[228:229] neg_lo:[0,1] neg_hi:[0,1]
    v_pk_mul_f32 v[142:143], v[142:143], s[66:67]
    v_pk_add_f32 v[144:145], v[144:145], v[228:229] neg_lo:[0,1] neg_hi:[0,1]
    v_pk_mul_f32 v[144:145], v[144:145], s[66:67]
    v_pk_add_f32 v[146:147], v[146:147], v[228:229] neg_lo:[0,1] neg_hi:[0,1]
    v_pk_mul_f32 v[146:147], v[146:147], s[66:67]
    v_pk_add_f32 v[148:149], v[148:149], v[228:229] neg_lo:[0,1] neg_hi:[0,1]
    v_pk_mul_f32 v[148:149], v[148:149], s[66:67]
    v_pk_add_f32 v[150:151], v[150:151], v[228:229] neg_lo:[0,1] neg_hi:[0,1]
    v_pk_mul_f32 v[150:151], v[150:151], s[66:67]
    v_pk_add_f32 v[152:153], v[152:153], v[228:229] neg_lo:[0,1] neg_hi:[0,1]
    v_pk_mul_f32 v[152:153], v[152:153], s[66:67]
    v_pk_add_f32 v[154:155], v[154:155], v[228:229] neg_lo:[0,1] neg_hi:[0,1]
    v_pk_mul_f32 v[154:155], v[154:155], s[66:67]
    v_exp_f32 v84, v84
    v_exp_f32 v85, v85
    v_exp_f32 v86, v86
    v_exp_f32 v87, v87
    v_exp_f32 v88, v88
    v_exp_f32 v89, v89
    v_exp_f32 v90, v90
    v_exp_f32 v91, v91
    v_exp_f32 v92, v92
    v_exp_f32 v93, v93
    v_exp_f32 v94, v94
    v_exp_f32 v95, v95
    v_exp_f32 v96, v96
    v_exp_f32 v97, v97
    v_exp_f32 v98, v98
    v_exp_f32 v99, v99
    v_exp_f32 v100, v100
    v_exp_f32 v101, v101
    v_exp_f32 v102, v102
    v_exp_f32 v103, v103
    v_exp_f32 v104, v104
    v_exp_f32 v105, v105
    v_exp_f32 v106, v106
    v_exp_f32 v107, v107
    v_exp_f32 v108, v108
    v_exp_f32 v109, v109
    v_exp_f32 v110, v110
    v_exp_f32 v111, v111
    v_exp_f32 v112, v112
    v_exp_f32 v113, v113
    v_exp_f32 v114, v114
    v_exp_f32 v115, v115
    v_exp_f32 v116, v116
    v_exp_f32 v117, v117
    v_exp_f32 v118, v118
    v_exp_f32 v119, v119
    v_exp_f32 v120, v120
    v_exp_f32 v121, v121
    v_exp_f32 v122, v122
    v_exp_f32 v123, v123
    v_exp_f32 v124, v124
    v_exp_f32 v125, v125
    v_exp_f32 v126, v126
    v_exp_f32 v127, v127
    v_exp_f32 v128, v128
    v_exp_f32 v129, v129
    v_exp_f32 v130, v130
    v_exp_f32 v131, v131
    v_exp_f32 v132, v132
    v_exp_f32 v133, v133
    v_exp_f32 v134, v134
    v_exp_f32 v135, v135
    v_exp_f32 v136, v136
    v_exp_f32 v137, v137
    v_exp_f32 v138, v138
    v_exp_f32 v139, v139
    v_exp_f32 v140, v140
    v_exp_f32 v141, v141
    v_exp_f32 v142, v142
    v_exp_f32 v143, v143
    v_exp_f32 v144, v144
    v_exp_f32 v145, v145
    v_exp_f32 v146, v146
    v_exp_f32 v147, v147
    v_exp_f32 v148, v148
    v_exp_f32 v149, v149
    v_exp_f32 v150, v150
    v_exp_f32 v151, v151
    v_exp_f32 v152, v152
    v_exp_f32 v153, v153
    v_exp_f32 v154, v154
    v_exp_f32 v155, v155
    s_nop 0
    v_pk_add_f32 v[12:13], v[84:85], v[86:87]
    v_pk_add_f32 v[12:13], v[12:13], v[88:89]
    v_pk_add_f32 v[12:13], v[12:13], v[90:91]
    v_pk_add_f32 v[12:13], v[12:13], v[92:93]
    v_pk_add_f32 v[12:13], v[12:13], v[94:95]
    v_pk_add_f32 v[12:13], v[12:13], v[96:97]
    v_pk_add_f32 v[12:13], v[12:13], v[98:99]
    v_pk_add_f32 v[12:13], v[12:13], v[100:101]
    v_pk_add_f32 v[12:13], v[12:13], v[102:103]
    v_pk_add_f32 v[12:13], v[12:13], v[104:105]
    v_pk_add_f32 v[12:13], v[12:13], v[106:107]
    v_pk_add_f32 v[12:13], v[12:13], v[108:109]
    v_pk_add_f32 v[12:13], v[12:13], v[110:111]
    v_pk_add_f32 v[12:13], v[12:13], v[112:113]
    v_pk_add_f32 v[12:13], v[12:13], v[114:115]
    v_pk_add_f32 v[12:13], v[12:13], v[116:117]
    v_pk_add_f32 v[12:13], v[12:13], v[118:119]
    v_pk_add_f32 v[12:13], v[12:13], v[120:121]
    v_pk_add_f32 v[12:13], v[12:13], v[122:123]
    v_pk_add_f32 v[12:13], v[12:13], v[124:125]
    v_pk_add_f32 v[12:13], v[12:13], v[126:127]
    v_pk_add_f32 v[12:13], v[12:13], v[128:129]
    v_pk_add_f32 v[12:13], v[12:13], v[130:131]
    v_pk_add_f32 v[12:13], v[12:13], v[132:133]
    v_pk_add_f32 v[12:13], v[12:13], v[134:135]
    v_pk_add_f32 v[12:13], v[12:13], v[136:137]
    v_pk_add_f32 v[12:13], v[12:13], v[138:139]
    v_pk_add_f32 v[12:13], v[12:13], v[140:141]
    v_pk_add_f32 v[12:13], v[12:13], v[142:143]
    v_pk_add_f32 v[12:13], v[12:13], v[144:145]
    v_pk_add_f32 v[12:13], v[12:13], v[146:147]
    v_pk_add_f32 v[12:13], v[12:13], v[148:149]
    v_pk_add_f32 v[12:13], v[12:13], v[150:151]
    v_pk_add_f32 v[12:13], v[12:13], v[152:153]
    v_pk_add_f32 v[12:13], v[12:13], v[154:155]
    v_add_f32 v228, v12, v13
    v_mov_b32 v229, v228
    s_nop 1
    v_permlane16_swap_b32 v229, v228
    s_nop 0
    v_add_f32 v228, v228, v229
    v_mov_b32 v229, v228
    s_nop 1
    v_permlane32_swap_b32 v229, v228
    s_nop 0
    v_add_f32 v228, v228, v229
    v_rcp_f32 v228, v228
    s_nop 0
    v_mov_b32 v229, v228
    v_pk_mul_f32 v[84:85], v[84:85], v[228:229]
    v_pk_mul_f32 v[86:87], v[86:87], v[228:229]
    v_pk_mul_f32 v[88:89], v[88:89], v[228:229]
    v_pk_mul_f32 v[90:91], v[90:91], v[228:229]
    v_pk_mul_f32 v[92:93], v[92:93], v[228:229]
    v_pk_mul_f32 v[94:95], v[94:95], v[228:229]
    v_pk_mul_f32 v[96:97], v[96:97], v[228:229]
    v_pk_mul_f32 v[98:99], v[98:99], v[228:229]
    v_pk_mul_f32 v[100:101], v[100:101], v[228:229]
    v_pk_mul_f32 v[102:103], v[102:103], v[228:229]
    v_pk_mul_f32 v[104:105], v[104:105], v[228:229]
    v_pk_mul_f32 v[106:107], v[106:107], v[228:229]
    v_pk_mul_f32 v[108:109], v[108:109], v[228:229]
    v_pk_mul_f32 v[110:111], v[110:111], v[228:229]
    v_pk_mul_f32 v[112:113], v[112:113], v[228:229]
    v_pk_mul_f32 v[114:115], v[114:115], v[228:229]
    v_pk_mul_f32 v[116:117], v[116:117], v[228:229]
    v_pk_mul_f32 v[118:119], v[118:119], v[228:229]
    v_pk_mul_f32 v[120:121], v[120:121], v[228:229]
    v_pk_mul_f32 v[122:123], v[122:123], v[228:229]
    v_pk_mul_f32 v[124:125], v[124:125], v[228:229]
    v_pk_mul_f32 v[126:127], v[126:127], v[228:229]
    v_pk_mul_f32 v[128:129], v[128:129], v[228:229]
    v_pk_mul_f32 v[130:131], v[130:131], v[228:229]
    v_pk_mul_f32 v[132:133], v[132:133], v[228:229]
    v_pk_mul_f32 v[134:135], v[134:135], v[228:229]
    v_pk_mul_f32 v[136:137], v[136:137], v[228:229]
    v_pk_mul_f32 v[138:139], v[138:139], v[228:229]
    v_pk_mul_f32 v[140:141], v[140:141], v[228:229]
    v_pk_mul_f32 v[142:143], v[142:143], v[228:229]
    v_pk_mul_f32 v[144:145], v[144:145], v[228:229]
    v_pk_mul_f32 v[146:147], v[146:147], v[228:229]
    v_pk_mul_f32 v[148:149], v[148:149], v[228:229]
    v_pk_mul_f32 v[150:151], v[150:151], v[228:229]
    v_pk_mul_f32 v[152:153], v[152:153], v[228:229]
    v_pk_mul_f32 v[154:155], v[154:155], v[228:229]
    v_cvt_pk_bf16_f32 v192, v84, v85
    v_cvt_pk_bf16_f32 v193, v86, v87
    v_cvt_pk_bf16_f32 v194, v88, v89
    v_cvt_pk_bf16_f32 v195, v90, v91
    v_cvt_pk_bf16_f32 v196, v92, v93
    v_cvt_pk_bf16_f32 v197, v94, v95
    v_cvt_pk_bf16_f32 v198, v96, v97
    v_cvt_pk_bf16_f32 v199, v98, v99
    v_cvt_pk_bf16_f32 v200, v100, v101
    v_cvt_pk_bf16_f32 v201, v102, v103
    v_cvt_pk_bf16_f32 v202, v104, v105
    v_cvt_pk_bf16_f32 v203, v106, v107
    v_cvt_pk_bf16_f32 v204, v108, v109
    v_cvt_pk_bf16_f32 v205, v110, v111
    v_cvt_pk_bf16_f32 v206, v112, v113
    v_cvt_pk_bf16_f32 v207, v114, v115
    v_cvt_pk_bf16_f32 v208, v116, v117
    v_cvt_pk_bf16_f32 v209, v118, v119
    v_cvt_pk_bf16_f32 v210, v120, v121
    v_cvt_pk_bf16_f32 v211, v122, v123
    v_cvt_pk_bf16_f32 v212, v124, v125
    v_cvt_pk_bf16_f32 v213, v126, v127
    v_cvt_pk_bf16_f32 v214, v128, v129
    v_cvt_pk_bf16_f32 v215, v130, v131
    v_cvt_pk_bf16_f32 v216, v132, v133
    v_cvt_pk_bf16_f32 v217, v134, v135
    v_cvt_pk_bf16_f32 v218, v136, v137
    v_cvt_pk_bf16_f32 v219, v138, v139
    v_cvt_pk_bf16_f32 v220, v140, v141
    v_cvt_pk_bf16_f32 v221, v142, v143
    v_cvt_pk_bf16_f32 v222, v144, v145
    v_cvt_pk_bf16_f32 v223, v146, v147
    v_cvt_pk_bf16_f32 v224, v148, v149
    v_cvt_pk_bf16_f32 v225, v150, v151
    v_cvt_pk_bf16_f32 v226, v152, v153
    v_cvt_pk_bf16_f32 v227, v154, v155
    s_nop 1
    v_mfma_f32_16x16x32_bf16 v[228:231], v[48:51], v[192:195], 0
    v_mfma_f32_16x16x32_bf16 v[228:231], v[52:55], v[196:199], v[228:231]
    v_mfma_f32_16x16x32_bf16 v[228:231], v[56:59], v[200:203], v[228:231]
    v_mfma_f32_16x16x32_bf16 v[228:231], v[60:63], v[204:207], v[228:231]
    v_mfma_f32_16x16x32_bf16 v[228:231], v[64:67], v[208:211], v[228:231]
    v_mfma_f32_16x16x32_bf16 v[228:231], v[68:71], v[212:215], v[228:231]
    v_mfma_f32_16x16x32_bf16 v[228:231], v[72:75], v[216:219], v[228:231]
    v_mfma_f32_16x16x32_bf16 v[228:231], v[76:79], v[220:223], v[228:231]
    v_mfma_f32_16x16x32_bf16 v[228:231], v[80:83], v[224:227], v[228:231]
    s_nop 7
    v_cvt_pk_bf16_f32 v228, v228, v229
    v_cvt_pk_bf16_f32 v229, v230, v231
    s_lshl_b32 s61, s56, 14
    s_lshl_b32 s62, s58, 5
    s_add_u32 s61, s61, s62
    s_add_u32 s61, s61, 0x6600000
    buffer_store_dwordx2 v[228:229], v5, s[32:35], s61 offen sc1
    s_add_u32 s58, s58, 1
    s_add_u32 s59, s59, 1
    s_cmp_lt_u32 s59, 8
    s_nop 1
    s_cbranch_scc1 L_aa_56
    s_lshl_b32 s60, s53, 7
    s_add_u32 s60, s60, 0x2800
    s_waitcnt vmcnt(0)
    s_barrier
    s_cmp_lg_u32 s45, 0
    s_cbranch_scc1 L_w0_57
    s_cmp_lg_u32 s98, 0
    s_cbranch_scc1 L_id_59
    v_mov_b32 v16, 128
L_iw_58:
    s_add_u32 s101, s101, 1
    s_cmp_gt_u32 s101, 0x200000
    s_cbranch_scc1 L_exit
    global_load_dword v17, v16, s[26:27] sc1
    s_waitcnt vmcnt(0)
    v_readfirstlane_b32 s61, v17
    s_nop 2
    s_cmp_lt_u32 s61, 32
    s_cbranch_scc1 L_iw_58
    s_mov_b32 s98, 1
L_id_59:
    s_mov_b64 exec, 1
    v_mov_b32 v16, 0
    v_mov_b32 v17, 1
    buffer_atomic_add v17, v16, s[32:35], s60 offen
    s_mov_b64 exec, -1
L_w0_57:
    s_branch L_next_regs
L_t_aout:
    s_cmp_lg_u32 s45, 0
    s_cbranch_scc1 L_w0_60
    s_lshl_b32 s60, s53, 7
    s_add_u32 s60, s60, 0x2800
    s_cmp_lg_u32 s98, 0
    s_cbranch_scc1 L_id_62
    v_mov_b32 v16, 128
L_iw_61:
    s_add_u32 s101, s101, 1
    s_cmp_gt_u32 s101, 0x200000
    s_cbranch_scc1 L_exit
    global_load_dword v17, v16, s[26:27] sc1
    s_waitcnt vmcnt(0)
    v_readfirstlane_b32 s61, v17
    s_nop 2
    s_cmp_lt_u32 s61, 32
    s_cbranch_scc1 L_iw_61
    s_mov_b32 s98, 1
L_id_62:
    v_mov_b32 v16, 0
L_wait_63:
    s_add_u32 s101, s101, 1
    s_cmp_gt_u32 s101, 0x200000
    s_cbranch_scc1 L_exit
    buffer_load_dword v17, v16, s[32:35], s60 offen sc1
    s_waitcnt vmcnt(0)
    v_readfirstlane_b32 s61, v17
    s_nop 2
    s_cmp_ge_u32 s61, 8
    s_cbranch_scc1 L_waitd_64
    s_sleep 16
    s_branch L_wait_63
L_waitd_64:
L_w0_60:
    s_barrier
    s_mov_b32 s80, s8
    s_and_b32 s81, s9, 0xffff
    s_mov_b32 s82, 0x80000
    s_mov_b32 s83, 0x00020000
    s_mov_b32 s92, s24
    s_and_b32 s93, s25, 0xffff
    s_mov_b32 s94, 0x400000
    s_mov_b32 s95, 0x00020000
    v_lshrrev_b32 v16, 3, v1
    s_mov_b32 s60, 1024
    v_mul_lo_u32 v16, v16, s60
    v_and_b32 v17, 7, v1
    v_lshrrev_b32 v18, 4, v1
    v_xor_b32 v17, v17, v18
    v_lshl_add_u32 v16, v17, 4, v16
    v_xor_b32 v2, 0, v16
    v_xor_b32 v3, 64, v16
    v_add_u32 v3, 8192, v3
    v_xor_b32 v4, 0, v16
    v_add_u32 v4, 16384, v4
    v_xor_b32 v5, 64, v16
    v_add_u32 v5, 24576, v5
    s_mov_b32 s60, 1024
    v_mul_lo_u32 v16, v18, s60
    v_and_b32 v17, 15, v1
    v_lshlrev_b32 v19, 2, v18
    v_xor_b32 v17, v17, v19
    v_lshl_add_u32 v6, v17, 4, v16
    s_lshl_b32 s60, s53, 2
    s_add_u32 s60, s60, s45
    s_mul_i32 s55, s60, 32768
    s_add_u32 s55, s55, 0x6600000
    s_lshl_b32 s56, s54, 8
    v_mov_b64 v[64:65], 0
    v_mov_b64 v[66:67], 0
    v_mov_b64 v[68:69], 0
    v_mov_b64 v[70:71], 0
    v_mov_b64 v[72:73], 0
    v_mov_b64 v[74:75], 0
    v_mov_b64 v[76:77], 0
    v_mov_b64 v[78:79], 0
    v_mov_b64 v[80:81], 0
    v_mov_b64 v[82:83], 0
    v_mov_b64 v[84:85], 0
    v_mov_b64 v[86:87], 0
    v_mov_b64 v[88:89], 0
    v_mov_b64 v[90:91], 0
    v_mov_b64 v[92:93], 0
    v_mov_b64 v[94:95], 0
    v_mov_b64 v[96:97], 0
    v_mov_b64 v[98:99], 0
    v_mov_b64 v[100:101], 0
    v_mov_b64 v[102:103], 0
    v_mov_b64 v[104:105], 0
    v_mov_b64 v[106:107], 0
    v_mov_b64 v[108:109], 0
    v_mov_b64 v[110:111], 0
    v_mov_b64 v[112:113], 0
    v_mov_b64 v[114:115], 0
    v_mov_b64 v[116:117], 0
    v_mov_b64 v[118:119], 0
    v_mov_b64 v[120:121], 0
    v_mov_b64 v[122:123], 0
    v_mov_b64 v[124:125], 0
    v_mov_b64 v[126:127], 0
    s_mov_b32 s59, 0
    s_lshl_b32 s60, s45, 12
    s_lshl_b32 s61, s59, 7
    s_add_u32 s61, s61, s55
    s_add_u32 m0, s60, 0
    s_nop 0
    buffer_load_dwordx4 v2, s[32:35], s61 offen sc1 lds
    s_add_u32 m0, s60, 1024
    s_nop 0
    buffer_load_dwordx4 v3, s[32:35], s61 offen sc1 lds
    s_add_u32 m0, s60, 2048
    s_nop 0
    buffer_load_dwordx4 v4, s[32:35], s61 offen sc1 lds
    s_add_u32 m0, s60, 3072
    s_nop 0
    buffer_load_dwordx4 v5, s[32:35], s61 offen sc1 lds
    s_lshl_b32 s61, s59, 6
    s_lshl_b32 s62, s45, 4
    s_add_u32 s61, s61, s62
    s_mul_i32 s61, s61, 1024
    s_add_u32 s62, s61, s56
    s_add_u32 m0, s60, 16384
    s_add_u32 s63, s62, 0
    buffer_load_dwordx4 v6, s[80:83], s63 offen lds
    s_add_u32 m0, s60, 17408
    s_add_u32 s63, s62, 4096
    buffer_load_dwordx4 v6, s[80:83], s63 offen lds
    s_add_u32 m0, s60, 18432
    s_add_u32 s63, s62, 8192
    buffer_load_dwordx4 v6, s[80:83], s63 offen lds
    s_add_u32 m0, s60, 19456
    s_add_u32 s63, s62, 12288
    buffer_load_dwordx4 v6, s[80:83], s63 offen lds
    s_mov_b32 s59, 1
    s_lshl_b32 s60, s45, 12
    s_lshl_b32 s61, s59, 7
    s_add_u32 s61, s61, s55
    s_add_u32 m0, s60, 32768
    s_nop 0
    buffer_load_dwordx4 v2, s[32:35], s61 offen sc1 lds
    s_add_u32 m0, s60, 33792
    s_nop 0
    buffer_load_dwordx4 v3, s[32:35], s61 offen sc1 lds
    s_add_u32 m0, s60, 34816
    s_nop 0
    buffer_load_dwordx4 v4, s[32:35], s61 offen sc1 lds
    s_add_u32 m0, s60, 35840
    s_nop 0
    buffer_load_dwordx4 v5, s[32:35], s61 offen sc1 lds
    s_lshl_b32 s61, s59, 6
    s_lshl_b32 s62, s45, 4
    s_add_u32 s61, s61, s62
    s_mul_i32 s61, s61, 1024
    s_add_u32 s62, s61, s56
    s_add_u32 m0, s60, 49152
    s_add_u32 s63, s62, 0
    buffer_load_dwordx4 v6, s[80:83], s63 offen lds
    s_add_u32 m0, s60, 50176
    s_add_u32 s63, s62, 4096
    buffer_load_dwordx4 v6, s[80:83], s63 offen lds
    s_add_u32 m0, s60, 51200
    s_add_u32 s63, s62, 8192
    buffer_load_dwordx4 v6, s[80:83], s63 offen lds
    s_add_u32 m0, s60, 52224
    s_add_u32 s63, s62, 12288
    buffer_load_dwordx4 v6, s[80:83], s63 offen lds
    s_mov_b32 s59, 2
    s_lshl_b32 s60, s45, 12
    s_lshl_b32 s61, s59, 7
    s_add_u32 s61, s61, s55
    s_add_u32 m0, s60, 65536
    s_nop 0
    buffer_load_dwordx4 v2, s[32:35], s61 offen sc1 lds
    s_add_u32 m0, s60, 66560
    s_nop 0
    buffer_load_dwordx4 v3, s[32:35], s61 offen sc1 lds
    s_add_u32 m0, s60, 67584
    s_nop 0
    buffer_load_dwordx4 v4, s[32:35], s61 offen sc1 lds
    s_add_u32 m0, s60, 68608
    s_nop 0
    buffer_load_dwordx4 v5, s[32:35], s61 offen sc1 lds
    s_lshl_b32 s61, s59, 6
    s_lshl_b32 s62, s45, 4
    s_add_u32 s61, s61, s62
    s_mul_i32 s61, s61, 1024
    s_add_u32 s62, s61, s56
    s_add_u32 m0, s60, 81920
    s_add_u32 s63, s62, 0
    buffer_load_dwordx4 v6, s[80:83], s63 offen lds
    s_add_u32 m0, s60, 82944
    s_add_u32 s63, s62, 4096
    buffer_load_dwordx4 v6, s[80:83], s63 offen lds
    s_add_u32 m0, s60, 83968
    s_add_u32 s63, s62, 8192
    buffer_load_dwordx4 v6, s[80:83], s63 offen lds
    s_add_u32 m0, s60, 84992
    s_add_u32 s63, s62, 12288
    buffer_load_dwordx4 v6, s[80:83], s63 offen lds
    s_mov_b32 s100, 2
L_gl_ao:
    s_waitcnt vmcnt(16)
L_gl_ao_in:
    s_barrier
    ds_read_b128 a[48:51], v8
    ds_read_b64_tr_b16 a[0:1], v12 offset:0
    ds_read_b64_tr_b16 a[2:3], v12 offset:1024
    ds_read_b64_tr_b16 a[4:5], v13 offset:0
    ds_read_b64_tr_b16 a[6:7], v13 offset:1024
    ds_read_b64_tr_b16 a[8:9], v14 offset:0
    ds_read_b64_tr_b16 a[10:11], v14 offset:1024
    ds_read_b64_tr_b16 a[12:13], v15 offset:0
    ds_read_b64_tr_b16 a[14:15], v15 offset:1024
    s_add_u32 s100, s100, 1
    s_min_u32 s59, s100, 7
    s_waitcnt lgkmcnt(6)
    v_mfma_f32_32x32x16_bf16 v[64:79], a[0:3], a[48:51], v[64:79]
    ds_read_b128 a[112:115], v9
    ds_read_b64_tr_b16 a[64:65], v12 offset:4096
    ds_read_b64_tr_b16 a[66:67], v12 offset:5120
    s_lshl_b32 s60, s45, 12
    s_lshl_b32 s61, s59, 7
    s_add_u32 s61, s61, s55
    s_add_u32 m0, s60, 98304
    s_nop 0
    buffer_load_dwordx4 v2, s[32:35], s61 offen sc1 lds
    s_waitcnt lgkmcnt(7)
    v_mfma_f32_32x32x16_bf16 v[80:95], a[4:7], a[48:51], v[80:95]
    ds_read_b64_tr_b16 a[68:69], v13 offset:4096
    ds_read_b64_tr_b16 a[70:71], v13 offset:5120
    s_waitcnt lgkmcnt(7)
    v_mfma_f32_32x32x16_bf16 v[96:111], a[8:11], a[48:51], v[96:111]
    ds_read_b64_tr_b16 a[72:73], v14 offset:4096
    ds_read_b64_tr_b16 a[74:75], v14 offset:5120
    s_add_u32 m0, s60, 99328
    s_nop 0
    buffer_load_dwordx4 v3, s[32:35], s61 offen sc1 lds
    s_waitcnt lgkmcnt(7)
    v_mfma_f32_32x32x16_bf16 v[112:127], a[12:15], a[48:51], v[112:127]
    ds_read_b64_tr_b16 a[76:77], v15 offset:4096
    ds_read_b64_tr_b16 a[78:79], v15 offset:5120
    s_waitcnt lgkmcnt(6)
    v_mfma_f32_32x32x16_bf16 v[64:79], a[64:67], a[112:115], v[64:79]
    ds_read_b128 a[48:51], v10
    ds_read_b64_tr_b16 a[0:1], v12 offset:8192
    ds_read_b64_tr_b16 a[2:3], v12 offset:9216
    s_add_u32 m0, s60, 100352
    s_nop 0
    buffer_load_dwordx4 v4, s[32:35], s61 offen sc1 lds
    s_waitcnt lgkmcnt(7)
    v_mfma_f32_32x32x16_bf16 v[80:95], a[68:71], a[112:115], v[80:95]
    ds_read_b64_tr_b16 a[4:5], v13 offset:8192
    ds_read_b64_tr_b16 a[6:7], v13 offset:9216
    s_waitcnt lgkmcnt(7)
    v_mfma_f32_32x32x16_bf16 v[96:111], a[72:75], a[112:115], v[96:111]
    ds_read_b64_tr_b16 a[8:9], v14 offset:8192
    ds_read_b64_tr_b16 a[10:11], v14 offset:9216
    s_add_u32 m0, s60, 101376
    s_nop 0
    buffer_load_dwordx4 v5, s[32:35], s61 offen sc1 lds
    s_waitcnt lgkmcnt(7)
    v_mfma_f32_32x32x16_bf16 v[112:127], a[76:79], a[112:115], v[112:127]
    ds_read_b64_tr_b16 a[12:13], v15 offset:8192
    ds_read_b64_tr_b16 a[14:15], v15 offset:9216
    s_waitcnt lgkmcnt(6)
    v_mfma_f32_32x32x16_bf16 v[64:79], a[0:3], a[48:51], v[64:79]
    ds_read_b128 a[112:115], v11
    ds_read_b64_tr_b16 a[64:65], v12 offset:12288
    ds_read_b64_tr_b16 a[66:67], v12 offset:13312
    s_lshl_b32 s61, s59, 6
    s_lshl_b32 s62, s45, 4
    s_add_u32 s61, s61, s62
    s_mul_i32 s61, s61, 1024
    s_add_u32 s62, s61, s56
    s_add_u32 m0, s60, 114688
    s_add_u32 s63, s62, 0
    buffer_load_dwordx4 v6, s[80:83], s63 offen lds
    s_waitcnt lgkmcnt(7)
    v_mfma_f32_32x32x16_bf16 v[80:95], a[4:7], a[48:51], v[80:95]
    ds_read_b64_tr_b16 a[68:69], v13 offset:12288
    ds_read_b64_tr_b16 a[70:71], v13 offset:13312
    s_waitcnt lgkmcnt(7)
    v_mfma_f32_32x32x16_bf16 v[96:111], a[8:11], a[48:51], v[96:111]
    ds_read_b64_tr_b16 a[72:73], v14 offset:12288
    ds_read_b64_tr_b16 a[74:75], v14 offset:13312
    s_add_u32 m0, s60, 115712
    s_add_u32 s63, s62, 4096
    buffer_load_dwordx4 v6, s[80:83], s63 offen lds
    s_waitcnt lgkmcnt(7)
    v_mfma_f32_32x32x16_bf16 v[112:127], a[12:15], a[48:51], v[112:127]
    ds_read_b64_tr_b16 a[76:77], v15 offset:12288
    ds_read_b64_tr_b16 a[78:79], v15 offset:13312
    s_waitcnt lgkmcnt(6)
    v_mfma_f32_32x32x16_bf16 v[64:79], a[64:67], a[112:115], v[64:79]
    s_add_u32 m0, s60, 116736
    s_add_u32 s63, s62, 8192
    buffer_load_dwordx4 v6, s[80:83], s63 offen lds
    s_waitcnt lgkmcnt(4)
    v_mfma_f32_32x32x16_bf16 v[80:95], a[68:71], a[112:115], v[80:95]
    s_waitcnt lgkmcnt(2)
    v_mfma_f32_32x32x16_bf16 v[96:111], a[72:75], a[112:115], v[96:111]
    s_add_u32 m0, s60, 117760
    s_add_u32 s63, s62, 12288
    buffer_load_dwordx4 v6, s[80:83], s63 offen lds
    s_waitcnt lgkmcnt(0)
    v_mfma_f32_32x32x16_bf16 v[112:127], a[76:79], a[112:115], v[112:127]
    v_add_u32 v8, 0x8000, v8
    v_add_u32 v12, 0x8000, v12
    v_add_u32 v9, 0x8000, v9
    v_add_u32 v13, 0x8000, v13
    v_add_u32 v10, 0x8000, v10
    v_add_u32 v14, 0x8000, v14
    v_add_u32 v11, 0x8000, v11
    v_add_u32 v15, 0x8000, v15
    s_waitcnt vmcnt(16)
    s_barrier
    ds_read_b128 a[48:51], v8
    ds_read_b64_tr_b16 a[0:1], v12 offset:0
    ds_read_b64_tr_b16 a[2:3], v12 offset:1024
    ds_read_b64_tr_b16 a[4:5], v13 offset:0
    ds_read_b64_tr_b16 a[6:7], v13 offset:1024
    ds_read_b64_tr_b16 a[8:9], v14 offset:0
    ds_read_b64_tr_b16 a[10:11], v14 offset:1024
    ds_read_b64_tr_b16 a[12:13], v15 offset:0
    ds_read_b64_tr_b16 a[14:15], v15 offset:1024
    s_add_u32 s100, s100, 1
    s_min_u32 s59, s100, 7
    s_waitcnt lgkmcnt(6)
    v_mfma_f32_32x32x16_bf16 v[64:79], a[0:3], a[48:51], v[64:79]
    ds_read_b128 a[112:115], v9
    ds_read_b64_tr_b16 a[64:65], v12 offset:4096
    ds_read_b64_tr_b16 a[66:67], v12 offset:5120
    s_lshl_b32 s60, s45, 12
    s_lshl_b32 s61, s59, 7
    s_add_u32 s61, s61, s55
    s_add_u32 m0, s60, 0
    s_nop 0
    buffer_load_dwordx4 v2, s[32:35], s61 offen sc1 lds
    s_waitcnt lgkmcnt(7)
    v_mfma_f32_32x32x16_bf16 v[80:95], a[4:7], a[48:51], v[80:95]
    ds_read_b64_tr_b16 a[68:69], v13 offset:4096
    ds_read_b64_tr_b16 a[70:71], v13 offset:5120
    s_waitcnt lgkmcnt(7)
    v_mfma_f32_32x32x16_bf16 v[96:111], a[8:11], a[48:51], v[96:111]
    ds_read_b64_tr_b16 a[72:73], v14 offset:4096
    ds_read_b64_tr_b16 a[74:75], v14 offset:5120
    s_add_u32 m0, s60, 1024
    s_nop 0
    buffer_load_dwordx4 v3, s[32:35], s61 offen sc1 lds
    s_waitcnt lgkmcnt(7)
    v_mfma_f32_32x32x16_bf16 v[112:127], a[12:15], a[48:51], v[112:127]
    ds_read_b64_tr_b16 a[76:77], v15 offset:4096
    ds_read_b64_tr_b16 a[78:79], v15 offset:5120
    s_waitcnt lgkmcnt(6)
    v_mfma_f32_32x32x16_bf16 v[64:79], a[64:67], a[112:115], v[64:79]
    ds_read_b128 a[48:51], v10
    ds_read_b64_tr_b16 a[0:1], v12 offset:8192
    ds_read_b64_tr_b16 a[2:3], v12 offset:9216
    s_add_u32 m0, s60, 2048
    s_nop 0
    buffer_load_dwordx4 v4, s[32:35], s61 offen sc1 lds
    s_waitcnt lgkmcnt(7)
    v_mfma_f32_32x32x16_bf16 v[80:95], a[68:71], a[112:115], v[80:95]
    ds_read_b64_tr_b16 a[4:5], v13 offset:8192
    ds_read_b64_tr_b16 a[6:7], v13 offset:9216
    s_waitcnt lgkmcnt(7)
    v_mfma_f32_32x32x16_bf16 v[96:111], a[72:75], a[112:115], v[96:111]
    ds_read_b64_tr_b16 a[8:9], v14 offset:8192
    ds_read_b64_tr_b16 a[10:11], v14 offset:9216
    s_add_u32 m0, s60, 3072
    s_nop 0
    buffer_load_dwordx4 v5, s[32:35], s61 offen sc1 lds
    s_waitcnt lgkmcnt(7)
    v_mfma_f32_32x32x16_bf16 v[112:127], a[76:79], a[112:115], v[112:127]
    ds_read_b64_tr_b16 a[12:13], v15 offset:8192
    ds_read_b64_tr_b16 a[14:15], v15 offset:9216
    s_waitcnt lgkmcnt(6)
    v_mfma_f32_32x32x16_bf16 v[64:79], a[0:3], a[48:51], v[64:79]
    ds_read_b128 a[112:115], v11
    ds_read_b64_tr_b16 a[64:65], v12 offset:12288
    ds_read_b64_tr_b16 a[66:67], v12 offset:13312
    s_lshl_b32 s61, s59, 6
    s_lshl_b32 s62, s45, 4
    s_add_u32 s61, s61, s62
    s_mul_i32 s61, s61, 1024
    s_add_u32 s62, s61, s56
    s_add_u32 m0, s60, 16384
    s_add_u32 s63, s62, 0
    buffer_load_dwordx4 v6, s[80:83], s63 offen lds
    s_waitcnt lgkmcnt(7)
    v_mfma_f32_32x32x16_bf16 v[80:95], a[4:7], a[48:51], v[80:95]
    ds_read_b64_tr_b16 a[68:69], v13 offset:12288
    ds_read_b64_tr_b16 a[70:71], v13 offset:13312
    s_waitcnt lgkmcnt(7)
    v_mfma_f32_32x32x16_bf16 v[96:111], a[8:11], a[48:51], v[96:111]
    ds_read_b64_tr_b16 a[72:73], v14 offset:12288
    ds_read_b64_tr_b16 a[74:75], v14 offset:13312
    s_add_u32 m0, s60, 17408
    s_add_u32 s63, s62, 4096
    buffer_load_dwordx4 v6, s[80:83], s63 offen lds
    s_waitcnt lgkmcnt(7)
    v_mfma_f32_32x32x16_bf16 v[112:127], a[12:15], a[48:51], v[112:127]
    ds_read_b64_tr_b16 a[76:77], v15 offset:12288
    ds_read_b64_tr_b16 a[78:79], v15 offset:13312
    s_waitcnt lgkmcnt(6)
    v_mfma_f32_32x32x16_bf16 v[64:79], a[64:67], a[112:115], v[64:79]
    s_add_u32 m0, s60, 18432
    s_add_u32 s63, s62, 8192
    buffer_load_dwordx4 v6, s[80:83], s63 offen lds
    s_waitcnt lgkmcnt(4)
    v_mfma_f32_32x32x16_bf16 v[80:95], a[68:71], a[112:115], v[80:95]
    s_waitcnt lgkmcnt(2)
    v_mfma_f32_32x32x16_bf16 v[96:111], a[72:75], a[112:115], v[96:111]
    s_add_u32 m0, s60, 19456
    s_add_u32 s63, s62, 12288
    buffer_load_dwordx4 v6, s[80:83], s63 offen lds
    s_waitcnt lgkmcnt(0)
    v_mfma_f32_32x32x16_bf16 v[112:127], a[76:79], a[112:115], v[112:127]
    v_add_u32 v8, 0x8000, v8
    v_add_u32 v12, 0x8000, v12
    v_add_u32 v9, 0x8000, v9
    v_add_u32 v13, 0x8000, v13
    v_add_u32 v10, 0x8000, v10
    v_add_u32 v14, 0x8000, v14
    v_add_u32 v11, 0x8000, v11
    v_add_u32 v15, 0x8000, v15
    s_waitcnt vmcnt(16)
    s_barrier
    ds_read_b128 a[48:51], v8
    ds_read_b64_tr_b16 a[0:1], v12 offset:0
    ds_read_b64_tr_b16 a[2:3], v12 offset:1024
    ds_read_b64_tr_b16 a[4:5], v13 offset:0
    ds_read_b64_tr_b16 a[6:7], v13 offset:1024
    ds_read_b64_tr_b16 a[8:9], v14 offset:0
    ds_read_b64_tr_b16 a[10:11], v14 offset:1024
    ds_read_b64_tr_b16 a[12:13], v15 offset:0
    ds_read_b64_tr_b16 a[14:15], v15 offset:1024
    s_add_u32 s100, s100, 1
    s_min_u32 s59, s100, 7
    s_waitcnt lgkmcnt(6)
    v_mfma_f32_32x32x16_bf16 v[64:79], a[0:3], a[48:51], v[64:79]
    ds_read_b128 a[112:115], v9
    ds_read_b64_tr_b16 a[64:65], v12 offset:4096
    ds_read_b64_tr_b16 a[66:67], v12 offset:5120
    s_lshl_b32 s60, s45, 12
    s_lshl_b32 s61, s59, 7
    s_add_u32 s61, s61, s55
    s_add_u32 m0, s60, 32768
    s_nop 0
    buffer_load_dwordx4 v2, s[32:35], s61 offen sc1 lds
    s_waitcnt lgkmcnt(7)
    v_mfma_f32_32x32x16_bf16 v[80:95], a[4:7], a[48:51], v[80:95]
    ds_read_b64_tr_b16 a[68:69], v13 offset:4096
    ds_read_b64_tr_b16 a[70:71], v13 offset:5120
    s_waitcnt lgkmcnt(7)
    v_mfma_f32_32x32x16_bf16 v[96:111], a[8:11], a[48:51], v[96:111]
    ds_read_b64_tr_b16 a[72:73], v14 offset:4096
    ds_read_b64_tr_b16 a[74:75], v14 offset:5120
    s_add_u32 m0, s60, 33792
    s_nop 0
    buffer_load_dwordx4 v3, s[32:35], s61 offen sc1 lds
    s_waitcnt lgkmcnt(7)
    v_mfma_f32_32x32x16_bf16 v[112:127], a[12:15], a[48:51], v[112:127]
    ds_read_b64_tr_b16 a[76:77], v15 offset:4096
    ds_read_b64_tr_b16 a[78:79], v15 offset:5120
    s_waitcnt lgkmcnt(6)
    v_mfma_f32_32x32x16_bf16 v[64:79], a[64:67], a[112:115], v[64:79]
    ds_read_b128 a[48:51], v10
    ds_read_b64_tr_b16 a[0:1], v12 offset:8192
    ds_read_b64_tr_b16 a[2:3], v12 offset:9216
    s_add_u32 m0, s60, 34816
    s_nop 0
    buffer_load_dwordx4 v4, s[32:35], s61 offen sc1 lds
    s_waitcnt lgkmcnt(7)
    v_mfma_f32_32x32x16_bf16 v[80:95], a[68:71], a[112:115], v[80:95]
    ds_read_b64_tr_b16 a[4:5], v13 offset:8192
    ds_read_b64_tr_b16 a[6:7], v13 offset:9216
    s_waitcnt lgkmcnt(7)
    v_mfma_f32_32x32x16_bf16 v[96:111], a[72:75], a[112:115], v[96:111]
    ds_read_b64_tr_b16 a[8:9], v14 offset:8192
    ds_read_b64_tr_b16 a[10:11], v14 offset:9216
    s_add_u32 m0, s60, 35840
    s_nop 0
    buffer_load_dwordx4 v5, s[32:35], s61 offen sc1 lds
    s_waitcnt lgkmcnt(7)
    v_mfma_f32_32x32x16_bf16 v[112:127], a[76:79], a[112:115], v[112:127]
    ds_read_b64_tr_b16 a[12:13], v15 offset:8192
    ds_read_b64_tr_b16 a[14:15], v15 offset:9216
    s_waitcnt lgkmcnt(6)
    v_mfma_f32_32x32x16_bf16 v[64:79], a[0:3], a[48:51], v[64:79]
    ds_read_b128 a[112:115], v11
    ds_read_b64_tr_b16 a[64:65], v12 offset:12288
    ds_read_b64_tr_b16 a[66:67], v12 offset:13312
    s_lshl_b32 s61, s59, 6
    s_lshl_b32 s62, s45, 4
    s_add_u32 s61, s61, s62
    s_mul_i32 s61, s61, 1024
    s_add_u32 s62, s61, s56
    s_add_u32 m0, s60, 49152
    s_add_u32 s63, s62, 0
    buffer_load_dwordx4 v6, s[80:83], s63 offen lds
    s_waitcnt lgkmcnt(7)
    v_mfma_f32_32x32x16_bf16 v[80:95], a[4:7], a[48:51], v[80:95]
    ds_read_b64_tr_b16 a[68:69], v13 offset:12288
    ds_read_b64_tr_b16 a[70:71], v13 offset:13312
    s_waitcnt lgkmcnt(7)
    v_mfma_f32_32x32x16_bf16 v[96:111], a[8:11], a[48:51], v[96:111]
    ds_read_b64_tr_b16 a[72:73], v14 offset:12288
    ds_read_b64_tr_b16 a[74:75], v14 offset:13312
    s_add_u32 m0, s60, 50176
    s_add_u32 s63, s62, 4096
    buffer_load_dwordx4 v6, s[80:83], s63 offen lds
    s_waitcnt lgkmcnt(7)
    v_mfma_f32_32x32x16_bf16 v[112:127], a[12:15], a[48:51], v[112:127]
    ds_read_b64_tr_b16 a[76:77], v15 offset:12288
    ds_read_b64_tr_b16 a[78:79], v15 offset:13312
    s_waitcnt lgkmcnt(6)
    v_mfma_f32_32x32x16_bf16 v[64:79], a[64:67], a[112:115], v[64:79]
    s_add_u32 m0, s60, 51200
    s_add_u32 s63, s62, 8192
    buffer_load_dwordx4 v6, s[80:83], s63 offen lds
    s_waitcnt lgkmcnt(4)
    v_mfma_f32_32x32x16_bf16 v[80:95], a[68:71], a[112:115], v[80:95]
    s_waitcnt lgkmcnt(2)
    v_mfma_f32_32x32x16_bf16 v[96:111], a[72:75], a[112:115], v[96:111]
    s_add_u32 m0, s60, 52224
    s_add_u32 s63, s62, 12288
    buffer_load_dwordx4 v6, s[80:83], s63 offen lds
    s_waitcnt lgkmcnt(0)
    v_mfma_f32_32x32x16_bf16 v[112:127], a[76:79], a[112:115], v[112:127]
    v_add_u32 v8, 0x8000, v8
    v_add_u32 v12, 0x8000, v12
    v_add_u32 v9, 0x8000, v9
    v_add_u32 v13, 0x8000, v13
    v_add_u32 v10, 0x8000, v10
    v_add_u32 v14, 0x8000, v14
    v_add_u32 v11, 0x8000, v11
    v_add_u32 v15, 0x8000, v15
    s_waitcnt vmcnt(16)
    s_barrier
    ds_read_b128 a[48:51], v8
    ds_read_b64_tr_b16 a[0:1], v12 offset:0
    ds_read_b64_tr_b16 a[2:3], v12 offset:1024
    ds_read_b64_tr_b16 a[4:5], v13 offset:0
    ds_read_b64_tr_b16 a[6:7], v13 offset:1024
    ds_read_b64_tr_b16 a[8:9], v14 offset:0
    ds_read_b64_tr_b16 a[10:11], v14 offset:1024
    ds_read_b64_tr_b16 a[12:13], v15 offset:0
    ds_read_b64_tr_b16 a[14:15], v15 offset:1024
    s_add_u32 s100, s100, 1
    s_min_u32 s59, s100, 7
    s_waitcnt lgkmcnt(6)
    v_mfma_f32_32x32x16_bf16 v[64:79], a[0:3], a[48:51], v[64:79]
    ds_read_b128 a[112:115], v9
    ds_read_b64_tr_b16 a[64:65], v12 offset:4096
    ds_read_b64_tr_b16 a[66:67], v12 offset:5120
    s_lshl_b32 s60, s45, 12
    s_lshl_b32 s61, s59, 7
    s_add_u32 s61, s61, s55
    s_add_u32 m0, s60, 65536
    s_nop 0
    buffer_load_dwordx4 v2, s[32:35], s61 offen sc1 lds
    s_waitcnt lgkmcnt(7)
    v_mfma_f32_32x32x16_bf16 v[80:95], a[4:7], a[48:51], v[80:95]
    ds_read_b64_tr_b16 a[68:69], v13 offset:4096
    ds_read_b64_tr_b16 a[70:71], v13 offset:5120
    s_waitcnt lgkmcnt(7)
    v_mfma_f32_32x32x16_bf16 v[96:111], a[8:11], a[48:51], v[96:111]
    ds_read_b64_tr_b16 a[72:73], v14 offset:4096
    ds_read_b64_tr_b16 a[74:75], v14 offset:5120
    s_add_u32 m0, s60, 66560
    s_nop 0
    buffer_load_dwordx4 v3, s[32:35], s61 offen sc1 lds
    s_waitcnt lgkmcnt(7)
    v_mfma_f32_32x32x16_bf16 v[112:127], a[12:15], a[48:51], v[112:127]
    ds_read_b64_tr_b16 a[76:77], v15 offset:4096
    ds_read_b64_tr_b16 a[78:79], v15 offset:5120
    s_waitcnt lgkmcnt(6)
    v_mfma_f32_32x32x16_bf16 v[64:79], a[64:67], a[112:115], v[64:79]
    ds_read_b128 a[48:51], v10
    ds_read_b64_tr_b16 a[0:1], v12 offset:8192
    ds_read_b64_tr_b16 a[2:3], v12 offset:9216
    s_add_u32 m0, s60, 67584
    s_nop 0
    buffer_load_dwordx4 v4, s[32:35], s61 offen sc1 lds
    s_waitcnt lgkmcnt(7)
    v_mfma_f32_32x32x16_bf16 v[80:95], a[68:71], a[112:115], v[80:95]
    ds_read_b64_tr_b16 a[4:5], v13 offset:8192
    ds_read_b64_tr_b16 a[6:7], v13 offset:9216
    s_waitcnt lgkmcnt(7)
    v_mfma_f32_32x32x16_bf16 v[96:111], a[72:75], a[112:115], v[96:111]
    ds_read_b64_tr_b16 a[8:9], v14 offset:8192
    ds_read_b64_tr_b16 a[10:11], v14 offset:9216
    s_add_u32 m0, s60, 68608
    s_nop 0
    buffer_load_dwordx4 v5, s[32:35], s61 offen sc1 lds
    s_waitcnt lgkmcnt(7)
    v_mfma_f32_32x32x16_bf16 v[112:127], a[76:79], a[112:115], v[112:127]
    ds_read_b64_tr_b16 a[12:13], v15 offset:8192
    ds_read_b64_tr_b16 a[14:15], v15 offset:9216
    s_waitcnt lgkmcnt(6)
    v_mfma_f32_32x32x16_bf16 v[64:79], a[0:3], a[48:51], v[64:79]
    ds_read_b128 a[112:115], v11
    ds_read_b64_tr_b16 a[64:65], v12 offset:12288
    ds_read_b64_tr_b16 a[66:67], v12 offset:13312
    s_lshl_b32 s61, s59, 6
    s_lshl_b32 s62, s45, 4
    s_add_u32 s61, s61, s62
    s_mul_i32 s61, s61, 1024
    s_add_u32 s62, s61, s56
    s_add_u32 m0, s60, 81920
    s_add_u32 s63, s62, 0
    buffer_load_dwordx4 v6, s[80:83], s63 offen lds
    s_waitcnt lgkmcnt(7)
    v_mfma_f32_32x32x16_bf16 v[80:95], a[4:7], a[48:51], v[80:95]
    ds_read_b64_tr_b16 a[68:69], v13 offset:12288
    ds_read_b64_tr_b16 a[70:71], v13 offset:13312
    s_waitcnt lgkmcnt(7)
    v_mfma_f32_32x32x16_bf16 v[96:111], a[8:11], a[48:51], v[96:111]
    ds_read_b64_tr_b16 a[72:73], v14 offset:12288
    ds_read_b64_tr_b16 a[74:75], v14 offset:13312
    s_add_u32 m0, s60, 82944
    s_add_u32 s63, s62, 4096
    buffer_load_dwordx4 v6, s[80:83], s63 offen lds
    s_waitcnt lgkmcnt(7)
    v_mfma_f32_32x32x16_bf16 v[112:127], a[12:15], a[48:51], v[112:127]
    ds_read_b64_tr_b16 a[76:77], v15 offset:12288
    ds_read_b64_tr_b16 a[78:79], v15 offset:13312
    s_waitcnt lgkmcnt(6)
    v_mfma_f32_32x32x16_bf16 v[64:79], a[64:67], a[112:115], v[64:79]
    s_add_u32 m0, s60, 83968
    s_add_u32 s63, s62, 8192
    buffer_load_dwordx4 v6, s[80:83], s63 offen lds
    s_waitcnt lgkmcnt(4)
    v_mfma_f32_32x32x16_bf16 v[80:95], a[68:71], a[112:115], v[80:95]
    s_waitcnt lgkmcnt(2)
    v_mfma_f32_32x32x16_bf16 v[96:111], a[72:75], a[112:115], v[96:111]
    s_add_u32 m0, s60, 84992
    s_add_u32 s63, s62, 12288
    buffer_load_dwordx4 v6, s[80:83], s63 offen lds
    s_waitcnt lgkmcnt(0)
    v_mfma_f32_32x32x16_bf16 v[112:127], a[76:79], a[112:115], v[112:127]
    v_add_u32 v8, 0xfffe8000, v8
    v_add_u32 v12, 0xfffe8000, v12
    v_add_u32 v9, 0xfffe8000, v9
    v_add_u32 v13, 0xfffe8000, v13
    v_add_u32 v10, 0xfffe8000, v10
    v_add_u32 v14, 0xfffe8000, v14
    v_add_u32 v11, 0xfffe8000, v11
    v_add_u32 v15, 0xfffe8000, v15
    s_cmp_lt_u32 s100, 10
    s_cbranch_scc1 L_gl_ao
    s_waitcnt vmcnt(0)
    s_nop 15
    v_and_b32 v24, 31, v1
    v_lshlrev_b32 v24, 11, v24
    v_lshrrev_b32 v26, 5, v1
    v_lshl_add_u32 v24, v26, 3, v24
    s_lshl_b32 s60, s53, 2
    s_add_u32 s60, s60, s45
    s_lshl_b32 s60, s60, 16
    s_lshl_b32 s61, s54, 8
    s_add_u32 s60, s60, s61
    s_add_u32 s60, s60, 0
    v_cvt_pk_bf16_f32 v64, v64, v65
    v_cvt_pk_bf16_f32 v65, v66, v67
    v_cvt_pk_bf16_f32 v68, v68, v69
    v_cvt_pk_bf16_f32 v69, v70, v71
    v_cvt_pk_bf16_f32 v72, v72, v73
    v_cvt_pk_bf16_f32 v73, v74, v75
    v_cvt_pk_bf16_f32 v76, v76, v77
    v_cvt_pk_bf16_f32 v77, v78, v79
    buffer_store_dwordx2 v[64:65], v24, s[92:95], s60 offen offset:0
    buffer_store_dwordx2 v[68:69], v24, s[92:95], s60 offen offset:16
    buffer_store_dwordx2 v[72:73], v24, s[92:95], s60 offen offset:32
    buffer_store_dwordx2 v[76:77], v24, s[92:95], s60 offen offset:48
    v_cvt_pk_bf16_f32 v80, v80, v81
    v_cvt_pk_bf16_f32 v81, v82, v83
    v_cvt_pk_bf16_f32 v84, v84, v85
    v_cvt_pk_bf16_f32 v85, v86, v87
    v_cvt_pk_bf16_f32 v88, v88, v89
    v_cvt_pk_bf16_f32 v89, v90, v91
    v_cvt_pk_bf16_f32 v92, v92, v93
    v_cvt_pk_bf16_f32 v93, v94, v95
    buffer_store_dwordx2 v[80:81], v24, s[92:95], s60 offen offset:64
    buffer_store_dwordx2 v[84:85], v24, s[92:95], s60 offen offset:80
    buffer_store_dwordx2 v[88:89], v24, s[92:95], s60 offen offset:96
    buffer_store_dwordx2 v[92:93], v24, s[92:95], s60 offen offset:112
    v_cvt_pk_bf16_f32 v96, v96, v97
    v_cvt_pk_bf16_f32 v97, v98, v99
    v_cvt_pk_bf16_f32 v100, v100, v101
    v_cvt_pk_bf16_f32 v101, v102, v103
    v_cvt_pk_bf16_f32 v104, v104, v105
    v_cvt_pk_bf16_f32 v105, v106, v107
    v_cvt_pk_bf16_f32 v108, v108, v109
    v_cvt_pk_bf16_f32 v109, v110, v111
    buffer_store_dwordx2 v[96:97], v24, s[92:95], s60 offen offset:128
    buffer_store_dwordx2 v[100:101], v24, s[92:95], s60 offen offset:144
    buffer_store_dwordx2 v[104:105], v24, s[92:95], s60 offen offset:160
    buffer_store_dwordx2 v[108:109], v24, s[92:95], s60 offen offset:176
    v_cvt_pk_bf16_f32 v112, v112, v113
    v_cvt_pk_bf16_f32 v113, v114, v115
    v_cvt_pk_bf16_f32 v116, v116, v117
    v_cvt_pk_bf16_f32 v117, v118, v119
    v_cvt_pk_bf16_f32 v120, v120, v121
    v_cvt_pk_bf16_f32 v121, v122, v123
    v_cvt_pk_bf16_f32 v124, v124, v125
    v_cvt_pk_bf16_f32 v125, v126, v127
    buffer_store_dwordx2 v[112:113], v24, s[92:95], s60 offen offset:192
    buffer_store_dwordx2 v[116:117], v24, s[92:95], s60 offen offset:208
    buffer_store_dwordx2 v[120:121], v24, s[92:95], s60 offen offset:224
    buffer_store_dwordx2 v[124:125], v24, s[92:95], s60 offen offset:240
    s_branch L_next
L_t_battn:
    s_lshl_b32 s56, s54, 2
    s_add_u32 s56, s56, s45
    s_lshl_b32 s60, s56, 7
    s_lshl_b32 s61, s53, 2
    s_add_u32 s60, s60, s61
    s_add_u32 s60, s60, 0x0
    s_cmp_lg_u32 s98, 0
    s_cbranch_scc1 L_id_66
    v_mov_b32 v16, 128
L_iw_65:
    s_add_u32 s101, s101, 1
    s_cmp_gt_u32 s101, 0x200000
    s_cbranch_scc1 L_exit
    global_load_dword v17, v16, s[26:27] sc1
    s_waitcnt vmcnt(0)
    v_readfirstlane_b32 s61, v17
    s_nop 2
    s_cmp_lt_u32 s61, 32
    s_cbranch_scc1 L_iw_65
    s_mov_b32 s98, 1
L_id_66:
    v_mov_b32 v16, 0
L_wait_67:
    s_add_u32 s101, s101, 1
    s_cmp_gt_u32 s101, 0x200000
    s_cbranch_scc1 L_exit
    buffer_load_dword v17, v16, s[32:35], s60 offen sc1
    s_waitcnt vmcnt(0)
    v_readfirstlane_b32 s61, v17
    s_nop 2
    s_cmp_ge_u32 s61, 3
    s_cbranch_scc1 L_waitd_68
    s_sleep 16
    s_branch L_wait_67
L_waitd_68:
    v_bfe_u32 v8, v1, 4, 1
    v_lshrrev_b32 v9, 5, v1
    v_and_b32 v10, 15, v1
    v_lshlrev_b32 v2, 12, v8
    v_lshl_add_u32 v2, v9, 8, v2
    v_lshl_add_u32 v2, v10, 4, v2
    v_and_b32 v11, 7, v1
    v_lshlrev_b32 v3, 7, v9
    v_lshl_add_u32 v3, v11, 4, v3
    v_lshlrev_b32 v4, 10, v8
    v_lshl_add_u32 v4, v9, 8, v4
    v_lshl_add_u32 v4, v10, 4, v4
    v_and_b32 v11, 31, v1
    v_lshlrev_b32 v5, 4, v11
    v_lshl_add_u32 v5, v9, 3, v5
    v_lshlrev_b32 v6, 13, v11
    v_lshl_add_u32 v6, v9, 4, v6
    v_lshlrev_b32 v12, 2, v9
    v_sub_u32 v7, v11, v12
    s_lshl_b32 s60, s55, 5
    s_add_u32 s60, s60, s56
    s_lshl_b32 s61, s60, 13
    s_lshl_b32 s60, s60, 12
    s_add_u32 s62, s61, 0x3000000
    s_add_u32 s63, s61, 0x1000000
    buffer_load_dwordx4 v[16:19], v2, s[32:35], s62 offen offset:0 sc1
    buffer_load_dwordx4 v[48:51], v2, s[32:35], s63 offen offset:0 sc1
    buffer_load_dwordx4 v[20:23], v2, s[32:35], s62 offen offset:512 sc1
    buffer_load_dwordx4 v[52:55], v2, s[32:35], s63 offen offset:512 sc1
    buffer_load_dwordx4 v[24:27], v2, s[32:35], s62 offen offset:1024 sc1
    buffer_load_dwordx4 v[56:59], v2, s[32:35], s63 offen offset:1024 sc1
    buffer_load_dwordx4 v[28:31], v2, s[32:35], s62 offen offset:1536 sc1
    buffer_load_dwordx4 v[60:63], v2, s[32:35], s63 offen offset:1536 sc1
    buffer_load_dwordx4 v[32:35], v2, s[32:35], s62 offen offset:2048 sc1
    buffer_load_dwordx4 v[64:67], v2, s[32:35], s63 offen offset:2048 sc1
    buffer_load_dwordx4 v[36:39], v2, s[32:35], s62 offen offset:2560 sc1
    buffer_load_dwordx4 v[68:71], v2, s[32:35], s63 offen offset:2560 sc1
    buffer_load_dwordx4 v[40:43], v2, s[32:35], s62 offen offset:3072 sc1
    buffer_load_dwordx4 v[72:75], v2, s[32:35], s63 offen offset:3072 sc1
    buffer_load_dwordx4 v[44:47], v2, s[32:35], s62 offen offset:3584 sc1
    buffer_load_dwordx4 v[76:79], v2, s[32:35], s63 offen offset:3584 sc1
    s_add_u32 s62, s61, 0x2000000
    s_add_u32 s63, s62, 4096
    buffer_load_dwordx2 v[112:113], v4, s[32:35], s62 offen offset:0 sc1
    buffer_load_dwordx2 v[114:115], v4, s[32:35], s62 offen offset:512 sc1
    buffer_load_dwordx2 v[116:117], v4, s[32:35], s62 offen offset:8 sc1
    buffer_load_dwordx2 v[118:119], v4, s[32:35], s62 offen offset:520 sc1
    buffer_load_dwordx2 v[120:121], v4, s[32:35], s62 offen offset:2048 sc1
    buffer_load_dwordx2 v[122:123], v4, s[32:35], s62 offen offset:2560 sc1
    buffer_load_dwordx2 v[124:125], v4, s[32:35], s62 offen offset:2056 sc1
    buffer_load_dwordx2 v[126:127], v4, s[32:35], s62 offen offset:2568 sc1
    buffer_load_dwordx2 v[128:129], v4, s[32:35], s63 offen offset:0 sc1
    buffer_load_dwordx2 v[130:131], v4, s[32:35], s63 offen offset:512 sc1
    buffer_load_dwordx2 v[132:133], v4, s[32:35], s63 offen offset:8 sc1
    buffer_load_dwordx2 v[134:135], v4, s[32:35], s63 offen offset:520 sc1
    buffer_load_dwordx2 v[136:137], v4, s[32:35], s63 offen offset:2048 sc1
    buffer_load_dwordx2 v[138:139], v4, s[32:35], s63 offen offset:2560 sc1
    buffer_load_dwordx2 v[140:141], v4, s[32:35], s63 offen offset:2056 sc1
    buffer_load_dwordx2 v[142:143], v4, s[32:35], s63 offen offset:2568 sc1
    s_lshl_b32 s57, s56, 7
    s_add_u32 s57, s57, 0x1000
    v_mov_b32 v212, 0
L_wait_69:
    s_add_u32 s101, s101, 1
    s_cmp_gt_u32 s101, 0x200000
    s_cbranch_scc1 L_exit
    buffer_load_dwordx4 v[208:211], v212, s[32:35], s57 offen sc1
    s_waitcnt vmcnt(0)
    v_min3_u32 v208, v208, v209, v210
    v_min_u32 v208, v208, v211
    s_nop 0
    v_readfirstlane_b32 s61, v208
    s_nop 2
    s_cmp_gt_u32 s61, s55
    s_cbranch_scc1 L_waitd_70
    s_sleep 4
    s_branch L_wait_69
L_waitd_70:
    s_add_u32 s62, s60, 0x4000000
    buffer_load_dwordx4 v[80:83], v3, s[32:35], s62 offen offset:0 sc1
    buffer_load_dwordx4 v[84:87], v3, s[32:35], s62 offen offset:256 sc1
    buffer_load_dwordx4 v[88:91], v3, s[32:35], s62 offen offset:512 sc1
    buffer_load_dwordx4 v[92:95], v3, s[32:35], s62 offen offset:768 sc1
    buffer_load_dwordx4 v[96:99], v3, s[32:35], s62 offen offset:1024 sc1
    buffer_load_dwordx4 v[100:103], v3, s[32:35], s62 offen offset:1280 sc1
    buffer_load_dwordx4 v[104:107], v3, s[32:35], s62 offen offset:1536 sc1
    buffer_load_dwordx4 v[108:111], v3, s[32:35], s62 offen offset:1792 sc1
    s_add_u32 s62, s60, 0x4000800
    buffer_load_dwordx2 v[144:145], v5, s[32:35], s62 offen offset:0 sc1
    v_mov_b64 v[146:147], 0
    buffer_load_dwordx2 v[148:149], v5, s[32:35], s62 offen offset:512 sc1
    v_mov_b64 v[150:151], 0
    buffer_load_dwordx2 v[152:153], v5, s[32:35], s62 offen offset:1024 sc1
    v_mov_b64 v[154:155], 0
    buffer_load_dwordx2 v[156:157], v5, s[32:35], s62 offen offset:1536 sc1
    v_mov_b64 v[158:159], 0
    s_mov_b32 s64, 0x3db504f3
    s_mov_b32 s65, 0x3db504f3
    s_mov_b32 s66, 0x3fb8aa3b
    s_mov_b32 s67, 0x3fb8aa3b
    v_mfma_f32_32x32x16_bf16 v[160:175], v[48:51], v[16:19], 0
    v_mfma_f32_32x32x16_bf16 v[160:175], v[52:55], v[20:23], v[160:175]
    v_mfma_f32_32x32x16_bf16 v[160:175], v[56:59], v[24:27], v[160:175]
    v_mfma_f32_32x32x16_bf16 v[160:175], v[60:63], v[28:31], v[160:175]
    v_mfma_f32_32x32x16_bf16 v[160:175], v[64:67], v[32:35], v[160:175]
    v_mfma_f32_32x32x16_bf16 v[160:175], v[68:71], v[36:39], v[160:175]
    v_mfma_f32_32x32x16_bf16 v[160:175], v[72:75], v[40:43], v[160:175]
    v_mfma_f32_32x32x16_bf16 v[160:175], v[76:79], v[44:47], v[160:175]
    s_waitcnt vmcnt(4)
    v_mfma_f32_32x32x16_bf16 v[176:191], v[80:83], v[16:19], 0
    v_mfma_f32_32x32x16_bf16 v[176:191], v[84:87], v[20:23], v[176:191]
    v_mfma_f32_32x32x16_bf16 v[176:191], v[88:91], v[24:27], v[176:191]
    v_mfma_f32_32x32x16_bf16 v[176:191], v[92:95], v[28:31], v[176:191]
    v_mfma_f32_32x32x16_bf16 v[176:191], v[96:99], v[32:35], v[176:191]
    v_mfma_f32_32x32x16_bf16 v[176:191], v[100:103], v[36:39], v[176:191]
    v_mfma_f32_32x32x16_bf16 v[176:191], v[104:107], v[40:43], v[176:191]
    v_mfma_f32_32x32x16_bf16 v[176:191], v[108:111], v[44:47], v[176:191]
    s_nop 15
    v_cvt_pk_bf16_f32 v16, v160, v161
    v_lshlrev_b32 v160, 16, v16
    v_and_b32 v161, 0xffff0000, v16
    v_cvt_pk_bf16_f32 v17, v162, v163
    v_lshlrev_b32 v162, 16, v17
    v_and_b32 v163, 0xffff0000, v17
    v_cvt_pk_bf16_f32 v18, v164, v165
    v_lshlrev_b32 v164, 16, v18
    v_and_b32 v165, 0xffff0000, v18
    v_cvt_pk_bf16_f32 v19, v166, v167
    v_lshlrev_b32 v166, 16, v19
    v_and_b32 v167, 0xffff0000, v19
    v_cvt_pk_bf16_f32 v20, v168, v169
    v_lshlrev_b32 v168, 16, v20
    v_and_b32 v169, 0xffff0000, v20
    v_cvt_pk_bf16_f32 v21, v170, v171
    v_lshlrev_b32 v170, 16, v21
    v_and_b32 v171, 0xffff0000, v21
    v_cvt_pk_bf16_f32 v22, v172, v173
    v_lshlrev_b32 v172, 16, v22
    v_and_b32 v173, 0xffff0000, v22
    v_cvt_pk_bf16_f32 v23, v174, v175
    v_lshlrev_b32 v174, 16, v23
    v_and_b32 v175, 0xffff0000, v23
    v_cvt_pk_bf16_f32 v16, v176, v177
    v_lshlrev_b32 v176, 16, v16
    v_and_b32 v177, 0xffff0000, v16
    v_cvt_pk_bf16_f32 v17, v178, v179
    v_lshlrev_b32 v178, 16, v17
    v_and_b32 v179, 0xffff0000, v17
    v_pk_mul_f32 v[160:161], v[160:161], s[64:65]
    v_pk_mul_f32 v[162:163], v[162:163], s[64:65]
    v_pk_mul_f32 v[164:165], v[164:165], s[64:65]
    v_pk_mul_f32 v[166:167], v[166:167], s[64:65]
    v_pk_mul_f32 v[168:169], v[168:169], s[64:65]
    v_pk_mul_f32 v[170:171], v[170:171], s[64:65]
    v_pk_mul_f32 v[172:173], v[172:173], s[64:65]
    v_pk_mul_f32 v[174:175], v[174:175], s[64:65]
    v_pk_mul_f32 v[176:177], v[176:177], s[64:65]
    v_pk_mul_f32 v[178:179], v[178:179], s[64:65]
    v_cvt_pk_bf16_f32 v16, v160, v161
    v_lshlrev_b32 v160, 16, v16
    v_and_b32 v161, 0xffff0000, v16
    v_cvt_pk_bf16_f32 v17, v162, v163
    v_lshlrev_b32 v162, 16, v17
    v_and_b32 v163, 0xffff0000, v17
    v_cvt_pk_bf16_f32 v18, v164, v165
    v_lshlrev_b32 v164, 16, v18
    v_and_b32 v165, 0xffff0000, v18
    v_cvt_pk_bf16_f32 v19, v166, v167
    v_lshlrev_b32 v166, 16, v19
    v_and_b32 v167, 0xffff0000, v19
    v_cvt_pk_bf16_f32 v20, v168, v169
    v_lshlrev_b32 v168, 16, v20
    v_and_b32 v169, 0xffff0000, v20
    v_cvt_pk_bf16_f32 v21, v170, v171
    v_lshlrev_b32 v170, 16, v21
    v_and_b32 v171, 0xffff0000, v21
    v_cvt_pk_bf16_f32 v22, v172, v173
    v_lshlrev_b32 v172, 16, v22
    v_and_b32 v173, 0xffff0000, v22
    v_cvt_pk_bf16_f32 v23, v174, v175
    v_lshlrev_b32 v174, 16, v23
    v_and_b32 v175, 0xffff0000, v23
    v_cvt_pk_bf16_f32 v16, v176, v177
    v_lshlrev_b32 v176, 16, v16
    v_and_b32 v177, 0xffff0000, v16
    v_cvt_pk_bf16_f32 v17, v178, v179
    v_lshlrev_b32 v178, 16, v17
    v_and_b32 v179, 0xffff0000, v17
    v_mov_b32 v26, 0xf149f2ca
    v_cmp_le_i32 vcc, 0, v7
    s_nop 1
    v_cndmask_b32 v160, v26, v160, vcc
    v_cmp_le_i32 vcc, 1, v7
    s_nop 1
    v_cndmask_b32 v161, v26, v161, vcc
    v_cmp_le_i32 vcc, 2, v7
    s_nop 1
    v_cndmask_b32 v162, v26, v162, vcc
    v_cmp_le_i32 vcc, 3, v7
    s_nop 1
    v_cndmask_b32 v163, v26, v163, vcc
    v_cmp_le_i32 vcc, 8, v7
    s_nop 1
    v_cndmask_b32 v164, v26, v164, vcc
    v_cmp_le_i32 vcc, 9, v7
    s_nop 1
    v_cndmask_b32 v165, v26, v165, vcc
    v_cmp_le_i32 vcc, 10, v7
    s_nop 1
    v_cndmask_b32 v166, v26, v166, vcc
    v_cmp_le_i32 vcc, 11, v7
    s_nop 1
    v_cndmask_b32 v167, v26, v167, vcc
    v_cmp_le_i32 vcc, 16, v7
    s_nop 1
    v_cndmask_b32 v168, v26, v168, vcc
    v_cmp_le_i32 vcc, 17, v7
    s_nop 1
    v_cndmask_b32 v169, v26, v169, vcc
    v_cmp_le_i32 vcc, 18, v7
    s_nop 1
    v_cndmask_b32 v170, v26, v170, vcc
    v_cmp_le_i32 vcc, 19, v7
    s_nop 1
    v_cndmask_b32 v171, v26, v171, vcc
    v_cmp_le_i32 vcc, 24, v7
    s_nop 1
    v_cndmask_b32 v172, v26, v172, vcc
    v_cmp_le_i32 vcc, 25, v7
    s_nop 1
    v_cndmask_b32 v173, v26, v173, vcc
    v_cmp_le_i32 vcc, 26, v7
    s_nop 1
    v_cndmask_b32 v174, v26, v174, vcc
    v_cmp_le_i32 vcc, 27, v7
    s_nop 1
    v_cndmask_b32 v175, v26, v175, vcc
    v_max_f32 v24, v160, v161
    v_max3_f32 v24, v24, v162, v163
    v_max3_f32 v24, v24, v164, v165
    v_max3_f32 v24, v24, v166, v167
    v_max3_f32 v24, v24, v168, v169
    v_max3_f32 v24, v24, v170, v171
    v_max3_f32 v24, v24, v172, v173
    v_max3_f32 v24, v24, v174, v175
    v_max3_f32 v24, v24, v176, v177
    v_max3_f32 v24, v24, v178, v179
    v_mov_b32 v25, v24
    s_nop 1
    v_permlane32_swap_b32 v25, v24
    s_nop 0
    v_max_f32 v24, v24, v25
    v_mov_b32 v25, v24
    v_pk_add_f32 v[160:161], v[160:161], v[24:25] neg_lo:[0,1] neg_hi:[0,1]
    v_pk_mul_f32 v[160:161], v[160:161], s[66:67]
    v_pk_add_f32 v[162:163], v[162:163], v[24:25] neg_lo:[0,1] neg_hi:[0,1]
    v_pk_mul_f32 v[162:163], v[162:163], s[66:67]
    v_pk_add_f32 v[164:165], v[164:165], v[24:25] neg_lo:[0,1] neg_hi:[0,1]
    v_pk_mul_f32 v[164:165], v[164:165], s[66:67]
    v_pk_add_f32 v[166:167], v[166:167], v[24:25] neg_lo:[0,1] neg_hi:[0,1]
    v_pk_mul_f32 v[166:167], v[166:167], s[66:67]
    v_pk_add_f32 v[168:169], v[168:169], v[24:25] neg_lo:[0,1] neg_hi:[0,1]
    v_pk_mul_f32 v[168:169], v[168:169], s[66:67]
    v_pk_add_f32 v[170:171], v[170:171], v[24:25] neg_lo:[0,1] neg_hi:[0,1]
    v_pk_mul_f32 v[170:171], v[170:171], s[66:67]
    v_pk_add_f32 v[172:173], v[172:173], v[24:25] neg_lo:[0,1] neg_hi:[0,1]
    v_pk_mul_f32 v[172:173], v[172:173], s[66:67]
    v_pk_add_f32 v[174:175], v[174:175], v[24:25] neg_lo:[0,1] neg_hi:[0,1]
    v_pk_mul_f32 v[174:175], v[174:175], s[66:67]
    v_pk_add_f32 v[176:177], v[176:177], v[24:25] neg_lo:[0,1] neg_hi:[0,1]
    v_pk_mul_f32 v[176:177], v[176:177], s[66:67]
    v_pk_add_f32 v[178:179], v[178:179], v[24:25] neg_lo:[0,1] neg_hi:[0,1]
    v_pk_mul_f32 v[178:179], v[178:179], s[66:67]
    v_exp_f32 v160, v160
    v_exp_f32 v161, v161
    v_exp_f32 v162, v162
    v_exp_f32 v163, v163
    v_exp_f32 v164, v164
    v_exp_f32 v165, v165
    v_exp_f32 v166, v166
    v_exp_f32 v167, v167
    v_exp_f32 v168, v168
    v_exp_f32 v169, v169
    v_exp_f32 v170, v170
    v_exp_f32 v171, v171
    v_exp_f32 v172, v172
    v_exp_f32 v173, v173
    v_exp_f32 v174, v174
    v_exp_f32 v175, v175
    v_exp_f32 v176, v176
    v_exp_f32 v177, v177
    v_exp_f32 v178, v178
    v_exp_f32 v179, v179
    s_nop 0
    v_pk_add_f32 v[16:17], v[160:161], v[162:163]
    v_pk_add_f32 v[16:17], v[16:17], v[164:165]
    v_pk_add_f32 v[16:17], v[16:17], v[166:167]
    v_pk_add_f32 v[16:17], v[16:17], v[168:169]
    v_pk_add_f32 v[16:17], v[16:17], v[170:171]
    v_pk_add_f32 v[16:17], v[16:17], v[172:173]
    v_pk_add_f32 v[16:17], v[16:17], v[174:175]
    v_pk_add_f32 v[16:17], v[16:17], v[176:177]
    v_pk_add_f32 v[16:17], v[16:17], v[178:179]
    v_add_f32 v24, v16, v17
    v_mov_b32 v25, v24
    s_nop 1
    v_permlane32_swap_b32 v25, v24
    s_nop 0
    v_add_f32 v24, v24, v25
    v_rcp_f32 v24, v24
    s_nop 0
    v_mov_b32 v25, v24
    v_pk_mul_f32 v[160:161], v[160:161], v[24:25]
    v_pk_mul_f32 v[162:163], v[162:163], v[24:25]
    v_pk_mul_f32 v[164:165], v[164:165], v[24:25]
    v_pk_mul_f32 v[166:167], v[166:167], v[24:25]
    v_pk_mul_f32 v[168:169], v[168:169], v[24:25]
    v_pk_mul_f32 v[170:171], v[170:171], v[24:25]
    v_pk_mul_f32 v[172:173], v[172:173], v[24:25]
    v_pk_mul_f32 v[174:175], v[174:175], v[24:25]
    v_pk_mul_f32 v[176:177], v[176:177], v[24:25]
    v_pk_mul_f32 v[178:179], v[178:179], v[24:25]
    v_cvt_pk_bf16_f32 v192, v160, v161
    v_cvt_pk_bf16_f32 v193, v162, v163
    v_cvt_pk_bf16_f32 v194, v164, v165
    v_cvt_pk_bf16_f32 v195, v166, v167
    v_cvt_pk_bf16_f32 v196, v168, v169
    v_cvt_pk_bf16_f32 v197, v170, v171
    v_cvt_pk_bf16_f32 v198, v172, v173
    v_cvt_pk_bf16_f32 v199, v174, v175
    v_cvt_pk_bf16_f32 v200, v176, v177
    v_cvt_pk_bf16_f32 v201, v178, v179
    v_mov_b64 v[202:203], 0
    s_waitcnt vmcnt(0)
    s_lshl_b32 s60, s55, 18
    s_lshl_b32 s61, s56, 8
    s_add_u32 s60, s60, s61
    s_add_u32 s60, s60, 0x5000000
    v_mfma_f32_32x32x16_bf16 v[208:223], v[112:115], v[192:195], 0
    v_mfma_f32_32x32x16_bf16 v[208:223], v[116:119], v[196:199], v[208:223]
    v_mfma_f32_32x32x16_bf16 v[208:223], v[144:147], v[200:203], v[208:223]
    v_mfma_f32_32x32x16_bf16 v[224:239], v[120:123], v[192:195], 0
    v_mfma_f32_32x32x16_bf16 v[224:239], v[124:127], v[196:199], v[224:239]
    v_mfma_f32_32x32x16_bf16 v[224:239], v[148:151], v[200:203], v[224:239]
    v_mfma_f32_32x32x16_bf16 v[48:63], v[128:131], v[192:195], 0
    v_mfma_f32_32x32x16_bf16 v[48:63], v[132:135], v[196:199], v[48:63]
    v_mfma_f32_32x32x16_bf16 v[48:63], v[152:155], v[200:203], v[48:63]
    v_mfma_f32_32x32x16_bf16 v[64:79], v[136:139], v[192:195], 0
    v_mfma_f32_32x32x16_bf16 v[64:79], v[140:143], v[196:199], v[64:79]
    v_mfma_f32_32x32x16_bf16 v[64:79], v[156:159], v[200:203], v[64:79]
    s_nop 15
    v_cvt_pk_bf16_f32 v208, v208, v209
    v_cvt_pk_bf16_f32 v209, v210, v211
    v_cvt_pk_bf16_f32 v210, v212, v213
    v_cvt_pk_bf16_f32 v211, v214, v215
    v_cvt_pk_bf16_f32 v212, v216, v217
    v_cvt_pk_bf16_f32 v213, v218, v219
    v_cvt_pk_bf16_f32 v214, v220, v221
    v_cvt_pk_bf16_f32 v215, v222, v223
    s_nop 1
    v_permlane32_swap_b32 v208, v210
    v_permlane32_swap_b32 v209, v211
    v_permlane32_swap_b32 v212, v214
    v_permlane32_swap_b32 v213, v215
    s_nop 0
    buffer_store_dwordx4 v[208:211], v6, s[32:35], s60 offen offset:0 sc1
    buffer_store_dwordx4 v[212:215], v6, s[32:35], s60 offen offset:32 sc1
    v_cvt_pk_bf16_f32 v224, v224, v225
    v_cvt_pk_bf16_f32 v225, v226, v227
    v_cvt_pk_bf16_f32 v226, v228, v229
    v_cvt_pk_bf16_f32 v227, v230, v231
    v_cvt_pk_bf16_f32 v228, v232, v233
    v_cvt_pk_bf16_f32 v229, v234, v235
    v_cvt_pk_bf16_f32 v230, v236, v237
    v_cvt_pk_bf16_f32 v231, v238, v239
    s_nop 1
    v_permlane32_swap_b32 v224, v226
    v_permlane32_swap_b32 v225, v227
    v_permlane32_swap_b32 v228, v230
    v_permlane32_swap_b32 v229, v231
    s_nop 0
    buffer_store_dwordx4 v[224:227], v6, s[32:35], s60 offen offset:64 sc1
    buffer_store_dwordx4 v[228:231], v6, s[32:35], s60 offen offset:96 sc1
    v_cvt_pk_bf16_f32 v48, v48, v49
    v_cvt_pk_bf16_f32 v49, v50, v51
    v_cvt_pk_bf16_f32 v50, v52, v53
    v_cvt_pk_bf16_f32 v51, v54, v55
    v_cvt_pk_bf16_f32 v52, v56, v57
    v_cvt_pk_bf16_f32 v53, v58, v59
    v_cvt_pk_bf16_f32 v54, v60, v61
    v_cvt_pk_bf16_f32 v55, v62, v63
    s_nop 1
    v_permlane32_swap_b32 v48, v50
    v_permlane32_swap_b32 v49, v51
    v_permlane32_swap_b32 v52, v54
    v_permlane32_swap_b32 v53, v55
    s_nop 0
    buffer_store_dwordx4 v[48:51], v6, s[32:35], s60 offen offset:128 sc1
    buffer_store_dwordx4 v[52:55], v6, s[32:35], s60 offen offset:160 sc1
    v_cvt_pk_bf16_f32 v64, v64, v65
    v_cvt_pk_bf16_f32 v65, v66, v67
    v_cvt_pk_bf16_f32 v66, v68, v69
    v_cvt_pk_bf16_f32 v67, v70, v71
    v_cvt_pk_bf16_f32 v68, v72, v73
    v_cvt_pk_bf16_f32 v69, v74, v75
    v_cvt_pk_bf16_f32 v70, v76, v77
    v_cvt_pk_bf16_f32 v71, v78, v79
    s_nop 1
    v_permlane32_swap_b32 v64, v66
    v_permlane32_swap_b32 v65, v67
    v_permlane32_swap_b32 v68, v70
    v_permlane32_swap_b32 v69, v71
    s_nop 0
    buffer_store_dwordx4 v[64:67], v6, s[32:35], s60 offen offset:192 sc1
    buffer_store_dwordx4 v[68:71], v6, s[32:35], s60 offen offset:224 sc1
    s_lshl_b32 s60, s53, 7
    s_add_u32 s60, s60, 0x3000
    s_lshl_b32 s61, s55, 7
    s_add_u32 s61, s61, 0x2000
    s_cmp_ge_u32 s55, 48
    s_cselect_b32 s60, s61, s60
    s_waitcnt vmcnt(0)
    s_barrier
    s_cmp_lg_u32 s45, 0
    s_cbranch_scc1 L_w0_71
    s_cmp_lg_u32 s98, 0
    s_cbranch_scc1 L_id_73
    v_mov_b32 v16, 128
L_iw_72:
    s_add_u32 s101, s101, 1
    s_cmp_gt_u32 s101, 0x200000
    s_cbranch_scc1 L_exit
    global_load_dword v17, v16, s[26:27] sc1
    s_waitcnt vmcnt(0)
    v_readfirstlane_b32 s61, v17
    s_nop 2
    s_cmp_lt_u32 s61, 32
    s_cbranch_scc1 L_iw_72
    s_mov_b32 s98, 1
L_id_73:
    s_mov_b64 exec, 1
    v_mov_b32 v16, 0
    v_mov_b32 v17, 1
    buffer_atomic_add v17, v16, s[32:35], s60 offen
    s_mov_b64 exec, -1
L_w0_71:
    s_branch L_next_regs
L_t_bout:
    s_cmp_lg_u32 s45, 0
    s_cbranch_scc1 L_w0_74
    s_lshl_b32 s60, s53, 7
    s_add_u32 s60, s60, 0x3000
    s_cmp_lg_u32 s98, 0
    s_cbranch_scc1 L_id_76
    v_mov_b32 v16, 128
L_iw_75:
    s_add_u32 s101, s101, 1
    s_cmp_gt_u32 s101, 0x200000
    s_cbranch_scc1 L_exit
    global_load_dword v17, v16, s[26:27] sc1
    s_waitcnt vmcnt(0)
    v_readfirstlane_b32 s61, v17
    s_nop 2
    s_cmp_lt_u32 s61, 32
    s_cbranch_scc1 L_iw_75
    s_mov_b32 s98, 1
L_id_76:
    v_mov_b32 v16, 0
L_wait_77:
    s_add_u32 s101, s101, 1
    s_cmp_gt_u32 s101, 0x200000
    s_cbranch_scc1 L_exit
    buffer_load_dword v17, v16, s[32:35], s60 offen sc1
    s_waitcnt vmcnt(0)
    v_readfirstlane_b32 s61, v17
    s_nop 2
    s_cmp_ge_u32 s61, 32
    s_cbranch_scc1 L_waitd_78
    s_sleep 16
    s_branch L_wait_77
L_waitd_78:
L_w0_74:
    s_barrier
    s_mov_b32 s80, s20
    s_and_b32 s81, s21, 0xffff
    s_mov_b32 s82, 0x400000
    s_mov_b32 s83, 0x00020000
    s_mov_b32 s92, s24
    s_and_b32 s93, s25, 0xffff
    s_mov_b32 s94, 0x400000
    s_mov_b32 s95, 0x00020000
    v_lshrrev_b32 v16, 3, v1
    s_mov_b32 s60, 8192
    v_mul_lo_u32 v16, v16, s60
    v_and_b32 v17, 7, v1
    v_lshrrev_b32 v18, 4, v1
    v_xor_b32 v17, v17, v18
    v_lshl_add_u32 v16, v17, 4, v16
    v_xor_b32 v2, 0, v16
    v_xor_b32 v3, 64, v16
    v_add_u32 v3, 65536, v3
    v_xor_b32 v4, 0, v16
    v_add_u32 v4, 131072, v4
    v_xor_b32 v5, 64, v16
    v_add_u32 v5, 196608, v5
    s_mov_b32 s60, 1024
    v_mul_lo_u32 v16, v18, s60
    v_and_b32 v17, 15, v1
    v_lshlrev_b32 v19, 2, v18
    v_xor_b32 v17, v17, v19
    v_lshl_add_u32 v6, v17, 4, v16
    s_lshl_b32 s60, s53, 2
    s_add_u32 s60, s60, s45
    s_mul_i32 s55, s60, 262144
    s_add_u32 s55, s55, 0x5000000
    s_lshl_b32 s56, s54, 8
    v_mov_b64 v[64:65], 0
    v_mov_b64 v[66:67], 0
    v_mov_b64 v[68:69], 0
    v_mov_b64 v[70:71], 0
    v_mov_b64 v[72:73], 0
    v_mov_b64 v[74:75], 0
    v_mov_b64 v[76:77], 0
    v_mov_b64 v[78:79], 0
    v_mov_b64 v[80:81], 0
    v_mov_b64 v[82:83], 0
    v_mov_b64 v[84:85], 0
    v_mov_b64 v[86:87], 0
    v_mov_b64 v[88:89], 0
    v_mov_b64 v[90:91], 0
    v_mov_b64 v[92:93], 0
    v_mov_b64 v[94:95], 0
    v_mov_b64 v[96:97], 0
    v_mov_b64 v[98:99], 0
    v_mov_b64 v[100:101], 0
    v_mov_b64 v[102:103], 0
    v_mov_b64 v[104:105], 0
    v_mov_b64 v[106:107], 0
    v_mov_b64 v[108:109], 0
    v_mov_b64 v[110:111], 0
    v_mov_b64 v[112:113], 0
    v_mov_b64 v[114:115], 0
    v_mov_b64 v[116:117], 0
    v_mov_b64 v[118:119], 0
    v_mov_b64 v[120:121], 0
    v_mov_b64 v[122:123], 0
    v_mov_b64 v[124:125], 0
    v_mov_b64 v[126:127], 0
    s_mov_b32 s59, 0
    s_lshl_b32 s60, s45, 12
    s_lshl_b32 s61, s59, 7
    s_add_u32 s61, s61, s55
    s_add_u32 m0, s60, 0
    s_nop 0
    buffer_load_dwordx4 v2, s[32:35], s61 offen sc1 lds
    s_add_u32 m0, s60, 1024
    s_nop 0
    buffer_load_dwordx4 v3, s[32:35], s61 offen sc1 lds
    s_add_u32 m0, s60, 2048
    s_nop 0
    buffer_load_dwordx4 v4, s[32:35], s61 offen sc1 lds
    s_add_u32 m0, s60, 3072
    s_nop 0
    buffer_load_dwordx4 v5, s[32:35], s61 offen sc1 lds
    s_lshl_b32 s61, s59, 6
    s_lshl_b32 s62, s45, 4
    s_add_u32 s61, s61, s62
    s_mul_i32 s61, s61, 1024
    s_add_u32 s62, s61, s56
    s_add_u32 m0, s60, 16384
    s_add_u32 s63, s62, 0
    buffer_load_dwordx4 v6, s[80:83], s63 offen lds
    s_add_u32 m0, s60, 17408
    s_add_u32 s63, s62, 4096
    buffer_load_dwordx4 v6, s[80:83], s63 offen lds
    s_add_u32 m0, s60, 18432
    s_add_u32 s63, s62, 8192
    buffer_load_dwordx4 v6, s[80:83], s63 offen lds
    s_add_u32 m0, s60, 19456
    s_add_u32 s63, s62, 12288
    buffer_load_dwordx4 v6, s[80:83], s63 offen lds
    s_mov_b32 s59, 1
    s_lshl_b32 s60, s45, 12
    s_lshl_b32 s61, s59, 7
    s_add_u32 s61, s61, s55
    s_add_u32 m0, s60, 32768
    s_nop 0
    buffer_load_dwordx4 v2, s[32:35], s61 offen sc1 lds
    s_add_u32 m0, s60, 33792
    s_nop 0
    buffer_load_dwordx4 v3, s[32:35], s61 offen sc1 lds
    s_add_u32 m0, s60, 34816
    s_nop 0
    buffer_load_dwordx4 v4, s[32:35], s61 offen sc1 lds
    s_add_u32 m0, s60, 35840
    s_nop 0
    buffer_load_dwordx4 v5, s[32:35], s61 offen sc1 lds
    s_lshl_b32 s61, s59, 6
    s_lshl_b32 s62, s45, 4
    s_add_u32 s61, s61, s62
    s_mul_i32 s61, s61, 1024
    s_add_u32 s62, s61, s56
    s_add_u32 m0, s60, 49152
    s_add_u32 s63, s62, 0
    buffer_load_dwordx4 v6, s[80:83], s63 offen lds
    s_add_u32 m0, s60, 50176
    s_add_u32 s63, s62, 4096
    buffer_load_dwordx4 v6, s[80:83], s63 offen lds
    s_add_u32 m0, s60, 51200
    s_add_u32 s63, s62, 8192
    buffer_load_dwordx4 v6, s[80:83], s63 offen lds
    s_add_u32 m0, s60, 52224
    s_add_u32 s63, s62, 12288
    buffer_load_dwordx4 v6, s[80:83], s63 offen lds
    s_mov_b32 s59, 2
    s_lshl_b32 s60, s45, 12
    s_lshl_b32 s61, s59, 7
    s_add_u32 s61, s61, s55
    s_add_u32 m0, s60, 65536
    s_nop 0
    buffer_load_dwordx4 v2, s[32:35], s61 offen sc1 lds
    s_add_u32 m0, s60, 66560
    s_nop 0
    buffer_load_dwordx4 v3, s[32:35], s61 offen sc1 lds
    s_add_u32 m0, s60, 67584
    s_nop 0
    buffer_load_dwordx4 v4, s[32:35], s61 offen sc1 lds
    s_add_u32 m0, s60, 68608
    s_nop 0
    buffer_load_dwordx4 v5, s[32:35], s61 offen sc1 lds
    s_lshl_b32 s61, s59, 6
    s_lshl_b32 s62, s45, 4
    s_add_u32 s61, s61, s62
    s_mul_i32 s61, s61, 1024
    s_add_u32 s62, s61, s56
    s_add_u32 m0, s60, 81920
    s_add_u32 s63, s62, 0
    buffer_load_dwordx4 v6, s[80:83], s63 offen lds
    s_add_u32 m0, s60, 82944
    s_add_u32 s63, s62, 4096
    buffer_load_dwordx4 v6, s[80:83], s63 offen lds
    s_add_u32 m0, s60, 83968
    s_add_u32 s63, s62, 8192
    buffer_load_dwordx4 v6, s[80:83], s63 offen lds
    s_add_u32 m0, s60, 84992
    s_add_u32 s63, s62, 12288
    buffer_load_dwordx4 v6, s[80:83], s63 offen lds
    s_mov_b32 s100, 2
L_gl_bo:
    s_waitcnt vmcnt(16)
L_gl_bo_in:
    s_barrier
    ds_read_b128 a[48:51], v8
    ds_read_b64_tr_b16 a[0:1], v12 offset:0
    ds_read_b64_tr_b16 a[2:3], v12 offset:1024
    ds_read_b64_tr_b16 a[4:5], v13 offset:0
    ds_read_b64_tr_b16 a[6:7], v13 offset:1024
    ds_read_b64_tr_b16 a[8:9], v14 offset:0
    ds_read_b64_tr_b16 a[10:11], v14 offset:1024
    ds_read_b64_tr_b16 a[12:13], v15 offset:0
    ds_read_b64_tr_b16 a[14:15], v15 offset:1024
    s_add_u32 s100, s100, 1
    s_min_u32 s59, s100, 63
    s_waitcnt lgkmcnt(6)
    v_mfma_f32_32x32x16_bf16 v[64:79], a[0:3], a[48:51], v[64:79]
    ds_read_b128 a[112:115], v9
    ds_read_b64_tr_b16 a[64:65], v12 offset:4096
    ds_read_b64_tr_b16 a[66:67], v12 offset:5120
    s_lshl_b32 s60, s45, 12
    s_lshl_b32 s61, s59, 7
    s_add_u32 s61, s61, s55
    s_add_u32 m0, s60, 98304
    s_nop 0
    buffer_load_dwordx4 v2, s[32:35], s61 offen sc1 lds
    s_waitcnt lgkmcnt(7)
    v_mfma_f32_32x32x16_bf16 v[80:95], a[4:7], a[48:51], v[80:95]
    ds_read_b64_tr_b16 a[68:69], v13 offset:4096
    ds_read_b64_tr_b16 a[70:71], v13 offset:5120
    s_waitcnt lgkmcnt(7)
    v_mfma_f32_32x32x16_bf16 v[96:111], a[8:11], a[48:51], v[96:111]
    ds_read_b64_tr_b16 a[72:73], v14 offset:4096
    ds_read_b64_tr_b16 a[74:75], v14 offset:5120
    s_add_u32 m0, s60, 99328
    s_nop 0
    buffer_load_dwordx4 v3, s[32:35], s61 offen sc1 lds
    s_waitcnt lgkmcnt(7)
    v_mfma_f32_32x32x16_bf16 v[112:127], a[12:15], a[48:51], v[112:127]
    ds_read_b64_tr_b16 a[76:77], v15 offset:4096
    ds_read_b64_tr_b16 a[78:79], v15 offset:5120
    s_waitcnt lgkmcnt(6)
    v_mfma_f32_32x32x16_bf16 v[64:79], a[64:67], a[112:115], v[64:79]
    ds_read_b128 a[48:51], v10
    ds_read_b64_tr_b16 a[0:1], v12 offset:8192
    ds_read_b64_tr_b16 a[2:3], v12 offset:9216
    s_add_u32 m0, s60, 100352
    s_nop 0
    buffer_load_dwordx4 v4, s[32:35], s61 offen sc1 lds
    s_waitcnt lgkmcnt(7)
    v_mfma_f32_32x32x16_bf16 v[80:95], a[68:71], a[112:115], v[80:95]
    ds_read_b64_tr_b16 a[4:5], v13 offset:8192
    ds_read_b64_tr_b16 a[6:7], v13 offset:9216
    s_waitcnt lgkmcnt(7)
    v_mfma_f32_32x32x16_bf16 v[96:111], a[72:75], a[112:115], v[96:111]
    ds_read_b64_tr_b16 a[8:9], v14 offset:8192
    ds_read_b64_tr_b16 a[10:11], v14 offset:9216
    s_add_u32 m0, s60, 101376
    s_nop 0
    buffer_load_dwordx4 v5, s[32:35], s61 offen sc1 lds
    s_waitcnt lgkmcnt(7)
    v_mfma_f32_32x32x16_bf16 v[112:127], a[76:79], a[112:115], v[112:127]
    ds_read_b64_tr_b16 a[12:13], v15 offset:8192
    ds_read_b64_tr_b16 a[14:15], v15 offset:9216
    s_waitcnt lgkmcnt(6)
    v_mfma_f32_32x32x16_bf16 v[64:79], a[0:3], a[48:51], v[64:79]
    ds_read_b128 a[112:115], v11
    ds_read_b64_tr_b16 a[64:65], v12 offset:12288
    ds_read_b64_tr_b16 a[66:67], v12 offset:13312
    s_lshl_b32 s61, s59, 6
    s_lshl_b32 s62, s45, 4
    s_add_u32 s61, s61, s62
    s_mul_i32 s61, s61, 1024
    s_add_u32 s62, s61, s56
    s_add_u32 m0, s60, 114688
    s_add_u32 s63, s62, 0
    buffer_load_dwordx4 v6, s[80:83], s63 offen lds
    s_waitcnt lgkmcnt(7)
    v_mfma_f32_32x32x16_bf16 v[80:95], a[4:7], a[48:51], v[80:95]
    ds_read_b64_tr_b16 a[68:69], v13 offset:12288
    ds_read_b64_tr_b16 a[70:71], v13 offset:13312
    s_waitcnt lgkmcnt(7)
    v_mfma_f32_32x32x16_bf16 v[96:111], a[8:11], a[48:51], v[96:111]
    ds_read_b64_tr_b16 a[72:73], v14 offset:12288
    ds_read_b64_tr_b16 a[74:75], v14 offset:13312
    s_add_u32 m0, s60, 115712
    s_add_u32 s63, s62, 4096
    buffer_load_dwordx4 v6, s[80:83], s63 offen lds
    s_waitcnt lgkmcnt(7)
    v_mfma_f32_32x32x16_bf16 v[112:127], a[12:15], a[48:51], v[112:127]
    ds_read_b64_tr_b16 a[76:77], v15 offset:12288
    ds_read_b64_tr_b16 a[78:79], v15 offset:13312
    s_waitcnt lgkmcnt(6)
    v_mfma_f32_32x32x16_bf16 v[64:79], a[64:67], a[112:115], v[64:79]
    s_add_u32 m0, s60, 116736
    s_add_u32 s63, s62, 8192
    buffer_load_dwordx4 v6, s[80:83], s63 offen lds
    s_waitcnt lgkmcnt(4)
    v_mfma_f32_32x32x16_bf16 v[80:95], a[68:71], a[112:115], v[80:95]
    s_waitcnt lgkmcnt(2)
    v_mfma_f32_32x32x16_bf16 v[96:111], a[72:75], a[112:115], v[96:111]
    s_add_u32 m0, s60, 117760
    s_add_u32 s63, s62, 12288
    buffer_load_dwordx4 v6, s[80:83], s63 offen lds
    s_waitcnt lgkmcnt(0)
    v_mfma_f32_32x32x16_bf16 v[112:127], a[76:79], a[112:115], v[112:127]
    v_add_u32 v8, 0x8000, v8
    v_add_u32 v12, 0x8000, v12
    v_add_u32 v9, 0x8000, v9
    v_add_u32 v13, 0x8000, v13
    v_add_u32 v10, 0x8000, v10
    v_add_u32 v14, 0x8000, v14
    v_add_u32 v11, 0x8000, v11
    v_add_u32 v15, 0x8000, v15
    s_waitcnt vmcnt(16)
    s_barrier
    ds_read_b128 a[48:51], v8
    ds_read_b64_tr_b16 a[0:1], v12 offset:0
    ds_read_b64_tr_b16 a[2:3], v12 offset:1024
    ds_read_b64_tr_b16 a[4:5], v13 offset:0
    ds_read_b64_tr_b16 a[6:7], v13 offset:1024
    ds_read_b64_tr_b16 a[8:9], v14 offset:0
    ds_read_b64_tr_b16 a[10:11], v14 offset:1024
    ds_read_b64_tr_b16 a[12:13], v15 offset:0
    ds_read_b64_tr_b16 a[14:15], v15 offset:1024
    s_add_u32 s100, s100, 1
    s_min_u32 s59, s100, 63
    s_waitcnt lgkmcnt(6)
    v_mfma_f32_32x32x16_bf16 v[64:79], a[0:3], a[48:51], v[64:79]
    ds_read_b128 a[112:115], v9
    ds_read_b64_tr_b16 a[64:65], v12 offset:4096
    ds_read_b64_tr_b16 a[66:67], v12 offset:5120
    s_lshl_b32 s60, s45, 12
    s_lshl_b32 s61, s59, 7
    s_add_u32 s61, s61, s55
    s_add_u32 m0, s60, 0
    s_nop 0
    buffer_load_dwordx4 v2, s[32:35], s61 offen sc1 lds
    s_waitcnt lgkmcnt(7)
    v_mfma_f32_32x32x16_bf16 v[80:95], a[4:7], a[48:51], v[80:95]
    ds_read_b64_tr_b16 a[68:69], v13 offset:4096
    ds_read_b64_tr_b16 a[70:71], v13 offset:5120
    s_waitcnt lgkmcnt(7)
    v_mfma_f32_32x32x16_bf16 v[96:111], a[8:11], a[48:51], v[96:111]
    ds_read_b64_tr_b16 a[72:73], v14 offset:4096
    ds_read_b64_tr_b16 a[74:75], v14 offset:5120
    s_add_u32 m0, s60, 1024
    s_nop 0
    buffer_load_dwordx4 v3, s[32:35], s61 offen sc1 lds
    s_waitcnt lgkmcnt(7)
    v_mfma_f32_32x32x16_bf16 v[112:127], a[12:15], a[48:51], v[112:127]
    ds_read_b64_tr_b16 a[76:77], v15 offset:4096
    ds_read_b64_tr_b16 a[78:79], v15 offset:5120
    s_waitcnt lgkmcnt(6)
    v_mfma_f32_32x32x16_bf16 v[64:79], a[64:67], a[112:115], v[64:79]
    ds_read_b128 a[48:51], v10
    ds_read_b64_tr_b16 a[0:1], v12 offset:8192
    ds_read_b64_tr_b16 a[2:3], v12 offset:9216
    s_add_u32 m0, s60, 2048
    s_nop 0
    buffer_load_dwordx4 v4, s[32:35], s61 offen sc1 lds
    s_waitcnt lgkmcnt(7)
    v_mfma_f32_32x32x16_bf16 v[80:95], a[68:71], a[112:115], v[80:95]
    ds_read_b64_tr_b16 a[4:5], v13 offset:8192
    ds_read_b64_tr_b16 a[6:7], v13 offset:9216
    s_waitcnt lgkmcnt(7)
    v_mfma_f32_32x32x16_bf16 v[96:111], a[72:75], a[112:115], v[96:111]
    ds_read_b64_tr_b16 a[8:9], v14 offset:8192
    ds_read_b64_tr_b16 a[10:11], v14 offset:9216
    s_add_u32 m0, s60, 3072
    s_nop 0
    buffer_load_dwordx4 v5, s[32:35], s61 offen sc1 lds
    s_waitcnt lgkmcnt(7)
    v_mfma_f32_32x32x16_bf16 v[112:127], a[76:79], a[112:115], v[112:127]
    ds_read_b64_tr_b16 a[12:13], v15 offset:8192
    ds_read_b64_tr_b16 a[14:15], v15 offset:9216
    s_waitcnt lgkmcnt(6)
    v_mfma_f32_32x32x16_bf16 v[64:79], a[0:3], a[48:51], v[64:79]
    ds_read_b128 a[112:115], v11
    ds_read_b64_tr_b16 a[64:65], v12 offset:12288
    ds_read_b64_tr_b16 a[66:67], v12 offset:13312
    s_lshl_b32 s61, s59, 6
    s_lshl_b32 s62, s45, 4
    s_add_u32 s61, s61, s62
    s_mul_i32 s61, s61, 1024
    s_add_u32 s62, s61, s56
    s_add_u32 m0, s60, 16384
    s_add_u32 s63, s62, 0
    buffer_load_dwordx4 v6, s[80:83], s63 offen lds
    s_waitcnt lgkmcnt(7)
    v_mfma_f32_32x32x16_bf16 v[80:95], a[4:7], a[48:51], v[80:95]
    ds_read_b64_tr_b16 a[68:69], v13 offset:12288
    ds_read_b64_tr_b16 a[70:71], v13 offset:13312
    s_waitcnt lgkmcnt(7)
    v_mfma_f32_32x32x16_bf16 v[96:111], a[8:11], a[48:51], v[96:111]
    ds_read_b64_tr_b16 a[72:73], v14 offset:12288
    ds_read_b64_tr_b16 a[74:75], v14 offset:13312
    s_add_u32 m0, s60, 17408
    s_add_u32 s63, s62, 4096
    buffer_load_dwordx4 v6, s[80:83], s63 offen lds
    s_waitcnt lgkmcnt(7)
    v_mfma_f32_32x32x16_bf16 v[112:127], a[12:15], a[48:51], v[112:127]
    ds_read_b64_tr_b16 a[76:77], v15 offset:12288
    ds_read_b64_tr_b16 a[78:79], v15 offset:13312
    s_waitcnt lgkmcnt(6)
    v_mfma_f32_32x32x16_bf16 v[64:79], a[64:67], a[112:115], v[64:79]
    s_add_u32 m0, s60, 18432
    s_add_u32 s63, s62, 8192
    buffer_load_dwordx4 v6, s[80:83], s63 offen lds
    s_waitcnt lgkmcnt(4)
    v_mfma_f32_32x32x16_bf16 v[80:95], a[68:71], a[112:115], v[80:95]
    s_waitcnt lgkmcnt(2)
    v_mfma_f32_32x32x16_bf16 v[96:111], a[72:75], a[112:115], v[96:111]
    s_add_u32 m0, s60, 19456
    s_add_u32 s63, s62, 12288
    buffer_load_dwordx4 v6, s[80:83], s63 offen lds
    s_waitcnt lgkmcnt(0)
    v_mfma_f32_32x32x16_bf16 v[112:127], a[76:79], a[112:115], v[112:127]
    v_add_u32 v8, 0x8000, v8
    v_add_u32 v12, 0x8000, v12
    v_add_u32 v9, 0x8000, v9
    v_add_u32 v13, 0x8000, v13
    v_add_u32 v10, 0x8000, v10
    v_add_u32 v14, 0x8000, v14
    v_add_u32 v11, 0x8000, v11
    v_add_u32 v15, 0x8000, v15
    s_waitcnt vmcnt(16)
    s_barrier
    ds_read_b128 a[48:51], v8
    ds_read_b64_tr_b16 a[0:1], v12 offset:0
    ds_read_b64_tr_b16 a[2:3], v12 offset:1024
    ds_read_b64_tr_b16 a[4:5], v13 offset:0
    ds_read_b64_tr_b16 a[6:7], v13 offset:1024
    ds_read_b64_tr_b16 a[8:9], v14 offset:0
    ds_read_b64_tr_b16 a[10:11], v14 offset:1024
    ds_read_b64_tr_b16 a[12:13], v15 offset:0
    ds_read_b64_tr_b16 a[14:15], v15 offset:1024
    s_add_u32 s100, s100, 1
    s_min_u32 s59, s100, 63
    s_waitcnt lgkmcnt(6)
    v_mfma_f32_32x32x16_bf16 v[64:79], a[0:3], a[48:51], v[64:79]
    ds_read_b128 a[112:115], v9
    ds_read_b64_tr_b16 a[64:65], v12 offset:4096
    ds_read_b64_tr_b16 a[66:67], v12 offset:5120
    s_lshl_b32 s60, s45, 12
    s_lshl_b32 s61, s59, 7
    s_add_u32 s61, s61, s55
    s_add_u32 m0, s60, 32768
    s_nop 0
    buffer_load_dwordx4 v2, s[32:35], s61 offen sc1 lds
    s_waitcnt lgkmcnt(7)
    v_mfma_f32_32x32x16_bf16 v[80:95], a[4:7], a[48:51], v[80:95]
    ds_read_b64_tr_b16 a[68:69], v13 offset:4096
    ds_read_b64_tr_b16 a[70:71], v13 offset:5120
    s_waitcnt lgkmcnt(7)
    v_mfma_f32_32x32x16_bf16 v[96:111], a[8:11], a[48:51], v[96:111]
    ds_read_b64_tr_b16 a[72:73], v14 offset:4096
    ds_read_b64_tr_b16 a[74:75], v14 offset:5120
    s_add_u32 m0, s60, 33792
    s_nop 0
    buffer_load_dwordx4 v3, s[32:35], s61 offen sc1 lds
    s_waitcnt lgkmcnt(7)
    v_mfma_f32_32x32x16_bf16 v[112:127], a[12:15], a[48:51], v[112:127]
    ds_read_b64_tr_b16 a[76:77], v15 offset:4096
    ds_read_b64_tr_b16 a[78:79], v15 offset:5120
    s_waitcnt lgkmcnt(6)
    v_mfma_f32_32x32x16_bf16 v[64:79], a[64:67], a[112:115], v[64:79]
    ds_read_b128 a[48:51], v10
    ds_read_b64_tr_b16 a[0:1], v12 offset:8192
    ds_read_b64_tr_b16 a[2:3], v12 offset:9216
    s_add_u32 m0, s60, 34816
    s_nop 0
    buffer_load_dwordx4 v4, s[32:35], s61 offen sc1 lds
    s_waitcnt lgkmcnt(7)
    v_mfma_f32_32x32x16_bf16 v[80:95], a[68:71], a[112:115], v[80:95]
    ds_read_b64_tr_b16 a[4:5], v13 offset:8192
    ds_read_b64_tr_b16 a[6:7], v13 offset:9216
    s_waitcnt lgkmcnt(7)
    v_mfma_f32_32x32x16_bf16 v[96:111], a[72:75], a[112:115], v[96:111]
    ds_read_b64_tr_b16 a[8:9], v14 offset:8192
    ds_read_b64_tr_b16 a[10:11], v14 offset:9216
    s_add_u32 m0, s60, 35840
    s_nop 0
    buffer_load_dwordx4 v5, s[32:35], s61 offen sc1 lds
    s_waitcnt lgkmcnt(7)
    v_mfma_f32_32x32x16_bf16 v[112:127], a[76:79], a[112:115], v[112:127]
    ds_read_b64_tr_b16 a[12:13], v15 offset:8192
    ds_read_b64_tr_b16 a[14:15], v15 offset:9216
    s_waitcnt lgkmcnt(6)
    v_mfma_f32_32x32x16_bf16 v[64:79], a[0:3], a[48:51], v[64:79]
    ds_read_b128 a[112:115], v11
    ds_read_b64_tr_b16 a[64:65], v12 offset:12288
    ds_read_b64_tr_b16 a[66:67], v12 offset:13312
    s_lshl_b32 s61, s59, 6
    s_lshl_b32 s62, s45, 4
    s_add_u32 s61, s61, s62
    s_mul_i32 s61, s61, 1024
    s_add_u32 s62, s61, s56
    s_add_u32 m0, s60, 49152
    s_add_u32 s63, s62, 0
    buffer_load_dwordx4 v6, s[80:83], s63 offen lds
    s_waitcnt lgkmcnt(7)
    v_mfma_f32_32x32x16_bf16 v[80:95], a[4:7], a[48:51], v[80:95]
    ds_read_b64_tr_b16 a[68:69], v13 offset:12288
    ds_read_b64_tr_b16 a[70:71], v13 offset:13312
    s_waitcnt lgkmcnt(7)
    v_mfma_f32_32x32x16_bf16 v[96:111], a[8:11], a[48:51], v[96:111]
    ds_read_b64_tr_b16 a[72:73], v14 offset:12288
    ds_read_b64_tr_b16 a[74:75], v14 offset:13312
    s_add_u32 m0, s60, 50176
    s_add_u32 s63, s62, 4096
    buffer_load_dwordx4 v6, s[80:83], s63 offen lds
    s_waitcnt lgkmcnt(7)
    v_mfma_f32_32x32x16_bf16 v[112:127], a[12:15], a[48:51], v[112:127]
    ds_read_b64_tr_b16 a[76:77], v15 offset:12288
    ds_read_b64_tr_b16 a[78:79], v15 offset:13312
    s_waitcnt lgkmcnt(6)
    v_mfma_f32_32x32x16_bf16 v[64:79], a[64:67], a[112:115], v[64:79]
    s_add_u32 m0, s60, 51200
    s_add_u32 s63, s62, 8192
    buffer_load_dwordx4 v6, s[80:83], s63 offen lds
    s_waitcnt lgkmcnt(4)
    v_mfma_f32_32x32x16_bf16 v[80:95], a[68:71], a[112:115], v[80:95]
    s_waitcnt lgkmcnt(2)
    v_mfma_f32_32x32x16_bf16 v[96:111], a[72:75], a[112:115], v[96:111]
    s_add_u32 m0, s60, 52224
    s_add_u32 s63, s62, 12288
    buffer_load_dwordx4 v6, s[80:83], s63 offen lds
    s_waitcnt lgkmcnt(0)
    v_mfma_f32_32x32x16_bf16 v[112:127], a[76:79], a[112:115], v[112:127]
    v_add_u32 v8, 0x8000, v8
    v_add_u32 v12, 0x8000, v12
    v_add_u32 v9, 0x8000, v9
    v_add_u32 v13, 0x8000, v13
    v_add_u32 v10, 0x8000, v10
    v_add_u32 v14, 0x8000, v14
    v_add_u32 v11, 0x8000, v11
    v_add_u32 v15, 0x8000, v15
    s_waitcnt vmcnt(16)
    s_barrier
    ds_read_b128 a[48:51], v8
    ds_read_b64_tr_b16 a[0:1], v12 offset:0
    ds_read_b64_tr_b16 a[2:3], v12 offset:1024
    ds_read_b64_tr_b16 a[4:5], v13 offset:0
    ds_read_b64_tr_b16 a[6:7], v13 offset:1024
    ds_read_b64_tr_b16 a[8:9], v14 offset:0
    ds_read_b64_tr_b16 a[10:11], v14 offset:1024
    ds_read_b64_tr_b16 a[12:13], v15 offset:0
    ds_read_b64_tr_b16 a[14:15], v15 offset:1024
    s_add_u32 s100, s100, 1
    s_min_u32 s59, s100, 63
    s_waitcnt lgkmcnt(6)
    v_mfma_f32_32x32x16_bf16 v[64:79], a[0:3], a[48:51], v[64:79]
    ds_read_b128 a[112:115], v9
    ds_read_b64_tr_b16 a[64:65], v12 offset:4096
    ds_read_b64_tr_b16 a[66:67], v12 offset:5120
    s_lshl_b32 s60, s45, 12
    s_lshl_b32 s61, s59, 7
    s_add_u32 s61, s61, s55
    s_add_u32 m0, s60, 65536
    s_nop 0
    buffer_load_dwordx4 v2, s[32:35], s61 offen sc1 lds
    s_waitcnt lgkmcnt(7)
    v_mfma_f32_32x32x16_bf16 v[80:95], a[4:7], a[48:51], v[80:95]
    ds_read_b64_tr_b16 a[68:69], v13 offset:4096
    ds_read_b64_tr_b16 a[70:71], v13 offset:5120
    s_waitcnt lgkmcnt(7)
    v_mfma_f32_32x32x16_bf16 v[96:111], a[8:11], a[48:51], v[96:111]
    ds_read_b64_tr_b16 a[72:73], v14 offset:4096
    ds_read_b64_tr_b16 a[74:75], v14 offset:5120
    s_add_u32 m0, s60, 66560
    s_nop 0
    buffer_load_dwordx4 v3, s[32:35], s61 offen sc1 lds
    s_waitcnt lgkmcnt(7)
    v_mfma_f32_32x32x16_bf16 v[112:127], a[12:15], a[48:51], v[112:127]
    ds_read_b64_tr_b16 a[76:77], v15 offset:4096
    ds_read_b64_tr_b16 a[78:79], v15 offset:5120
    s_waitcnt lgkmcnt(6)
    v_mfma_f32_32x32x16_bf16 v[64:79], a[64:67], a[112:115], v[64:79]
    ds_read_b128 a[48:51], v10
    ds_read_b64_tr_b16 a[0:1], v12 offset:8192
    ds_read_b64_tr_b16 a[2:3], v12 offset:9216
    s_add_u32 m0, s60, 67584
    s_nop 0
    buffer_load_dwordx4 v4, s[32:35], s61 offen sc1 lds
    s_waitcnt lgkmcnt(7)
    v_mfma_f32_32x32x16_bf16 v[80:95], a[68:71], a[112:115], v[80:95]
    ds_read_b64_tr_b16 a[4:5], v13 offset:8192
    ds_read_b64_tr_b16 a[6:7], v13 offset:9216
    s_waitcnt lgkmcnt(7)
    v_mfma_f32_32x32x16_bf16 v[96:111], a[72:75], a[112:115], v[96:111]
    ds_read_b64_tr_b16 a[8:9], v14 offset:8192
    ds_read_b64_tr_b16 a[10:11], v14 offset:9216
    s_add_u32 m0, s60, 68608
    s_nop 0
    buffer_load_dwordx4 v5, s[32:35], s61 offen sc1 lds
    s_waitcnt lgkmcnt(7)
    v_mfma_f32_32x32x16_bf16 v[112:127], a[76:79], a[112:115], v[112:127]
    ds_read_b64_tr_b16 a[12:13], v15 offset:8192
    ds_read_b64_tr_b16 a[14:15], v15 offset:9216
    s_waitcnt lgkmcnt(6)
    v_mfma_f32_32x32x16_bf16 v[64:79], a[0:3], a[48:51], v[64:79]
    ds_read_b128 a[112:115], v11
    ds_read_b64_tr_b16 a[64:65], v12 offset:12288
    ds_read_b64_tr_b16 a[66:67], v12 offset:13312
    s_lshl_b32 s61, s59, 6
    s_lshl_b32 s62, s45, 4
    s_add_u32 s61, s61, s62
    s_mul_i32 s61, s61, 1024
    s_add_u32 s62, s61, s56
    s_add_u32 m0, s60, 81920
    s_add_u32 s63, s62, 0
    buffer_load_dwordx4 v6, s[80:83], s63 offen lds
    s_waitcnt lgkmcnt(7)
    v_mfma_f32_32x32x16_bf16 v[80:95], a[4:7], a[48:51], v[80:95]
    ds_read_b64_tr_b16 a[68:69], v13 offset:12288
    ds_read_b64_tr_b16 a[70:71], v13 offset:13312
    s_waitcnt lgkmcnt(7)
    v_mfma_f32_32x32x16_bf16 v[96:111], a[8:11], a[48:51], v[96:111]
    ds_read_b64_tr_b16 a[72:73], v14 offset:12288
    ds_read_b64_tr_b16 a[74:75], v14 offset:13312
    s_add_u32 m0, s60, 82944
    s_add_u32 s63, s62, 4096
    buffer_load_dwordx4 v6, s[80:83], s63 offen lds
    s_waitcnt lgkmcnt(7)
    v_mfma_f32_32x32x16_bf16 v[112:127], a[12:15], a[48:51], v[112:127]
    ds_read_b64_tr_b16 a[76:77], v15 offset:12288
    ds_read_b64_tr_b16 a[78:79], v15 offset:13312
    s_waitcnt lgkmcnt(6)
    v_mfma_f32_32x32x16_bf16 v[64:79], a[64:67], a[112:115], v[64:79]
    s_add_u32 m0, s60, 83968
    s_add_u32 s63, s62, 8192
    buffer_load_dwordx4 v6, s[80:83], s63 offen lds
    s_waitcnt lgkmcnt(4)
    v_mfma_f32_32x32x16_bf16 v[80:95], a[68:71], a[112:115], v[80:95]
    s_waitcnt lgkmcnt(2)
    v_mfma_f32_32x32x16_bf16 v[96:111], a[72:75], a[112:115], v[96:111]
    s_add_u32 m0, s60, 84992
    s_add_u32 s63, s62, 12288
    buffer_load_dwordx4 v6, s[80:83], s63 offen lds
    s_waitcnt lgkmcnt(0)
    v_mfma_f32_32x32x16_bf16 v[112:127], a[76:79], a[112:115], v[112:127]
    v_add_u32 v8, 0xfffe8000, v8
    v_add_u32 v12, 0xfffe8000, v12
    v_add_u32 v9, 0xfffe8000, v9
    v_add_u32 v13, 0xfffe8000, v13
    v_add_u32 v10, 0xfffe8000, v10
    v_add_u32 v14, 0xfffe8000, v14
    v_add_u32 v11, 0xfffe8000, v11
    v_add_u32 v15, 0xfffe8000, v15
    s_cmp_lt_u32 s100, 66
    s_cbranch_scc1 L_gl_bo
    s_waitcnt vmcnt(0)
    s_nop 15
    v_and_b32 v24, 31, v1
    v_lshlrev_b32 v24, 11, v24
    v_lshrrev_b32 v26, 5, v1
    v_lshl_add_u32 v24, v26, 3, v24
    s_lshl_b32 s60, s53, 2
    s_add_u32 s60, s60, s45
    s_lshl_b32 s60, s60, 16
    s_lshl_b32 s61, s54, 8
    s_add_u32 s60, s60, s61
    s_add_u32 s60, s60, 1024
    v_cvt_pk_bf16_f32 v64, v64, v65
    v_cvt_pk_bf16_f32 v65, v66, v67
    v_cvt_pk_bf16_f32 v68, v68, v69
    v_cvt_pk_bf16_f32 v69, v70, v71
    v_cvt_pk_bf16_f32 v72, v72, v73
    v_cvt_pk_bf16_f32 v73, v74, v75
    v_cvt_pk_bf16_f32 v76, v76, v77
    v_cvt_pk_bf16_f32 v77, v78, v79
    buffer_store_dwordx2 v[64:65], v24, s[92:95], s60 offen offset:0
    buffer_store_dwordx2 v[68:69], v24, s[92:95], s60 offen offset:16
    buffer_store_dwordx2 v[72:73], v24, s[92:95], s60 offen offset:32
    buffer_store_dwordx2 v[76:77], v24, s[92:95], s60 offen offset:48
    v_cvt_pk_bf16_f32 v80, v80, v81
    v_cvt_pk_bf16_f32 v81, v82, v83
    v_cvt_pk_bf16_f32 v84, v84, v85
    v_cvt_pk_bf16_f32 v85, v86, v87
    v_cvt_pk_bf16_f32 v88, v88, v89
    v_cvt_pk_bf16_f32 v89, v90, v91
    v_cvt_pk_bf16_f32 v92, v92, v93
    v_cvt_pk_bf16_f32 v93, v94, v95
    buffer_store_dwordx2 v[80:81], v24, s[92:95], s60 offen offset:64
    buffer_store_dwordx2 v[84:85], v24, s[92:95], s60 offen offset:80
    buffer_store_dwordx2 v[88:89], v24, s[92:95], s60 offen offset:96
    buffer_store_dwordx2 v[92:93], v24, s[92:95], s60 offen offset:112
    v_cvt_pk_bf16_f32 v96, v96, v97
    v_cvt_pk_bf16_f32 v97, v98, v99
    v_cvt_pk_bf16_f32 v100, v100, v101
    v_cvt_pk_bf16_f32 v101, v102, v103
    v_cvt_pk_bf16_f32 v104, v104, v105
    v_cvt_pk_bf16_f32 v105, v106, v107
    v_cvt_pk_bf16_f32 v108, v108, v109
    v_cvt_pk_bf16_f32 v109, v110, v111
    buffer_store_dwordx2 v[96:97], v24, s[92:95], s60 offen offset:128
    buffer_store_dwordx2 v[100:101], v24, s[92:95], s60 offen offset:144
    buffer_store_dwordx2 v[104:105], v24, s[92:95], s60 offen offset:160
    buffer_store_dwordx2 v[108:109], v24, s[92:95], s60 offen offset:176
    v_cvt_pk_bf16_f32 v112, v112, v113
    v_cvt_pk_bf16_f32 v113, v114, v115
    v_cvt_pk_bf16_f32 v116, v116, v117
    v_cvt_pk_bf16_f32 v117, v118, v119
    v_cvt_pk_bf16_f32 v120, v120, v121
    v_cvt_pk_bf16_f32 v121, v122, v123
    v_cvt_pk_bf16_f32 v124, v124, v125
    v_cvt_pk_bf16_f32 v125, v126, v127
    buffer_store_dwordx2 v[112:113], v24, s[92:95], s60 offen offset:192
    buffer_store_dwordx2 v[116:117], v24, s[92:95], s60 offen offset:208
    buffer_store_dwordx2 v[120:121], v24, s[92:95], s60 offen offset:224
    buffer_store_dwordx2 v[124:125], v24, s[92:95], s60 offen offset:240
    s_branch L_next
L_exit:
    s_endpgm
.section .rodata,"a"
.p2align 6
.amdhsa_kernel concat_heads__sliding_block__memory_aug_recurrent_mem_tr__prompt_kernel
  .amdhsa_next_free_vgpr 512
  .amdhsa_next_free_sgpr 102
  .amdhsa_accum_offset 256
  .amdhsa_group_segment_fixed_size 0
  .amdhsa_kernarg_size 104
  .amdhsa_user_sgpr_count 2
  .amdhsa_user_sgpr_kernarg_segment_ptr 1
  .amdhsa_system_sgpr_workgroup_id_x 1
  .amdhsa_float_denorm_mode_32 3
.end_amdhsa_kernel
```
